```python
import torch

def _softmax(x, axis=-1):
    return torch.softmax(x, dim=axis)
def _gelu(x):
    return torch.nn.functional.gelu(x, approximate="tanh")
def _silu(x):
    return torch.nn.functional.silu(x)
def _sigmoid(x):
    return torch.sigmoid(x)
def _layernorm(x, axis=-1, eps=1e-5):
    m = x.mean(dim=axis, keepdim=True)
    v = x.var(dim=axis, keepdim=True, unbiased=False)
    return (x - m) / torch.sqrt(v + eps)
def _scatter_add(tgt, idx, src, axis=0):
    return tgt.clone().index_add_(axis, idx, src)
def _segment_sum(src, seg, n):
    out = torch.zeros((n,) + src.shape[1:], dtype=src.dtype)
    return out.index_add_(0, seg, src)
def _pad(x, pw):
    flat = tuple(v for pair in reversed(pw) for v in pair)
    return torch.nn.functional.pad(x, flat)

kernel_name = 'recurrent_scan__mha_block_cached__glu_gated_reglu__prompt'

def setup_inputs():

    _w = (lambda a: (lambda t: t.to(torch.bfloat16) if t.is_floating_point() else t)(torch.as_tensor(a)))
    def _A_setup():
        B, Sq, D = 1, 2048, 1024
        H, Sk, Dh = 32, 2048, 128
        return {
            "x": _w((lambda *s: torch.randn(*s, dtype=torch.bfloat16) * 0.05)(B, Sq, D)),
            "k_cache": _w((lambda *s: torch.randn(*s, dtype=torch.bfloat16) * 1.6)(B, H, Sk, Dh)),
            "v_cache": _w((lambda *s: torch.randn(*s, dtype=torch.bfloat16) * 1.6)(B, H, Sk, Dh)),
            "wq": _w((lambda *s: torch.randn(*s, dtype=torch.bfloat16) * 1.6)(D, H * Dh) * (D ** -0.5)),
            "wo": _w((lambda *s: torch.randn(*s, dtype=torch.bfloat16) * 1.6)(H * Dh, D) * ((H * Dh) ** -0.5)),
        }
    _A_in = _A_setup()

    def _B_setup():
        B, S, D, F = 1, 2048, 1024, 3584
        return {
            "x": _w((lambda *s: torch.randn(*s, dtype=torch.bfloat16) * 0.05)(B, S, D)),
            "W_gate": _w((lambda *s: torch.randn(*s, dtype=torch.bfloat16) * 0.2)(D, F) * (2.0 / D) ** 0.5),
            "W_up": _w((lambda *s: torch.randn(*s, dtype=torch.bfloat16) * 0.2)(D, F) * (2.0 / D) ** 0.5),
            "W_down": _w((lambda *s: torch.randn(*s, dtype=torch.bfloat16) * 0.2)(F, D) * (1.0 / F) ** 0.5),
        }
    _B_in = _B_setup()

    return {
        "A_x": _A_in["x"],
        "A_k_cache": _A_in["k_cache"],
        "A_v_cache": _A_in["v_cache"],
        "A_wq": _A_in["wq"],
        "A_wo": _A_in["wo"],
        "B_x": _B_in["x"],
        "B_W_gate": _B_in["W_gate"],
        "B_W_up": _B_in["W_up"],
        "B_W_down": _B_in["W_down"],
    }

def reference(A_x, A_k_cache, A_v_cache, A_wq, A_wo, B_x, B_W_gate, B_W_up, B_W_down):
    def _A_ref(x, k_cache, v_cache, wq, wo):
        B, Sq, D = x.shape
        H, Dh = 32, 128
        q = (lambda x, *d: x.permute(*d))((x @ wq).reshape(B, Sq, H, Dh), 0, 2, 1, 3)
        scores = torch.einsum("bhqd,bhkd->bhqk", q, k_cache) * (Dh ** -0.5)
        p = _softmax(scores, axis=-1)
        o = torch.einsum("bhqk,bhkd->bhqd", p, v_cache)
        return (lambda x, *d: x.permute(*d))(o, 0, 2, 1, 3).reshape(B, Sq, H * Dh) @ wo

    def _B_ref(x, W_gate, W_up, W_down):
        gate = torch.einsum("bsd,df->bsf", x, W_gate)
        up = torch.einsum("bsd,df->bsf", x, W_up)
        gate = gate * (lambda x, dt: x.to(dt))(gate > 0, gate.dtype)
        h = gate * up
        return torch.einsum("bsf,fd->bsd", h, W_down)

    x = A_x
    xn = _layernorm(x, axis=-1)
    s = _A_ref(xn, A_k_cache, A_v_cache, A_wq, A_wo)
    g = _silu(_B_ref(xn, B_W_gate, B_W_up, B_W_down))
    return x + s * g
```

```asm
; @launch kernel=ln_kernel grid=(512,1,1) block=(256,1,1) lds=0
; @launch kernel=attn_kernel grid=(256,1,1) block=(512,1,1) lds=163840
; @launch kernel=g2_kernel grid=(256,1,1) block=(512,1,1) lds=147456
; @launch kernel=comb_kernel grid=(1024,1,1) block=(256,1,1) lds=0
.amdgcn_target "amdgcn-amd-amdhsa--gfx950"
.text
.globl ln_kernel
.p2align 8
.type ln_kernel,@function
ln_kernel:
    s_cmp_ge_u32 s2, 512
    s_cbranch_scc1 L_ln_done
    s_load_dwordx2 s[4:5], s[0:1], 0
    s_load_dwordx2 s[6:7], s[0:1], 88
    s_load_dwordx2 s[26:27], s[0:1], 24
    s_load_dwordx2 s[16:17], s[0:1], 48
    s_load_dwordx2 s[18:19], s[0:1], 56
    v_and_b32 v1, 63, v0
    v_lshrrev_b32 v2, 6, v0
    s_lshl_b32 s3, s2, 2
    v_add_u32 v2, s3, v2
    v_lshlrev_b32 v2, 11, v2
    v_lshl_add_u32 v2, v1, 4, v2
    s_waitcnt lgkmcnt(0)
    s_mov_b32 s8, s4
    s_mov_b32 s9, s5
    s_and_b32 s9, s9, 0xffff
    s_mov_b32 s10, 0x400000
    s_mov_b32 s11, 0x00020000
    s_mov_b32 s12, s6
    s_mov_b32 s13, s7
    s_and_b32 s13, s13, 0xffff
    s_mov_b32 s14, 0x400000
    s_mov_b32 s15, 0x00020000
    buffer_load_dwordx4 v[4:7], v2, s[8:11], 0 offen
    buffer_load_dwordx4 v[8:11], v2, s[8:11], 0 offen offset:1024
    v_lshrrev_b32 v41, 11, v2
    v_mul_u32_u24 v43, 1024, v41
    v_lshl_add_u32 v43, v1, 4, v43
    s_mov_b32 s28, s26
    s_mov_b32 s29, s27
    s_and_b32 s29, s29, 0xffff
    s_mov_b32 s30, 0x800000
    s_mov_b32 s31, 0x00020000
    buffer_load_dwordx4 v[44:47], v43, s[28:31], 0 offen offset:0
    s_waitcnt vmcnt(1)
    v_lshlrev_b32 v16, 16, v4
    v_and_b32 v17, 0xffff0000, v4
    v_lshlrev_b32 v18, 16, v5
    v_and_b32 v19, 0xffff0000, v5
    v_lshlrev_b32 v20, 16, v6
    v_and_b32 v21, 0xffff0000, v6
    v_lshlrev_b32 v22, 16, v7
    v_and_b32 v23, 0xffff0000, v7
    v_lshlrev_b32 v24, 16, v8
    v_and_b32 v25, 0xffff0000, v8
    v_lshlrev_b32 v26, 16, v9
    v_and_b32 v27, 0xffff0000, v9
    v_lshlrev_b32 v28, 16, v10
    v_and_b32 v29, 0xffff0000, v10
    v_lshlrev_b32 v30, 16, v11
    v_and_b32 v31, 0xffff0000, v11
    v_add_f32 v32, v16, v17
    v_add_f32 v32, v32, v18
    v_add_f32 v32, v32, v19
    v_add_f32 v32, v32, v20
    v_add_f32 v32, v32, v21
    v_add_f32 v32, v32, v22
    v_add_f32 v32, v32, v23
    v_add_f32 v32, v32, v24
    v_add_f32 v32, v32, v25
    v_add_f32 v32, v32, v26
    v_add_f32 v32, v32, v27
    v_add_f32 v32, v32, v28
    v_add_f32 v32, v32, v29
    v_add_f32 v32, v32, v30
    v_add_f32 v32, v32, v31
    s_nop 1
    v_add_f32_dpp v33, v32, v32 quad_perm:[1,0,3,2] row_mask:0xf bank_mask:0xf
    v_mov_b32 v32, v33
    s_nop 1
    v_add_f32_dpp v33, v32, v32 quad_perm:[2,3,0,1] row_mask:0xf bank_mask:0xf
    v_mov_b32 v32, v33
    s_nop 1
    v_add_f32_dpp v33, v32, v32 row_half_mirror row_mask:0xf bank_mask:0xf
    v_mov_b32 v32, v33
    s_nop 1
    v_add_f32_dpp v33, v32, v32 row_mirror row_mask:0xf bank_mask:0xf
    v_mov_b32 v32, v33
    s_nop 0
    v_readlane_b32 s20, v32, 0
    v_readlane_b32 s21, v32, 16
    v_readlane_b32 s22, v32, 32
    v_readlane_b32 s23, v32, 48
    s_nop 1
    v_mov_b32 v32, s20
    v_add_f32 v32, s21, v32
    v_add_f32 v32, s22, v32
    v_add_f32 v32, s23, v32
    v_mul_f32 v32, 0x3a800000, v32
    v_sub_f32 v34, v16, v32
    v_mul_f32 v35, v34, v34
    v_sub_f32 v34, v17, v32
    v_fmac_f32 v35, v34, v34
    v_sub_f32 v34, v18, v32
    v_fmac_f32 v35, v34, v34
    v_sub_f32 v34, v19, v32
    v_fmac_f32 v35, v34, v34
    v_sub_f32 v34, v20, v32
    v_fmac_f32 v35, v34, v34
    v_sub_f32 v34, v21, v32
    v_fmac_f32 v35, v34, v34
    v_sub_f32 v34, v22, v32
    v_fmac_f32 v35, v34, v34
    v_sub_f32 v34, v23, v32
    v_fmac_f32 v35, v34, v34
    v_sub_f32 v34, v24, v32
    v_fmac_f32 v35, v34, v34
    v_sub_f32 v34, v25, v32
    v_fmac_f32 v35, v34, v34
    v_sub_f32 v34, v26, v32
    v_fmac_f32 v35, v34, v34
    v_sub_f32 v34, v27, v32
    v_fmac_f32 v35, v34, v34
    v_sub_f32 v34, v28, v32
    v_fmac_f32 v35, v34, v34
    v_sub_f32 v34, v29, v32
    v_fmac_f32 v35, v34, v34
    v_sub_f32 v34, v30, v32
    v_fmac_f32 v35, v34, v34
    v_sub_f32 v34, v31, v32
    v_fmac_f32 v35, v34, v34
    s_nop 1
    v_add_f32_dpp v33, v35, v35 quad_perm:[1,0,3,2] row_mask:0xf bank_mask:0xf
    v_mov_b32 v35, v33
    s_nop 1
    v_add_f32_dpp v33, v35, v35 quad_perm:[2,3,0,1] row_mask:0xf bank_mask:0xf
    v_mov_b32 v35, v33
    s_nop 1
    v_add_f32_dpp v33, v35, v35 row_half_mirror row_mask:0xf bank_mask:0xf
    v_mov_b32 v35, v33
    s_nop 1
    v_add_f32_dpp v33, v35, v35 row_mirror row_mask:0xf bank_mask:0xf
    v_mov_b32 v35, v33
    s_nop 0
    v_readlane_b32 s20, v35, 0
    v_readlane_b32 s21, v35, 16
    v_readlane_b32 s22, v35, 32
    v_readlane_b32 s23, v35, 48
    s_nop 1
    v_mov_b32 v35, s20
    v_add_f32 v35, s21, v35
    v_add_f32 v35, s22, v35
    v_add_f32 v35, s23, v35
    v_mul_f32 v35, 0x3a800000, v35
    v_cvt_pk_bf16_f32 v32, v32, v32
    v_lshlrev_b32 v32, 16, v32
    v_cvt_pk_bf16_f32 v35, v35, v35
    v_lshlrev_b32 v35, 16, v35
    v_add_f32 v35, 0x3727c5ac, v35
    v_cvt_pk_bf16_f32 v35, v35, v35
    v_lshlrev_b32 v35, 16, v35
    v_sqrt_f32 v35, v35
    s_nop 0
    v_cvt_pk_bf16_f32 v35, v35, v35
    v_lshlrev_b32 v35, 16, v35
    v_rcp_f32 v36, v35
    s_nop 0
    v_sub_f32 v16, v16, v32
    v_cvt_pk_bf16_f32 v16, v16, v16
    v_lshlrev_b32 v16, 16, v16
    v_mul_f32 v37, v16, v36
    v_fma_f32 v38, -v37, v35, v16
    v_fma_f32 v16, v38, v36, v37
    v_sub_f32 v17, v17, v32
    v_cvt_pk_bf16_f32 v17, v17, v17
    v_lshlrev_b32 v17, 16, v17
    v_mul_f32 v37, v17, v36
    v_fma_f32 v38, -v37, v35, v17
    v_fma_f32 v17, v38, v36, v37
    v_sub_f32 v18, v18, v32
    v_cvt_pk_bf16_f32 v18, v18, v18
    v_lshlrev_b32 v18, 16, v18
    v_mul_f32 v37, v18, v36
    v_fma_f32 v38, -v37, v35, v18
    v_fma_f32 v18, v38, v36, v37
    v_sub_f32 v19, v19, v32
    v_cvt_pk_bf16_f32 v19, v19, v19
    v_lshlrev_b32 v19, 16, v19
    v_mul_f32 v37, v19, v36
    v_fma_f32 v38, -v37, v35, v19
    v_fma_f32 v19, v38, v36, v37
    v_sub_f32 v20, v20, v32
    v_cvt_pk_bf16_f32 v20, v20, v20
    v_lshlrev_b32 v20, 16, v20
    v_mul_f32 v37, v20, v36
    v_fma_f32 v38, -v37, v35, v20
    v_fma_f32 v20, v38, v36, v37
    v_sub_f32 v21, v21, v32
    v_cvt_pk_bf16_f32 v21, v21, v21
    v_lshlrev_b32 v21, 16, v21
    v_mul_f32 v37, v21, v36
    v_fma_f32 v38, -v37, v35, v21
    v_fma_f32 v21, v38, v36, v37
    v_sub_f32 v22, v22, v32
    v_cvt_pk_bf16_f32 v22, v22, v22
    v_lshlrev_b32 v22, 16, v22
    v_mul_f32 v37, v22, v36
    v_fma_f32 v38, -v37, v35, v22
    v_fma_f32 v22, v38, v36, v37
    v_sub_f32 v23, v23, v32
    v_cvt_pk_bf16_f32 v23, v23, v23
    v_lshlrev_b32 v23, 16, v23
    v_mul_f32 v37, v23, v36
    v_fma_f32 v38, -v37, v35, v23
    v_fma_f32 v23, v38, v36, v37
    v_sub_f32 v24, v24, v32
    v_cvt_pk_bf16_f32 v24, v24, v24
    v_lshlrev_b32 v24, 16, v24
    v_mul_f32 v37, v24, v36
    v_fma_f32 v38, -v37, v35, v24
    v_fma_f32 v24, v38, v36, v37
    v_sub_f32 v25, v25, v32
    v_cvt_pk_bf16_f32 v25, v25, v25
    v_lshlrev_b32 v25, 16, v25
    v_mul_f32 v37, v25, v36
    v_fma_f32 v38, -v37, v35, v25
    v_fma_f32 v25, v38, v36, v37
    v_sub_f32 v26, v26, v32
    v_cvt_pk_bf16_f32 v26, v26, v26
    v_lshlrev_b32 v26, 16, v26
    v_mul_f32 v37, v26, v36
    v_fma_f32 v38, -v37, v35, v26
    v_fma_f32 v26, v38, v36, v37
    v_sub_f32 v27, v27, v32
    v_cvt_pk_bf16_f32 v27, v27, v27
    v_lshlrev_b32 v27, 16, v27
    v_mul_f32 v37, v27, v36
    v_fma_f32 v38, -v37, v35, v27
    v_fma_f32 v27, v38, v36, v37
    v_sub_f32 v28, v28, v32
    v_cvt_pk_bf16_f32 v28, v28, v28
    v_lshlrev_b32 v28, 16, v28
    v_mul_f32 v37, v28, v36
    v_fma_f32 v38, -v37, v35, v28
    v_fma_f32 v28, v38, v36, v37
    v_sub_f32 v29, v29, v32
    v_cvt_pk_bf16_f32 v29, v29, v29
    v_lshlrev_b32 v29, 16, v29
    v_mul_f32 v37, v29, v36
    v_fma_f32 v38, -v37, v35, v29
    v_fma_f32 v29, v38, v36, v37
    v_sub_f32 v30, v30, v32
    v_cvt_pk_bf16_f32 v30, v30, v30
    v_lshlrev_b32 v30, 16, v30
    v_mul_f32 v37, v30, v36
    v_fma_f32 v38, -v37, v35, v30
    v_fma_f32 v30, v38, v36, v37
    v_sub_f32 v31, v31, v32
    v_cvt_pk_bf16_f32 v31, v31, v31
    v_lshlrev_b32 v31, 16, v31
    v_mul_f32 v37, v31, v36
    v_fma_f32 v38, -v37, v35, v31
    v_fma_f32 v31, v38, v36, v37
    v_cvt_pk_bf16_f32 v4, v16, v17
    v_cvt_pk_bf16_f32 v5, v18, v19
    v_cvt_pk_bf16_f32 v6, v20, v21
    v_cvt_pk_bf16_f32 v7, v22, v23
    v_cvt_pk_bf16_f32 v8, v24, v25
    v_cvt_pk_bf16_f32 v9, v26, v27
    v_cvt_pk_bf16_f32 v10, v28, v29
    v_cvt_pk_bf16_f32 v11, v30, v31
    buffer_store_dwordx4 v[4:7], v2, s[12:15], 0 offen
    buffer_store_dwordx4 v[8:11], v2, s[12:15], 0 offen offset:1024
L_ln_done:
    s_endpgm
.section .rodata,"a"
.p2align 6
.amdhsa_kernel ln_kernel
  .amdhsa_next_free_vgpr 48
  .amdhsa_next_free_sgpr 40
  .amdhsa_accum_offset 48
  .amdhsa_group_segment_fixed_size 0
  .amdhsa_kernarg_size 96
  .amdhsa_user_sgpr_count 2
  .amdhsa_user_sgpr_kernarg_segment_ptr 1
  .amdhsa_system_sgpr_workgroup_id_x 1
  .amdhsa_float_denorm_mode_32 3
.end_amdhsa_kernel
.text
.globl attn_kernel
.p2align 8
.type attn_kernel,@function
attn_kernel:
    s_cmp_ge_u32 s2, 256
    s_cbranch_scc1 L_at_done
    s_load_dwordx2 s[4:5], s[0:1], 88
    s_load_dwordx2 s[54:55], s[0:1], 24
    s_load_dwordx2 s[6:7], s[0:1], 8
    s_load_dwordx2 s[28:29], s[0:1], 16
    s_load_dwordx2 s[40:41], s[0:1], 32
    s_load_dwordx2 s[42:43], s[0:1], 64
    s_load_dwordx2 s[88:89], s[0:1], 48
    s_load_dwordx2 s[90:91], s[0:1], 56
    s_and_b32 s3, s2, 7
    s_lshl_b32 s3, s3, 2
    s_bfe_u32 s30, s2, 0x20003
    s_add_u32 s30, s30, s3
    s_lshr_b32 s31, s2, 5
    v_and_b32 v214, 63, v0
    v_lshrrev_b32 v215, 6, v0
    s_nop 0
    v_readfirstlane_b32 s32, v215
    v_lshrrev_b32 v216, 3, v214
    v_lshrrev_b32 v217, 4, v214
    v_and_b32 v218, 1, v215
    v_lshl_add_u32 v217, v218, 2, v217
    v_xor_b32 v217, v217, v214
    v_and_b32 v217, 7, v217
    v_lshl_add_u32 v216, v215, 3, v216
    s_lshl_b32 s33, s31, 8
    v_add_u32 v216, s33, v216
    v_lshlrev_b32 v216, 11, v216
    v_lshl_add_u32 v186, v217, 4, v216
    v_lshrrev_b32 v216, 4, v214
    v_and_b32 v217, 15, v214
    v_lshlrev_b32 v218, 1, v216
    v_xor_b32 v218, v217, v218
    v_lshl_add_u32 v219, v215, 2, v216
    v_lshlrev_b32 v213, 8, v219
    v_lshl_add_u32 v213, v218, 4, v213
    v_bfe_u32 v187, v215, 1, 1
    v_lshlrev_b32 v187, 3, v187
    v_xor_b32 v218, v218, v187
    v_lshlrev_b32 v187, 13, v219
    v_lshl_add_u32 v187, v218, 4, v187
    v_and_b32 v218, 15, v219
    v_xor_b32 v218, v217, v218
    v_lshlrev_b32 v212, 8, v219
    v_lshl_add_u32 v212, v218, 4, v212
    s_mov_b32 s80, 0
    s_lshl_b32 s81, s30, 8
    s_lshl_b32 s82, s32, 10
    s_waitcnt lgkmcnt(0)
    s_mov_b32 s16, s4
    s_mov_b32 s17, s5
    s_and_b32 s17, s17, 0xffff
    s_mov_b32 s18, 0x400000
    s_mov_b32 s19, 0x00020000
    s_mov_b32 s52, s54
    s_mov_b32 s53, s55
    s_and_b32 s53, s53, 0xffff
    s_mov_b32 s54, 0x800000
    s_mov_b32 s55, 0x00020000
    s_add_u32 m0, s82, 0
    s_add_u32 s35, s80, 0
    buffer_load_dwordx4 v186, s[16:19], s35 offen lds
    s_add_u32 m0, s82, 8192
    s_add_u32 s35, s80, 131072
    buffer_load_dwordx4 v186, s[16:19], s35 offen lds
    s_add_u32 m0, s82, 16384
    s_add_u32 s35, s80, 262144
    buffer_load_dwordx4 v186, s[16:19], s35 offen lds
    s_add_u32 m0, s82, 24576
    s_add_u32 s35, s80, 393216
    buffer_load_dwordx4 v186, s[16:19], s35 offen lds
    s_add_u32 m0, s82, 32768
    s_add_u32 s35, s81, 0
    buffer_load_dwordx4 v187, s[52:55], s35 offen lds
    s_add_u32 m0, s82, 40960
    s_add_u32 s35, s81, 262144
    buffer_load_dwordx4 v187, s[52:55], s35 offen lds
    s_add_u32 s80, s80, 128
    s_add_u32 s81, s81, 524288
    s_add_u32 m0, s82, 49152
    s_add_u32 s35, s80, 0
    buffer_load_dwordx4 v186, s[16:19], s35 offen lds
    s_add_u32 m0, s82, 57344
    s_add_u32 s35, s80, 131072
    buffer_load_dwordx4 v186, s[16:19], s35 offen lds
    s_add_u32 m0, s82, 65536
    s_add_u32 s35, s80, 262144
    buffer_load_dwordx4 v186, s[16:19], s35 offen lds
    s_add_u32 m0, s82, 73728
    s_add_u32 s35, s80, 393216
    buffer_load_dwordx4 v186, s[16:19], s35 offen lds
    s_add_u32 m0, s82, 81920
    s_add_u32 s35, s81, 0
    buffer_load_dwordx4 v187, s[52:55], s35 offen lds
    s_add_u32 m0, s82, 90112
    s_add_u32 s35, s81, 262144
    buffer_load_dwordx4 v187, s[52:55], s35 offen lds
    s_add_u32 s80, s80, 128
    s_add_u32 s81, s81, 524288
    s_add_u32 m0, s82, 98304
    s_add_u32 s35, s80, 0
    buffer_load_dwordx4 v186, s[16:19], s35 offen lds
    s_add_u32 m0, s82, 106496
    s_add_u32 s35, s80, 131072
    buffer_load_dwordx4 v186, s[16:19], s35 offen lds
    s_add_u32 m0, s82, 114688
    s_add_u32 s35, s80, 262144
    buffer_load_dwordx4 v186, s[16:19], s35 offen lds
    s_add_u32 m0, s82, 122880
    s_add_u32 s35, s80, 393216
    buffer_load_dwordx4 v186, s[16:19], s35 offen lds
    s_add_u32 m0, s82, 131072
    s_add_u32 s35, s81, 0
    buffer_load_dwordx4 v187, s[52:55], s35 offen lds
    s_add_u32 m0, s82, 139264
    s_add_u32 s35, s81, 262144
    buffer_load_dwordx4 v187, s[52:55], s35 offen lds
    s_add_u32 s80, s80, 128
    s_add_u32 s81, s81, 524288
    v_and_b32 v216, 15, v214
    v_lshl_add_u32 v216, v215, 5, v216
    v_lshlrev_b32 v216, 7, v216
    v_lshrrev_b32 v217, 4, v214
    v_bfe_u32 v218, v214, 1, 3
    v_xor_b32 v217, v217, v218
    v_xor_b32 v218, 0, v217
    v_lshl_add_u32 v184, v218, 4, v216
    v_xor_b32 v218, 4, v217
    v_lshl_add_u32 v185, v218, 4, v216
    v_bfe_u32 v219, v214, 1, 1
    v_lshlrev_b32 v219, 4, v219
    v_and_b32 v218, 1, v214
    v_lshl_add_u32 v219, v218, 3, v219
    v_bfe_u32 v216, v214, 2, 2
    v_lshrrev_b32 v217, 4, v214
    v_lshl_add_u32 v218, v217, 3, v216
    v_lshl_add_u32 v218, v218, 8, v219
    v_add_u32 v220, 0x8000, v218
    v_lshlrev_b32 v218, 1, v216
    v_and_b32 v221, 1, v217
    v_lshl_add_u32 v218, v221, 3, v218
    v_xor_b32 v221, 0, v218
    v_lshl_add_u32 v176, v221, 4, v220
    v_xor_b32 v221, 2, v218
    v_lshl_add_u32 v177, v221, 4, v220
    v_xor_b32 v221, 4, v218
    v_lshl_add_u32 v178, v221, 4, v220
    v_xor_b32 v221, 6, v218
    v_lshl_add_u32 v179, v221, 4, v220
    v_xor_b32 v221, 8, v218
    v_lshl_add_u32 v180, v221, 4, v220
    v_xor_b32 v221, 10, v218
    v_lshl_add_u32 v181, v221, 4, v220
    v_xor_b32 v221, 12, v218
    v_lshl_add_u32 v182, v221, 4, v220
    v_xor_b32 v221, 14, v218
    v_lshl_add_u32 v183, v221, 4, v220
    v_mul_u32_u24 v218, 1152, v217
    v_lshl_add_u32 v218, v216, 8, v218
    v_add_u32 v218, v218, v219
    v_xor_b32 v221, 0, v216
    v_lshl_add_u32 v204, v221, 5, v218
    v_add_u32 v208, 0x9000, v204
    v_xor_b32 v221, 1, v216
    v_lshl_add_u32 v205, v221, 5, v218
    v_add_u32 v209, 0x9000, v205
    v_xor_b32 v221, 2, v216
    v_lshl_add_u32 v206, v221, 5, v218
    v_add_u32 v210, 0x9000, v206
    v_xor_b32 v221, 3, v216
    v_lshl_add_u32 v207, v221, 5, v218
    v_add_u32 v211, 0x9000, v207
    v_and_b32 v216, 15, v214
    v_xor_b32 v217, v217, v216
    v_lshlrev_b32 v216, 8, v216
    v_add_u32 v216, 0x18000, v216
    v_xor_b32 v218, 0, v217
    v_lshl_add_u32 v200, v218, 4, v216
    v_xor_b32 v218, 4, v217
    v_lshl_add_u32 v201, v218, 4, v216
    v_xor_b32 v218, 8, v217
    v_lshl_add_u32 v202, v218, 4, v216
    v_xor_b32 v218, 12, v217
    v_lshl_add_u32 v203, v218, 4, v216
    s_lshl_b32 s33, s31, 4
    v_lshlrev_b32 v216, 1, v215
    v_add_u32 v216, s33, v216
    v_lshlrev_b32 v216, 7, v216
    s_lshl_b32 s33, s30, 2
    v_add_u32 v216, s33, v216
    v_lshlrev_b32 v216, 10, v216
    v_lshl_add_u32 v220, v214, 4, v216
    s_lshl_b32 s33, s30, 19
    s_add_u32 s8, s6, s33
    s_addc_u32 s9, s7, 0
    s_and_b32 s9, s9, 0xffff
    s_sub_u32 s10, 0x1000000, s33
    s_mov_b32 s11, 0x00020000
    s_add_u32 s12, s28, s33
    s_addc_u32 s13, s29, 0
    s_and_b32 s13, s13, 0xffff
    s_sub_u32 s14, 0x1000000, s33
    s_mov_b32 s15, 0x00020000
    s_add_u32 s64, s4, 0x2400000
    s_addc_u32 s65, s5, 0
    s_and_b32 s65, s65, 0xffff
    s_mov_b32 s66, 0x1000000
    s_mov_b32 s67, 0x00020000
    s_mov_b32 s44, s40
    s_mov_b32 s45, s41
    s_and_b32 s45, s45, 0xffff
    s_mov_b32 s46, 0x800000
    s_mov_b32 s47, 0x00020000
    s_mov_b32 s48, s42
    s_mov_b32 s49, s43
    s_and_b32 s49, s49, 0xffff
    s_mov_b32 s50, 0x700000
    s_mov_b32 s51, 0x00020000
    s_mov_b32 s92, s88
    s_mov_b32 s93, s89
    s_and_b32 s93, s93, 0xffff
    s_mov_b32 s94, 0x700000
    s_mov_b32 s95, 0x00020000
    s_mov_b32 s96, s90
    s_mov_b32 s97, s91
    s_and_b32 s97, s97, 0xffff
    s_mov_b32 s98, 0x700000
    s_mov_b32 s99, 0x00020000
    s_lshl_b32 s33, s2, 3
    v_add_u32 v216, s33, v215
    v_lshlrev_b32 v221, 12, v216
    v_lshl_add_u32 v221, v214, 4, v221
    v_mul_u32_u24 v222, 3584, v216
    v_lshl_add_u32 v223, v214, 3, v222
    v_lshl_add_u32 v222, v214, 4, v222
    s_mov_b32 s83, 0
    s_lshl_b32 s25, s32, 10
    s_add_u32 s25, s25, 98304
    s_mul_i32 s26, s32, 1152
    s_mov_b32 s24, 49152
    s_mov_b32 s36, 0x4e800000
    s_waitcnt vmcnt(12)
    s_barrier
    ds_read_b128 v[128:131], v184 offset:0
    ds_read_b128 v[132:135], v184 offset:2048
    ds_read_b64_tr_b16 v[96:97], v176 offset:0
    ds_read_b64_tr_b16 v[98:99], v176 offset:1024
    ds_read_b64_tr_b16 v[100:101], v177 offset:0
    ds_read_b64_tr_b16 v[102:103], v177 offset:1024
    ds_read_b64_tr_b16 v[104:105], v178 offset:0
    ds_read_b64_tr_b16 v[106:107], v178 offset:1024
    ds_read_b64_tr_b16 v[108:109], v179 offset:0
    ds_read_b64_tr_b16 v[110:111], v179 offset:1024
    ds_read_b64_tr_b16 v[112:113], v180 offset:0
    ds_read_b64_tr_b16 v[114:115], v180 offset:1024
    ds_read_b64_tr_b16 v[116:117], v181 offset:0
    ds_read_b64_tr_b16 v[118:119], v181 offset:1024
    ds_read_b64_tr_b16 v[120:121], v182 offset:0
    ds_read_b64_tr_b16 v[122:123], v182 offset:1024
    ds_read_b64_tr_b16 v[124:125], v183 offset:0
    ds_read_b64_tr_b16 v[126:127], v183 offset:1024
    s_waitcnt lgkmcnt(0)
    v_mfma_f32_16x16x32_bf16 v[0:3], v[96:99], v[128:131], 0
    ds_read_b128 v[168:171], v185 offset:0
    ds_read_b128 v[172:175], v185 offset:2048
    v_mfma_f32_16x16x32_bf16 v[4:7], v[96:99], v[132:135], 0
    ds_read_b64_tr_b16 v[136:137], v176 offset:8192
    ds_read_b64_tr_b16 v[138:139], v176 offset:9216
    v_mfma_f32_16x16x32_bf16 v[8:11], v[100:103], v[128:131], 0
    ds_read_b64_tr_b16 v[140:141], v177 offset:8192
    ds_read_b64_tr_b16 v[142:143], v177 offset:9216
    v_mfma_f32_16x16x32_bf16 v[12:15], v[100:103], v[132:135], 0
    ds_read_b64_tr_b16 v[144:145], v178 offset:8192
    ds_read_b64_tr_b16 v[146:147], v178 offset:9216
    v_mfma_f32_16x16x32_bf16 v[16:19], v[104:107], v[128:131], 0
    ds_read_b64_tr_b16 v[148:149], v179 offset:8192
    v_mfma_f32_16x16x32_bf16 v[20:23], v[104:107], v[132:135], 0
    ds_read_b64_tr_b16 v[150:151], v179 offset:9216
    ds_read_b64_tr_b16 v[152:153], v180 offset:8192
    v_mfma_f32_16x16x32_bf16 v[24:27], v[108:111], v[128:131], 0
    ds_read_b64_tr_b16 v[154:155], v180 offset:9216
    ds_read_b64_tr_b16 v[156:157], v181 offset:8192
    v_mfma_f32_16x16x32_bf16 v[28:31], v[108:111], v[132:135], 0
    ds_read_b64_tr_b16 v[158:159], v181 offset:9216
    ds_read_b64_tr_b16 v[160:161], v182 offset:8192
    v_mfma_f32_16x16x32_bf16 v[32:35], v[112:115], v[128:131], 0
    ds_read_b64_tr_b16 v[162:163], v182 offset:9216
    ds_read_b64_tr_b16 v[164:165], v183 offset:8192
    v_mfma_f32_16x16x32_bf16 v[36:39], v[112:115], v[132:135], 0
    ds_read_b64_tr_b16 v[166:167], v183 offset:9216
    v_mfma_f32_16x16x32_bf16 v[40:43], v[116:119], v[128:131], 0
    v_add_u32 v184, 0xc000, v184
    v_add_u32 v185, 0xc000, v185
    v_mfma_f32_16x16x32_bf16 v[44:47], v[116:119], v[132:135], 0
    v_add_u32 v176, 0xc000, v176
    v_add_u32 v177, 0xc000, v177
    v_mfma_f32_16x16x32_bf16 v[48:51], v[120:123], v[128:131], 0
    v_add_u32 v178, 0xc000, v178
    v_mfma_f32_16x16x32_bf16 v[52:55], v[120:123], v[132:135], 0
    v_add_u32 v179, 0xc000, v179
    v_add_u32 v180, 0xc000, v180
    v_mfma_f32_16x16x32_bf16 v[56:59], v[124:127], v[128:131], 0
    v_add_u32 v181, 0xc000, v181
    v_add_u32 v182, 0xc000, v182
    v_mfma_f32_16x16x32_bf16 v[60:63], v[124:127], v[132:135], 0
    v_add_u32 v183, 0xc000, v183
    s_waitcnt lgkmcnt(0)
    s_waitcnt vmcnt(6)
    s_barrier
    v_mfma_f32_16x16x32_bf16 v[0:3], v[136:139], v[168:171], v[0:3]
    ds_read_b128 v[128:131], v184 offset:0
    ds_read_b128 v[132:135], v184 offset:2048
    v_mfma_f32_16x16x32_bf16 v[4:7], v[136:139], v[172:175], v[4:7]
    ds_read_b64_tr_b16 v[96:97], v176 offset:0
    ds_read_b64_tr_b16 v[98:99], v176 offset:1024
    s_add_u32 m0, s82, 0
    s_add_u32 s35, s80, 0
    buffer_load_dwordx4 v186, s[16:19], s35 offen lds
    v_mfma_f32_16x16x32_bf16 v[8:11], v[140:143], v[168:171], v[8:11]
    ds_read_b64_tr_b16 v[100:101], v177 offset:0
    ds_read_b64_tr_b16 v[102:103], v177 offset:1024
    v_mfma_f32_16x16x32_bf16 v[12:15], v[140:143], v[172:175], v[12:15]
    ds_read_b64_tr_b16 v[104:105], v178 offset:0
    ds_read_b64_tr_b16 v[106:107], v178 offset:1024
    s_add_u32 m0, s82, 8192
    s_add_u32 s35, s80, 131072
    buffer_load_dwordx4 v186, s[16:19], s35 offen lds
    v_mfma_f32_16x16x32_bf16 v[16:19], v[144:147], v[168:171], v[16:19]
    ds_read_b64_tr_b16 v[108:109], v179 offset:0
    v_mfma_f32_16x16x32_bf16 v[20:23], v[144:147], v[172:175], v[20:23]
    ds_read_b64_tr_b16 v[110:111], v179 offset:1024
    ds_read_b64_tr_b16 v[112:113], v180 offset:0
    s_add_u32 m0, s82, 16384
    s_add_u32 s35, s80, 262144
    buffer_load_dwordx4 v186, s[16:19], s35 offen lds
    v_mfma_f32_16x16x32_bf16 v[24:27], v[148:151], v[168:171], v[24:27]
    ds_read_b64_tr_b16 v[114:115], v180 offset:1024
    ds_read_b64_tr_b16 v[116:117], v181 offset:0
    v_mfma_f32_16x16x32_bf16 v[28:31], v[148:151], v[172:175], v[28:31]
    ds_read_b64_tr_b16 v[118:119], v181 offset:1024
    ds_read_b64_tr_b16 v[120:121], v182 offset:0
    s_add_u32 m0, s82, 24576
    s_add_u32 s35, s80, 393216
    buffer_load_dwordx4 v186, s[16:19], s35 offen lds
    v_mfma_f32_16x16x32_bf16 v[32:35], v[152:155], v[168:171], v[32:35]
    ds_read_b64_tr_b16 v[122:123], v182 offset:1024
    ds_read_b64_tr_b16 v[124:125], v183 offset:0
    v_mfma_f32_16x16x32_bf16 v[36:39], v[152:155], v[172:175], v[36:39]
    ds_read_b64_tr_b16 v[126:127], v183 offset:1024
    s_add_u32 m0, s82, 32768
    s_add_u32 s35, s81, 0
    buffer_load_dwordx4 v187, s[52:55], s35 offen lds
    v_mfma_f32_16x16x32_bf16 v[40:43], v[156:159], v[168:171], v[40:43]
    v_mfma_f32_16x16x32_bf16 v[44:47], v[156:159], v[172:175], v[44:47]
    s_add_u32 m0, s82, 40960
    s_add_u32 s35, s81, 262144
    buffer_load_dwordx4 v187, s[52:55], s35 offen lds
    v_mfma_f32_16x16x32_bf16 v[48:51], v[160:163], v[168:171], v[48:51]
    v_mfma_f32_16x16x32_bf16 v[52:55], v[160:163], v[172:175], v[52:55]
    s_add_u32 s80, s80, 128
    s_add_u32 s81, s81, 524288
    v_mfma_f32_16x16x32_bf16 v[56:59], v[164:167], v[168:171], v[56:59]
    v_mfma_f32_16x16x32_bf16 v[60:63], v[164:167], v[172:175], v[60:63]
    s_mov_b32 s27, 4
L_at_qloop:
    s_waitcnt lgkmcnt(0)
    v_mfma_f32_16x16x32_bf16 v[0:3], v[96:99], v[128:131], v[0:3]
    ds_read_b128 v[168:171], v185 offset:0
    ds_read_b128 v[172:175], v185 offset:2048
    v_mfma_f32_16x16x32_bf16 v[4:7], v[96:99], v[132:135], v[4:7]
    ds_read_b64_tr_b16 v[136:137], v176 offset:8192
    ds_read_b64_tr_b16 v[138:139], v176 offset:9216
    v_mfma_f32_16x16x32_bf16 v[8:11], v[100:103], v[128:131], v[8:11]
    ds_read_b64_tr_b16 v[140:141], v177 offset:8192
    ds_read_b64_tr_b16 v[142:143], v177 offset:9216
    v_mfma_f32_16x16x32_bf16 v[12:15], v[100:103], v[132:135], v[12:15]
    ds_read_b64_tr_b16 v[144:145], v178 offset:8192
    ds_read_b64_tr_b16 v[146:147], v178 offset:9216
    v_mfma_f32_16x16x32_bf16 v[16:19], v[104:107], v[128:131], v[16:19]
    ds_read_b64_tr_b16 v[148:149], v179 offset:8192
    v_mfma_f32_16x16x32_bf16 v[20:23], v[104:107], v[132:135], v[20:23]
    ds_read_b64_tr_b16 v[150:151], v179 offset:9216
    ds_read_b64_tr_b16 v[152:153], v180 offset:8192
    v_mfma_f32_16x16x32_bf16 v[24:27], v[108:111], v[128:131], v[24:27]
    ds_read_b64_tr_b16 v[154:155], v180 offset:9216
    ds_read_b64_tr_b16 v[156:157], v181 offset:8192
    v_mfma_f32_16x16x32_bf16 v[28:31], v[108:111], v[132:135], v[28:31]
    ds_read_b64_tr_b16 v[158:159], v181 offset:9216
    ds_read_b64_tr_b16 v[160:161], v182 offset:8192
    v_mfma_f32_16x16x32_bf16 v[32:35], v[112:115], v[128:131], v[32:35]
    ds_read_b64_tr_b16 v[162:163], v182 offset:9216
    ds_read_b64_tr_b16 v[164:165], v183 offset:8192
    v_mfma_f32_16x16x32_bf16 v[36:39], v[112:115], v[132:135], v[36:39]
    ds_read_b64_tr_b16 v[166:167], v183 offset:9216
    v_mfma_f32_16x16x32_bf16 v[40:43], v[116:119], v[128:131], v[40:43]
    v_add_u32 v184, 0xc000, v184
    v_add_u32 v185, 0xc000, v185
    v_mfma_f32_16x16x32_bf16 v[44:47], v[116:119], v[132:135], v[44:47]
    v_add_u32 v176, 0xc000, v176
    v_add_u32 v177, 0xc000, v177
    v_mfma_f32_16x16x32_bf16 v[48:51], v[120:123], v[128:131], v[48:51]
    v_add_u32 v178, 0xc000, v178
    v_mfma_f32_16x16x32_bf16 v[52:55], v[120:123], v[132:135], v[52:55]
    v_add_u32 v179, 0xc000, v179
    v_add_u32 v180, 0xc000, v180
    v_mfma_f32_16x16x32_bf16 v[56:59], v[124:127], v[128:131], v[56:59]
    v_add_u32 v181, 0xc000, v181
    v_add_u32 v182, 0xc000, v182
    v_mfma_f32_16x16x32_bf16 v[60:63], v[124:127], v[132:135], v[60:63]
    v_add_u32 v183, 0xc000, v183
    s_waitcnt lgkmcnt(0)
    s_waitcnt vmcnt(6)
    s_barrier
    v_mfma_f32_16x16x32_bf16 v[0:3], v[136:139], v[168:171], v[0:3]
    ds_read_b128 v[128:131], v184 offset:0
    ds_read_b128 v[132:135], v184 offset:2048
    v_mfma_f32_16x16x32_bf16 v[4:7], v[136:139], v[172:175], v[4:7]
    ds_read_b64_tr_b16 v[96:97], v176 offset:0
    ds_read_b64_tr_b16 v[98:99], v176 offset:1024
    s_add_u32 m0, s82, 49152
    s_add_u32 s35, s80, 0
    buffer_load_dwordx4 v186, s[16:19], s35 offen lds
    v_mfma_f32_16x16x32_bf16 v[8:11], v[140:143], v[168:171], v[8:11]
    ds_read_b64_tr_b16 v[100:101], v177 offset:0
    ds_read_b64_tr_b16 v[102:103], v177 offset:1024
    v_mfma_f32_16x16x32_bf16 v[12:15], v[140:143], v[172:175], v[12:15]
    ds_read_b64_tr_b16 v[104:105], v178 offset:0
    ds_read_b64_tr_b16 v[106:107], v178 offset:1024
    s_add_u32 m0, s82, 57344
    s_add_u32 s35, s80, 131072
    buffer_load_dwordx4 v186, s[16:19], s35 offen lds
    v_mfma_f32_16x16x32_bf16 v[16:19], v[144:147], v[168:171], v[16:19]
    ds_read_b64_tr_b16 v[108:109], v179 offset:0
    v_mfma_f32_16x16x32_bf16 v[20:23], v[144:147], v[172:175], v[20:23]
    ds_read_b64_tr_b16 v[110:111], v179 offset:1024
    ds_read_b64_tr_b16 v[112:113], v180 offset:0
    s_add_u32 m0, s82, 65536
    s_add_u32 s35, s80, 262144
    buffer_load_dwordx4 v186, s[16:19], s35 offen lds
    v_mfma_f32_16x16x32_bf16 v[24:27], v[148:151], v[168:171], v[24:27]
    ds_read_b64_tr_b16 v[114:115], v180 offset:1024
    ds_read_b64_tr_b16 v[116:117], v181 offset:0
    v_mfma_f32_16x16x32_bf16 v[28:31], v[148:151], v[172:175], v[28:31]
    ds_read_b64_tr_b16 v[118:119], v181 offset:1024
    ds_read_b64_tr_b16 v[120:121], v182 offset:0
    s_add_u32 m0, s82, 73728
    s_add_u32 s35, s80, 393216
    buffer_load_dwordx4 v186, s[16:19], s35 offen lds
    v_mfma_f32_16x16x32_bf16 v[32:35], v[152:155], v[168:171], v[32:35]
    ds_read_b64_tr_b16 v[122:123], v182 offset:1024
    ds_read_b64_tr_b16 v[124:125], v183 offset:0
    v_mfma_f32_16x16x32_bf16 v[36:39], v[152:155], v[172:175], v[36:39]
    ds_read_b64_tr_b16 v[126:127], v183 offset:1024
    s_add_u32 m0, s82, 81920
    s_add_u32 s35, s81, 0
    buffer_load_dwordx4 v187, s[52:55], s35 offen lds
    v_mfma_f32_16x16x32_bf16 v[40:43], v[156:159], v[168:171], v[40:43]
    v_mfma_f32_16x16x32_bf16 v[44:47], v[156:159], v[172:175], v[44:47]
    s_add_u32 m0, s82, 90112
    s_add_u32 s35, s81, 262144
    buffer_load_dwordx4 v187, s[52:55], s35 offen lds
    v_mfma_f32_16x16x32_bf16 v[48:51], v[160:163], v[168:171], v[48:51]
    v_mfma_f32_16x16x32_bf16 v[52:55], v[160:163], v[172:175], v[52:55]
    s_add_u32 s80, s80, 128
    s_add_u32 s81, s81, 524288
    v_mfma_f32_16x16x32_bf16 v[56:59], v[164:167], v[168:171], v[56:59]
    v_mfma_f32_16x16x32_bf16 v[60:63], v[164:167], v[172:175], v[60:63]
    s_waitcnt lgkmcnt(0)
    v_mfma_f32_16x16x32_bf16 v[0:3], v[96:99], v[128:131], v[0:3]
    ds_read_b128 v[168:171], v185 offset:0
    ds_read_b128 v[172:175], v185 offset:2048
    v_mfma_f32_16x16x32_bf16 v[4:7], v[96:99], v[132:135], v[4:7]
    ds_read_b64_tr_b16 v[136:137], v176 offset:8192
    ds_read_b64_tr_b16 v[138:139], v176 offset:9216
    v_mfma_f32_16x16x32_bf16 v[8:11], v[100:103], v[128:131], v[8:11]
    ds_read_b64_tr_b16 v[140:141], v177 offset:8192
    ds_read_b64_tr_b16 v[142:143], v177 offset:9216
    v_mfma_f32_16x16x32_bf16 v[12:15], v[100:103], v[132:135], v[12:15]
    ds_read_b64_tr_b16 v[144:145], v178 offset:8192
    ds_read_b64_tr_b16 v[146:147], v178 offset:9216
    v_mfma_f32_16x16x32_bf16 v[16:19], v[104:107], v[128:131], v[16:19]
    ds_read_b64_tr_b16 v[148:149], v179 offset:8192
    v_mfma_f32_16x16x32_bf16 v[20:23], v[104:107], v[132:135], v[20:23]
    ds_read_b64_tr_b16 v[150:151], v179 offset:9216
    ds_read_b64_tr_b16 v[152:153], v180 offset:8192
    v_mfma_f32_16x16x32_bf16 v[24:27], v[108:111], v[128:131], v[24:27]
    ds_read_b64_tr_b16 v[154:155], v180 offset:9216
    ds_read_b64_tr_b16 v[156:157], v181 offset:8192
    v_mfma_f32_16x16x32_bf16 v[28:31], v[108:111], v[132:135], v[28:31]
    ds_read_b64_tr_b16 v[158:159], v181 offset:9216
    ds_read_b64_tr_b16 v[160:161], v182 offset:8192
    v_mfma_f32_16x16x32_bf16 v[32:35], v[112:115], v[128:131], v[32:35]
    ds_read_b64_tr_b16 v[162:163], v182 offset:9216
    ds_read_b64_tr_b16 v[164:165], v183 offset:8192
    v_mfma_f32_16x16x32_bf16 v[36:39], v[112:115], v[132:135], v[36:39]
    ds_read_b64_tr_b16 v[166:167], v183 offset:9216
    v_mfma_f32_16x16x32_bf16 v[40:43], v[116:119], v[128:131], v[40:43]
    v_subrev_u32 v184, 0x18000, v184
    v_subrev_u32 v185, 0x18000, v185
    v_mfma_f32_16x16x32_bf16 v[44:47], v[116:119], v[132:135], v[44:47]
    v_subrev_u32 v176, 0x18000, v176
    v_subrev_u32 v177, 0x18000, v177
    v_mfma_f32_16x16x32_bf16 v[48:51], v[120:123], v[128:131], v[48:51]
    v_subrev_u32 v178, 0x18000, v178
    v_mfma_f32_16x16x32_bf16 v[52:55], v[120:123], v[132:135], v[52:55]
    v_subrev_u32 v179, 0x18000, v179
    v_subrev_u32 v180, 0x18000, v180
    v_mfma_f32_16x16x32_bf16 v[56:59], v[124:127], v[128:131], v[56:59]
    v_subrev_u32 v181, 0x18000, v181
    v_subrev_u32 v182, 0x18000, v182
    v_mfma_f32_16x16x32_bf16 v[60:63], v[124:127], v[132:135], v[60:63]
    v_subrev_u32 v183, 0x18000, v183
    s_waitcnt lgkmcnt(0)
    s_waitcnt vmcnt(6)
    s_barrier
    v_mfma_f32_16x16x32_bf16 v[0:3], v[136:139], v[168:171], v[0:3]
    ds_read_b128 v[128:131], v184 offset:0
    ds_read_b128 v[132:135], v184 offset:2048
    v_mfma_f32_16x16x32_bf16 v[4:7], v[136:139], v[172:175], v[4:7]
    ds_read_b64_tr_b16 v[96:97], v176 offset:0
    ds_read_b64_tr_b16 v[98:99], v176 offset:1024
    s_add_u32 m0, s82, 98304
    s_add_u32 s35, s80, 0
    buffer_load_dwordx4 v186, s[16:19], s35 offen lds
    v_mfma_f32_16x16x32_bf16 v[8:11], v[140:143], v[168:171], v[8:11]
    ds_read_b64_tr_b16 v[100:101], v177 offset:0
    ds_read_b64_tr_b16 v[102:103], v177 offset:1024
    v_mfma_f32_16x16x32_bf16 v[12:15], v[140:143], v[172:175], v[12:15]
    ds_read_b64_tr_b16 v[104:105], v178 offset:0
    ds_read_b64_tr_b16 v[106:107], v178 offset:1024
    s_add_u32 m0, s82, 106496
    s_add_u32 s35, s80, 131072
    buffer_load_dwordx4 v186, s[16:19], s35 offen lds
    v_mfma_f32_16x16x32_bf16 v[16:19], v[144:147], v[168:171], v[16:19]
    ds_read_b64_tr_b16 v[108:109], v179 offset:0
    v_mfma_f32_16x16x32_bf16 v[20:23], v[144:147], v[172:175], v[20:23]
    ds_read_b64_tr_b16 v[110:111], v179 offset:1024
    ds_read_b64_tr_b16 v[112:113], v180 offset:0
    s_add_u32 m0, s82, 114688
    s_add_u32 s35, s80, 262144
    buffer_load_dwordx4 v186, s[16:19], s35 offen lds
    v_mfma_f32_16x16x32_bf16 v[24:27], v[148:151], v[168:171], v[24:27]
    ds_read_b64_tr_b16 v[114:115], v180 offset:1024
    ds_read_b64_tr_b16 v[116:117], v181 offset:0
    v_mfma_f32_16x16x32_bf16 v[28:31], v[148:151], v[172:175], v[28:31]
    ds_read_b64_tr_b16 v[118:119], v181 offset:1024
    ds_read_b64_tr_b16 v[120:121], v182 offset:0
    s_add_u32 m0, s82, 122880
    s_add_u32 s35, s80, 393216
    buffer_load_dwordx4 v186, s[16:19], s35 offen lds
    v_mfma_f32_16x16x32_bf16 v[32:35], v[152:155], v[168:171], v[32:35]
    ds_read_b64_tr_b16 v[122:123], v182 offset:1024
    ds_read_b64_tr_b16 v[124:125], v183 offset:0
    v_mfma_f32_16x16x32_bf16 v[36:39], v[152:155], v[172:175], v[36:39]
    ds_read_b64_tr_b16 v[126:127], v183 offset:1024
    s_add_u32 m0, s82, 131072
    s_add_u32 s35, s81, 0
    buffer_load_dwordx4 v187, s[52:55], s35 offen lds
    v_mfma_f32_16x16x32_bf16 v[40:43], v[156:159], v[168:171], v[40:43]
    v_mfma_f32_16x16x32_bf16 v[44:47], v[156:159], v[172:175], v[44:47]
    s_add_u32 m0, s82, 139264
    s_add_u32 s35, s81, 262144
    buffer_load_dwordx4 v187, s[52:55], s35 offen lds
    v_mfma_f32_16x16x32_bf16 v[48:51], v[160:163], v[168:171], v[48:51]
    v_mfma_f32_16x16x32_bf16 v[52:55], v[160:163], v[172:175], v[52:55]
    s_add_u32 s80, s80, 128
    s_add_u32 s81, s81, 524288
    v_mfma_f32_16x16x32_bf16 v[56:59], v[164:167], v[168:171], v[56:59]
    v_mfma_f32_16x16x32_bf16 v[60:63], v[164:167], v[172:175], v[60:63]
    s_waitcnt lgkmcnt(0)
    v_mfma_f32_16x16x32_bf16 v[0:3], v[96:99], v[128:131], v[0:3]
    ds_read_b128 v[168:171], v185 offset:0
    ds_read_b128 v[172:175], v185 offset:2048
    v_mfma_f32_16x16x32_bf16 v[4:7], v[96:99], v[132:135], v[4:7]
    ds_read_b64_tr_b16 v[136:137], v176 offset:8192
    ds_read_b64_tr_b16 v[138:139], v176 offset:9216
    v_mfma_f32_16x16x32_bf16 v[8:11], v[100:103], v[128:131], v[8:11]
    ds_read_b64_tr_b16 v[140:141], v177 offset:8192
    ds_read_b64_tr_b16 v[142:143], v177 offset:9216
    v_mfma_f32_16x16x32_bf16 v[12:15], v[100:103], v[132:135], v[12:15]
    ds_read_b64_tr_b16 v[144:145], v178 offset:8192
    ds_read_b64_tr_b16 v[146:147], v178 offset:9216
    v_mfma_f32_16x16x32_bf16 v[16:19], v[104:107], v[128:131], v[16:19]
    ds_read_b64_tr_b16 v[148:149], v179 offset:8192
    v_mfma_f32_16x16x32_bf16 v[20:23], v[104:107], v[132:135], v[20:23]
    ds_read_b64_tr_b16 v[150:151], v179 offset:9216
    ds_read_b64_tr_b16 v[152:153], v180 offset:8192
    v_mfma_f32_16x16x32_bf16 v[24:27], v[108:111], v[128:131], v[24:27]
    ds_read_b64_tr_b16 v[154:155], v180 offset:9216
    ds_read_b64_tr_b16 v[156:157], v181 offset:8192
    v_mfma_f32_16x16x32_bf16 v[28:31], v[108:111], v[132:135], v[28:31]
    ds_read_b64_tr_b16 v[158:159], v181 offset:9216
    ds_read_b64_tr_b16 v[160:161], v182 offset:8192
    v_mfma_f32_16x16x32_bf16 v[32:35], v[112:115], v[128:131], v[32:35]
    ds_read_b64_tr_b16 v[162:163], v182 offset:9216
    ds_read_b64_tr_b16 v[164:165], v183 offset:8192
    v_mfma_f32_16x16x32_bf16 v[36:39], v[112:115], v[132:135], v[36:39]
    ds_read_b64_tr_b16 v[166:167], v183 offset:9216
    v_mfma_f32_16x16x32_bf16 v[40:43], v[116:119], v[128:131], v[40:43]
    v_add_u32 v184, 0xc000, v184
    v_add_u32 v185, 0xc000, v185
    v_mfma_f32_16x16x32_bf16 v[44:47], v[116:119], v[132:135], v[44:47]
    v_add_u32 v176, 0xc000, v176
    v_add_u32 v177, 0xc000, v177
    v_mfma_f32_16x16x32_bf16 v[48:51], v[120:123], v[128:131], v[48:51]
    v_add_u32 v178, 0xc000, v178
    v_mfma_f32_16x16x32_bf16 v[52:55], v[120:123], v[132:135], v[52:55]
    v_add_u32 v179, 0xc000, v179
    v_add_u32 v180, 0xc000, v180
    v_mfma_f32_16x16x32_bf16 v[56:59], v[124:127], v[128:131], v[56:59]
    v_add_u32 v181, 0xc000, v181
    v_add_u32 v182, 0xc000, v182
    v_mfma_f32_16x16x32_bf16 v[60:63], v[124:127], v[132:135], v[60:63]
    v_add_u32 v183, 0xc000, v183
    s_waitcnt lgkmcnt(0)
    s_waitcnt vmcnt(6)
    s_barrier
    v_mfma_f32_16x16x32_bf16 v[0:3], v[136:139], v[168:171], v[0:3]
    ds_read_b128 v[128:131], v184 offset:0
    ds_read_b128 v[132:135], v184 offset:2048
    v_mfma_f32_16x16x32_bf16 v[4:7], v[136:139], v[172:175], v[4:7]
    ds_read_b64_tr_b16 v[96:97], v176 offset:0
    ds_read_b64_tr_b16 v[98:99], v176 offset:1024
    s_add_u32 m0, s82, 0
    s_add_u32 s35, s80, 0
    buffer_load_dwordx4 v186, s[16:19], s35 offen lds
    v_mfma_f32_16x16x32_bf16 v[8:11], v[140:143], v[168:171], v[8:11]
    ds_read_b64_tr_b16 v[100:101], v177 offset:0
    ds_read_b64_tr_b16 v[102:103], v177 offset:1024
    v_mfma_f32_16x16x32_bf16 v[12:15], v[140:143], v[172:175], v[12:15]
    ds_read_b64_tr_b16 v[104:105], v178 offset:0
    ds_read_b64_tr_b16 v[106:107], v178 offset:1024
    s_add_u32 m0, s82, 8192
    s_add_u32 s35, s80, 131072
    buffer_load_dwordx4 v186, s[16:19], s35 offen lds
    v_mfma_f32_16x16x32_bf16 v[16:19], v[144:147], v[168:171], v[16:19]
    ds_read_b64_tr_b16 v[108:109], v179 offset:0
    v_mfma_f32_16x16x32_bf16 v[20:23], v[144:147], v[172:175], v[20:23]
    ds_read_b64_tr_b16 v[110:111], v179 offset:1024
    ds_read_b64_tr_b16 v[112:113], v180 offset:0
    s_add_u32 m0, s82, 16384
    s_add_u32 s35, s80, 262144
    buffer_load_dwordx4 v186, s[16:19], s35 offen lds
    v_mfma_f32_16x16x32_bf16 v[24:27], v[148:151], v[168:171], v[24:27]
    ds_read_b64_tr_b16 v[114:115], v180 offset:1024
    ds_read_b64_tr_b16 v[116:117], v181 offset:0
    v_mfma_f32_16x16x32_bf16 v[28:31], v[148:151], v[172:175], v[28:31]
    ds_read_b64_tr_b16 v[118:119], v181 offset:1024
    ds_read_b64_tr_b16 v[120:121], v182 offset:0
    s_add_u32 m0, s82, 24576
    s_add_u32 s35, s80, 393216
    buffer_load_dwordx4 v186, s[16:19], s35 offen lds
    v_mfma_f32_16x16x32_bf16 v[32:35], v[152:155], v[168:171], v[32:35]
    ds_read_b64_tr_b16 v[122:123], v182 offset:1024
    ds_read_b64_tr_b16 v[124:125], v183 offset:0
    v_mfma_f32_16x16x32_bf16 v[36:39], v[152:155], v[172:175], v[36:39]
    ds_read_b64_tr_b16 v[126:127], v183 offset:1024
    s_add_u32 m0, s82, 32768
    s_add_u32 s35, s81, 0
    buffer_load_dwordx4 v187, s[52:55], s35 offen lds
    v_mfma_f32_16x16x32_bf16 v[40:43], v[156:159], v[168:171], v[40:43]
    v_mfma_f32_16x16x32_bf16 v[44:47], v[156:159], v[172:175], v[44:47]
    s_add_u32 m0, s82, 40960
    s_add_u32 s35, s81, 262144
    buffer_load_dwordx4 v187, s[52:55], s35 offen lds
    v_mfma_f32_16x16x32_bf16 v[48:51], v[160:163], v[168:171], v[48:51]
    v_mfma_f32_16x16x32_bf16 v[52:55], v[160:163], v[172:175], v[52:55]
    s_add_u32 s80, s80, 128
    s_add_u32 s81, s81, 524288
    v_mfma_f32_16x16x32_bf16 v[56:59], v[164:167], v[168:171], v[56:59]
    v_mfma_f32_16x16x32_bf16 v[60:63], v[164:167], v[172:175], v[60:63]
    s_sub_u32 s27, s27, 1
    s_cmp_lg_u32 s27, 0
    s_cbranch_scc1 L_at_qloop
    s_waitcnt lgkmcnt(0)
    v_mfma_f32_16x16x32_bf16 v[0:3], v[96:99], v[128:131], v[0:3]
    ds_read_b128 v[168:171], v185 offset:0
    ds_read_b128 v[172:175], v185 offset:2048
    v_mfma_f32_16x16x32_bf16 v[4:7], v[96:99], v[132:135], v[4:7]
    ds_read_b64_tr_b16 v[136:137], v176 offset:8192
    ds_read_b64_tr_b16 v[138:139], v176 offset:9216
    v_mfma_f32_16x16x32_bf16 v[8:11], v[100:103], v[128:131], v[8:11]
    ds_read_b64_tr_b16 v[140:141], v177 offset:8192
    ds_read_b64_tr_b16 v[142:143], v177 offset:9216
    v_mfma_f32_16x16x32_bf16 v[12:15], v[100:103], v[132:135], v[12:15]
    ds_read_b64_tr_b16 v[144:145], v178 offset:8192
    ds_read_b64_tr_b16 v[146:147], v178 offset:9216
    v_mfma_f32_16x16x32_bf16 v[16:19], v[104:107], v[128:131], v[16:19]
    ds_read_b64_tr_b16 v[148:149], v179 offset:8192
    v_mfma_f32_16x16x32_bf16 v[20:23], v[104:107], v[132:135], v[20:23]
    ds_read_b64_tr_b16 v[150:151], v179 offset:9216
    ds_read_b64_tr_b16 v[152:153], v180 offset:8192
    v_mfma_f32_16x16x32_bf16 v[24:27], v[108:111], v[128:131], v[24:27]
    ds_read_b64_tr_b16 v[154:155], v180 offset:9216
    ds_read_b64_tr_b16 v[156:157], v181 offset:8192
    v_mfma_f32_16x16x32_bf16 v[28:31], v[108:111], v[132:135], v[28:31]
    ds_read_b64_tr_b16 v[158:159], v181 offset:9216
    ds_read_b64_tr_b16 v[160:161], v182 offset:8192
    v_mfma_f32_16x16x32_bf16 v[32:35], v[112:115], v[128:131], v[32:35]
    ds_read_b64_tr_b16 v[162:163], v182 offset:9216
    ds_read_b64_tr_b16 v[164:165], v183 offset:8192
    v_mfma_f32_16x16x32_bf16 v[36:39], v[112:115], v[132:135], v[36:39]
    ds_read_b64_tr_b16 v[166:167], v183 offset:9216
    v_mfma_f32_16x16x32_bf16 v[40:43], v[116:119], v[128:131], v[40:43]
    v_add_u32 v184, 0xc000, v184
    v_add_u32 v185, 0xc000, v185
    v_mfma_f32_16x16x32_bf16 v[44:47], v[116:119], v[132:135], v[44:47]
    v_add_u32 v176, 0xc000, v176
    v_add_u32 v177, 0xc000, v177
    v_mfma_f32_16x16x32_bf16 v[48:51], v[120:123], v[128:131], v[48:51]
    v_add_u32 v178, 0xc000, v178
    v_mfma_f32_16x16x32_bf16 v[52:55], v[120:123], v[132:135], v[52:55]
    v_add_u32 v179, 0xc000, v179
    v_add_u32 v180, 0xc000, v180
    v_mfma_f32_16x16x32_bf16 v[56:59], v[124:127], v[128:131], v[56:59]
    v_add_u32 v181, 0xc000, v181
    v_add_u32 v182, 0xc000, v182
    v_mfma_f32_16x16x32_bf16 v[60:63], v[124:127], v[132:135], v[60:63]
    v_add_u32 v183, 0xc000, v183
    s_waitcnt lgkmcnt(0)
    s_waitcnt vmcnt(6)
    s_barrier
    v_mfma_f32_16x16x32_bf16 v[0:3], v[136:139], v[168:171], v[0:3]
    ds_read_b128 v[128:131], v184 offset:0
    ds_read_b128 v[132:135], v184 offset:2048
    v_mfma_f32_16x16x32_bf16 v[4:7], v[136:139], v[172:175], v[4:7]
    ds_read_b64_tr_b16 v[96:97], v176 offset:0
    ds_read_b64_tr_b16 v[98:99], v176 offset:1024
    v_mfma_f32_16x16x32_bf16 v[8:11], v[140:143], v[168:171], v[8:11]
    ds_read_b64_tr_b16 v[100:101], v177 offset:0
    ds_read_b64_tr_b16 v[102:103], v177 offset:1024
    v_mfma_f32_16x16x32_bf16 v[12:15], v[140:143], v[172:175], v[12:15]
    ds_read_b64_tr_b16 v[104:105], v178 offset:0
    ds_read_b64_tr_b16 v[106:107], v178 offset:1024
    v_mfma_f32_16x16x32_bf16 v[16:19], v[144:147], v[168:171], v[16:19]
    ds_read_b64_tr_b16 v[108:109], v179 offset:0
    v_mfma_f32_16x16x32_bf16 v[20:23], v[144:147], v[172:175], v[20:23]
    ds_read_b64_tr_b16 v[110:111], v179 offset:1024
    ds_read_b64_tr_b16 v[112:113], v180 offset:0
    v_mfma_f32_16x16x32_bf16 v[24:27], v[148:151], v[168:171], v[24:27]
    ds_read_b64_tr_b16 v[114:115], v180 offset:1024
    ds_read_b64_tr_b16 v[116:117], v181 offset:0
    v_mfma_f32_16x16x32_bf16 v[28:31], v[148:151], v[172:175], v[28:31]
    ds_read_b64_tr_b16 v[118:119], v181 offset:1024
    ds_read_b64_tr_b16 v[120:121], v182 offset:0
    v_mfma_f32_16x16x32_bf16 v[32:35], v[152:155], v[168:171], v[32:35]
    ds_read_b64_tr_b16 v[122:123], v182 offset:1024
    ds_read_b64_tr_b16 v[124:125], v183 offset:0
    v_mfma_f32_16x16x32_bf16 v[36:39], v[152:155], v[172:175], v[36:39]
    ds_read_b64_tr_b16 v[126:127], v183 offset:1024
    v_mfma_f32_16x16x32_bf16 v[40:43], v[156:159], v[168:171], v[40:43]
    v_mfma_f32_16x16x32_bf16 v[44:47], v[156:159], v[172:175], v[44:47]
    v_mfma_f32_16x16x32_bf16 v[48:51], v[160:163], v[168:171], v[48:51]
    v_mfma_f32_16x16x32_bf16 v[52:55], v[160:163], v[172:175], v[52:55]
    v_mfma_f32_16x16x32_bf16 v[56:59], v[164:167], v[168:171], v[56:59]
    v_mfma_f32_16x16x32_bf16 v[60:63], v[164:167], v[172:175], v[60:63]
    s_waitcnt lgkmcnt(0)
    v_mfma_f32_16x16x32_bf16 v[0:3], v[96:99], v[128:131], v[0:3]
    ds_read_b128 v[168:171], v185 offset:0
    ds_read_b128 v[172:175], v185 offset:2048
    v_mfma_f32_16x16x32_bf16 v[4:7], v[96:99], v[132:135], v[4:7]
    ds_read_b64_tr_b16 v[136:137], v176 offset:8192
    ds_read_b64_tr_b16 v[138:139], v176 offset:9216
    v_mfma_f32_16x16x32_bf16 v[8:11], v[100:103], v[128:131], v[8:11]
    ds_read_b64_tr_b16 v[140:141], v177 offset:8192
    ds_read_b64_tr_b16 v[142:143], v177 offset:9216
    v_mfma_f32_16x16x32_bf16 v[12:15], v[100:103], v[132:135], v[12:15]
    ds_read_b64_tr_b16 v[144:145], v178 offset:8192
    ds_read_b64_tr_b16 v[146:147], v178 offset:9216
    v_mfma_f32_16x16x32_bf16 v[16:19], v[104:107], v[128:131], v[16:19]
    ds_read_b64_tr_b16 v[148:149], v179 offset:8192
    v_mfma_f32_16x16x32_bf16 v[20:23], v[104:107], v[132:135], v[20:23]
    ds_read_b64_tr_b16 v[150:151], v179 offset:9216
    ds_read_b64_tr_b16 v[152:153], v180 offset:8192
    v_mfma_f32_16x16x32_bf16 v[24:27], v[108:111], v[128:131], v[24:27]
    ds_read_b64_tr_b16 v[154:155], v180 offset:9216
    ds_read_b64_tr_b16 v[156:157], v181 offset:8192
    v_mfma_f32_16x16x32_bf16 v[28:31], v[108:111], v[132:135], v[28:31]
    ds_read_b64_tr_b16 v[158:159], v181 offset:9216
    ds_read_b64_tr_b16 v[160:161], v182 offset:8192
    v_mfma_f32_16x16x32_bf16 v[32:35], v[112:115], v[128:131], v[32:35]
    ds_read_b64_tr_b16 v[162:163], v182 offset:9216
    ds_read_b64_tr_b16 v[164:165], v183 offset:8192
    v_mfma_f32_16x16x32_bf16 v[36:39], v[112:115], v[132:135], v[36:39]
    ds_read_b64_tr_b16 v[166:167], v183 offset:9216
    v_mfma_f32_16x16x32_bf16 v[40:43], v[116:119], v[128:131], v[40:43]
    v_subrev_u32 v184, 0x18000, v184
    v_subrev_u32 v185, 0x18000, v185
    v_mfma_f32_16x16x32_bf16 v[44:47], v[116:119], v[132:135], v[44:47]
    v_subrev_u32 v176, 0x18000, v176
    v_subrev_u32 v177, 0x18000, v177
    v_mfma_f32_16x16x32_bf16 v[48:51], v[120:123], v[128:131], v[48:51]
    v_subrev_u32 v178, 0x18000, v178
    v_mfma_f32_16x16x32_bf16 v[52:55], v[120:123], v[132:135], v[52:55]
    v_subrev_u32 v179, 0x18000, v179
    v_subrev_u32 v180, 0x18000, v180
    v_mfma_f32_16x16x32_bf16 v[56:59], v[124:127], v[128:131], v[56:59]
    v_subrev_u32 v181, 0x18000, v181
    v_subrev_u32 v182, 0x18000, v182
    v_mfma_f32_16x16x32_bf16 v[60:63], v[124:127], v[132:135], v[60:63]
    v_subrev_u32 v183, 0x18000, v183
    s_waitcnt lgkmcnt(0)
    s_waitcnt vmcnt(0)
    s_barrier
    v_mfma_f32_16x16x32_bf16 v[0:3], v[136:139], v[168:171], v[0:3]
    ds_read_b128 v[128:131], v184 offset:0
    ds_read_b128 v[132:135], v184 offset:2048
    v_mfma_f32_16x16x32_bf16 v[4:7], v[136:139], v[172:175], v[4:7]
    ds_read_b64_tr_b16 v[96:97], v176 offset:0
    ds_read_b64_tr_b16 v[98:99], v176 offset:1024
    s_add_u32 m0, s25, 0
    s_mov_b32 s35, 0
    buffer_load_dwordx4 v212, s[8:11], s35 offen lds
    v_mfma_f32_16x16x32_bf16 v[8:11], v[140:143], v[168:171], v[8:11]
    ds_read_b64_tr_b16 v[100:101], v177 offset:0
    ds_read_b64_tr_b16 v[102:103], v177 offset:1024
    v_mfma_f32_16x16x32_bf16 v[12:15], v[140:143], v[172:175], v[12:15]
    ds_read_b64_tr_b16 v[104:105], v178 offset:0
    ds_read_b64_tr_b16 v[106:107], v178 offset:1024
    s_add_u32 m0, s25, 8192
    s_mov_b32 s35, 8192
    buffer_load_dwordx4 v212, s[8:11], s35 offen lds
    v_mfma_f32_16x16x32_bf16 v[16:19], v[144:147], v[168:171], v[16:19]
    ds_read_b64_tr_b16 v[108:109], v179 offset:0
    v_mfma_f32_16x16x32_bf16 v[20:23], v[144:147], v[172:175], v[20:23]
    ds_read_b64_tr_b16 v[110:111], v179 offset:1024
    ds_read_b64_tr_b16 v[112:113], v180 offset:0
    v_mfma_f32_16x16x32_bf16 v[24:27], v[148:151], v[168:171], v[24:27]
    ds_read_b64_tr_b16 v[114:115], v180 offset:1024
    ds_read_b64_tr_b16 v[116:117], v181 offset:0
    s_add_u32 m0, s25, 16384
    s_mov_b32 s35, 16384
    buffer_load_dwordx4 v212, s[8:11], s35 offen lds
    v_mfma_f32_16x16x32_bf16 v[28:31], v[148:151], v[172:175], v[28:31]
    ds_read_b64_tr_b16 v[118:119], v181 offset:1024
    ds_read_b64_tr_b16 v[120:121], v182 offset:0
    v_mfma_f32_16x16x32_bf16 v[32:35], v[152:155], v[168:171], v[32:35]
    ds_read_b64_tr_b16 v[122:123], v182 offset:1024
    ds_read_b64_tr_b16 v[124:125], v183 offset:0
    s_add_u32 m0, s25, 24576
    s_mov_b32 s35, 24576
    buffer_load_dwordx4 v212, s[8:11], s35 offen lds
    v_mfma_f32_16x16x32_bf16 v[36:39], v[152:155], v[172:175], v[36:39]
    ds_read_b64_tr_b16 v[126:127], v183 offset:1024
    v_mfma_f32_16x16x32_bf16 v[40:43], v[156:159], v[168:171], v[40:43]
    v_mfma_f32_16x16x32_bf16 v[44:47], v[156:159], v[172:175], v[44:47]
    s_add_u32 m0, s25, 32768
    s_mov_b32 s35, 32768
    buffer_load_dwordx4 v212, s[8:11], s35 offen lds
    v_mfma_f32_16x16x32_bf16 v[48:51], v[160:163], v[168:171], v[48:51]
    v_mfma_f32_16x16x32_bf16 v[52:55], v[160:163], v[172:175], v[52:55]
    s_add_u32 m0, s25, 40960
    s_mov_b32 s35, 40960
    buffer_load_dwordx4 v212, s[8:11], s35 offen lds
    v_mfma_f32_16x16x32_bf16 v[56:59], v[164:167], v[168:171], v[56:59]
    v_mfma_f32_16x16x32_bf16 v[60:63], v[164:167], v[172:175], v[60:63]
    s_waitcnt lgkmcnt(0)
    v_mfma_f32_16x16x32_bf16 v[0:3], v[96:99], v[128:131], v[0:3]
    ds_read_b128 v[168:171], v185 offset:0
    ds_read_b128 v[172:175], v185 offset:2048
    v_mfma_f32_16x16x32_bf16 v[4:7], v[96:99], v[132:135], v[4:7]
    ds_read_b64_tr_b16 v[136:137], v176 offset:8192
    ds_read_b64_tr_b16 v[138:139], v176 offset:9216
    v_mfma_f32_16x16x32_bf16 v[8:11], v[100:103], v[128:131], v[8:11]
    ds_read_b64_tr_b16 v[140:141], v177 offset:8192
    ds_read_b64_tr_b16 v[142:143], v177 offset:9216
    v_mfma_f32_16x16x32_bf16 v[12:15], v[100:103], v[132:135], v[12:15]
    ds_read_b64_tr_b16 v[144:145], v178 offset:8192
    ds_read_b64_tr_b16 v[146:147], v178 offset:9216
    v_mfma_f32_16x16x32_bf16 v[16:19], v[104:107], v[128:131], v[16:19]
    ds_read_b64_tr_b16 v[148:149], v179 offset:8192
    v_mfma_f32_16x16x32_bf16 v[20:23], v[104:107], v[132:135], v[20:23]
    ds_read_b64_tr_b16 v[150:151], v179 offset:9216
    ds_read_b64_tr_b16 v[152:153], v180 offset:8192
    v_mfma_f32_16x16x32_bf16 v[24:27], v[108:111], v[128:131], v[24:27]
    ds_read_b64_tr_b16 v[154:155], v180 offset:9216
    ds_read_b64_tr_b16 v[156:157], v181 offset:8192
    v_mfma_f32_16x16x32_bf16 v[28:31], v[108:111], v[132:135], v[28:31]
    ds_read_b64_tr_b16 v[158:159], v181 offset:9216
    ds_read_b64_tr_b16 v[160:161], v182 offset:8192
    v_mfma_f32_16x16x32_bf16 v[32:35], v[112:115], v[128:131], v[32:35]
    ds_read_b64_tr_b16 v[162:163], v182 offset:9216
    ds_read_b64_tr_b16 v[164:165], v183 offset:8192
    v_mfma_f32_16x16x32_bf16 v[36:39], v[112:115], v[132:135], v[36:39]
    ds_read_b64_tr_b16 v[166:167], v183 offset:9216
    v_mfma_f32_16x16x32_bf16 v[40:43], v[116:119], v[128:131], v[40:43]
    v_mfma_f32_16x16x32_bf16 v[44:47], v[116:119], v[132:135], v[44:47]
    v_mfma_f32_16x16x32_bf16 v[48:51], v[120:123], v[128:131], v[48:51]
    v_mfma_f32_16x16x32_bf16 v[52:55], v[120:123], v[132:135], v[52:55]
    v_mfma_f32_16x16x32_bf16 v[56:59], v[124:127], v[128:131], v[56:59]
    v_mfma_f32_16x16x32_bf16 v[60:63], v[124:127], v[132:135], v[60:63]
    s_waitcnt lgkmcnt(0)
    s_barrier
    v_mfma_f32_16x16x32_bf16 v[0:3], v[136:139], v[168:171], v[0:3]
    v_mfma_f32_16x16x32_bf16 v[4:7], v[136:139], v[172:175], v[4:7]
    s_add_u32 m0, s26, 18432
    s_mov_b32 s35, 0
    buffer_load_dwordx4 v213, s[12:15], s35 offen lds
    v_mfma_f32_16x16x32_bf16 v[8:11], v[140:143], v[168:171], v[8:11]
    v_mfma_f32_16x16x32_bf16 v[12:15], v[140:143], v[172:175], v[12:15]
    v_mfma_f32_16x16x32_bf16 v[16:19], v[144:147], v[168:171], v[16:19]
    s_add_u32 m0, s26, 27648
    s_mov_b32 s35, 8192
    buffer_load_dwordx4 v213, s[12:15], s35 offen lds
    v_mfma_f32_16x16x32_bf16 v[20:23], v[144:147], v[172:175], v[20:23]
    v_mfma_f32_16x16x32_bf16 v[24:27], v[148:151], v[168:171], v[24:27]
    v_mfma_f32_16x16x32_bf16 v[28:31], v[148:151], v[172:175], v[28:31]
    v_mfma_f32_16x16x32_bf16 v[32:35], v[152:155], v[168:171], v[32:35]
    s_add_u32 m0, s26, 36864
    s_mov_b32 s35, 16384
    buffer_load_dwordx4 v213, s[12:15], s35 offen lds
    v_mfma_f32_16x16x32_bf16 v[36:39], v[152:155], v[172:175], v[36:39]
    v_mfma_f32_16x16x32_bf16 v[40:43], v[156:159], v[168:171], v[40:43]
    v_mfma_f32_16x16x32_bf16 v[44:47], v[156:159], v[172:175], v[44:47]
    v_mfma_f32_16x16x32_bf16 v[48:51], v[160:163], v[168:171], v[48:51]
    s_add_u32 m0, s26, 46080
    s_mov_b32 s35, 24576
    buffer_load_dwordx4 v213, s[12:15], s35 offen lds
    v_mfma_f32_16x16x32_bf16 v[52:55], v[160:163], v[172:175], v[52:55]
    v_mfma_f32_16x16x32_bf16 v[56:59], v[164:167], v[168:171], v[56:59]
    v_mfma_f32_16x16x32_bf16 v[60:63], v[164:167], v[172:175], v[60:63]
    s_nop 7
    s_mov_b32 s33, 0x3e0293ee
    v_cvt_pk_bf16_f32 v216, v0, v1
    v_lshlrev_b32 v0, 16, v216
    v_and_b32 v1, 0xffff0000, v216
    v_mul_f32 v0, s33, v0
    v_mul_f32 v1, s33, v1
    v_cvt_pk_bf16_f32 v64, v0, v1
    v_cvt_pk_bf16_f32 v216, v2, v3
    v_lshlrev_b32 v2, 16, v216
    v_and_b32 v3, 0xffff0000, v216
    v_mul_f32 v2, s33, v2
    v_mul_f32 v3, s33, v3
    v_cvt_pk_bf16_f32 v65, v2, v3
    v_cvt_pk_bf16_f32 v216, v8, v9
    v_lshlrev_b32 v8, 16, v216
    v_and_b32 v9, 0xffff0000, v216
    v_mul_f32 v8, s33, v8
    v_mul_f32 v9, s33, v9
    v_cvt_pk_bf16_f32 v66, v8, v9
    v_cvt_pk_bf16_f32 v216, v10, v11
    v_lshlrev_b32 v10, 16, v216
    v_and_b32 v11, 0xffff0000, v216
    v_mul_f32 v10, s33, v10
    v_mul_f32 v11, s33, v11
    v_cvt_pk_bf16_f32 v67, v10, v11
    v_cvt_pk_bf16_f32 v216, v16, v17
    v_lshlrev_b32 v16, 16, v216
    v_and_b32 v17, 0xffff0000, v216
    v_mul_f32 v16, s33, v16
    v_mul_f32 v17, s33, v17
    v_cvt_pk_bf16_f32 v68, v16, v17
    v_cvt_pk_bf16_f32 v216, v18, v19
    v_lshlrev_b32 v18, 16, v216
    v_and_b32 v19, 0xffff0000, v216
    v_mul_f32 v18, s33, v18
    v_mul_f32 v19, s33, v19
    v_cvt_pk_bf16_f32 v69, v18, v19
    v_cvt_pk_bf16_f32 v216, v24, v25
    v_lshlrev_b32 v24, 16, v216
    v_and_b32 v25, 0xffff0000, v216
    v_mul_f32 v24, s33, v24
    v_mul_f32 v25, s33, v25
    v_cvt_pk_bf16_f32 v70, v24, v25
    v_cvt_pk_bf16_f32 v216, v26, v27
    v_lshlrev_b32 v26, 16, v216
    v_and_b32 v27, 0xffff0000, v216
    v_mul_f32 v26, s33, v26
    v_mul_f32 v27, s33, v27
    v_cvt_pk_bf16_f32 v71, v26, v27
    v_cvt_pk_bf16_f32 v216, v32, v33
    v_lshlrev_b32 v32, 16, v216
    v_and_b32 v33, 0xffff0000, v216
    v_mul_f32 v32, s33, v32
    v_mul_f32 v33, s33, v33
    v_cvt_pk_bf16_f32 v72, v32, v33
    v_cvt_pk_bf16_f32 v216, v34, v35
    v_lshlrev_b32 v34, 16, v216
    v_and_b32 v35, 0xffff0000, v216
    v_mul_f32 v34, s33, v34
    v_mul_f32 v35, s33, v35
    v_cvt_pk_bf16_f32 v73, v34, v35
    v_cvt_pk_bf16_f32 v216, v40, v41
    v_lshlrev_b32 v40, 16, v216
    v_and_b32 v41, 0xffff0000, v216
    v_mul_f32 v40, s33, v40
    v_mul_f32 v41, s33, v41
    v_cvt_pk_bf16_f32 v74, v40, v41
    v_cvt_pk_bf16_f32 v216, v42, v43
    v_lshlrev_b32 v42, 16, v216
    v_and_b32 v43, 0xffff0000, v216
    v_mul_f32 v42, s33, v42
    v_mul_f32 v43, s33, v43
    v_cvt_pk_bf16_f32 v75, v42, v43
    v_cvt_pk_bf16_f32 v216, v48, v49
    v_lshlrev_b32 v48, 16, v216
    v_and_b32 v49, 0xffff0000, v216
    v_mul_f32 v48, s33, v48
    v_mul_f32 v49, s33, v49
    v_cvt_pk_bf16_f32 v76, v48, v49
    v_cvt_pk_bf16_f32 v216, v50, v51
    v_lshlrev_b32 v50, 16, v216
    v_and_b32 v51, 0xffff0000, v216
    v_mul_f32 v50, s33, v50
    v_mul_f32 v51, s33, v51
    v_cvt_pk_bf16_f32 v77, v50, v51
    v_cvt_pk_bf16_f32 v216, v56, v57
    v_lshlrev_b32 v56, 16, v216
    v_and_b32 v57, 0xffff0000, v216
    v_mul_f32 v56, s33, v56
    v_mul_f32 v57, s33, v57
    v_cvt_pk_bf16_f32 v78, v56, v57
    v_cvt_pk_bf16_f32 v216, v58, v59
    v_lshlrev_b32 v58, 16, v216
    v_and_b32 v59, 0xffff0000, v216
    v_mul_f32 v58, s33, v58
    v_mul_f32 v59, s33, v59
    v_cvt_pk_bf16_f32 v79, v58, v59
    v_cvt_pk_bf16_f32 v216, v4, v5
    v_lshlrev_b32 v4, 16, v216
    v_and_b32 v5, 0xffff0000, v216
    v_mul_f32 v4, s33, v4
    v_mul_f32 v5, s33, v5
    v_cvt_pk_bf16_f32 v80, v4, v5
    v_cvt_pk_bf16_f32 v216, v6, v7
    v_lshlrev_b32 v6, 16, v216
    v_and_b32 v7, 0xffff0000, v216
    v_mul_f32 v6, s33, v6
    v_mul_f32 v7, s33, v7
    v_cvt_pk_bf16_f32 v81, v6, v7
    v_cvt_pk_bf16_f32 v216, v12, v13
    v_lshlrev_b32 v12, 16, v216
    v_and_b32 v13, 0xffff0000, v216
    v_mul_f32 v12, s33, v12
    v_mul_f32 v13, s33, v13
    v_cvt_pk_bf16_f32 v82, v12, v13
    v_cvt_pk_bf16_f32 v216, v14, v15
    v_lshlrev_b32 v14, 16, v216
    v_and_b32 v15, 0xffff0000, v216
    v_mul_f32 v14, s33, v14
    v_mul_f32 v15, s33, v15
    v_cvt_pk_bf16_f32 v83, v14, v15
    v_cvt_pk_bf16_f32 v216, v20, v21
    v_lshlrev_b32 v20, 16, v216
    v_and_b32 v21, 0xffff0000, v216
    v_mul_f32 v20, s33, v20
    v_mul_f32 v21, s33, v21
    v_cvt_pk_bf16_f32 v84, v20, v21
    v_cvt_pk_bf16_f32 v216, v22, v23
    v_lshlrev_b32 v22, 16, v216
    v_and_b32 v23, 0xffff0000, v216
    v_mul_f32 v22, s33, v22
    v_mul_f32 v23, s33, v23
    v_cvt_pk_bf16_f32 v85, v22, v23
    v_cvt_pk_bf16_f32 v216, v28, v29
    v_lshlrev_b32 v28, 16, v216
    v_and_b32 v29, 0xffff0000, v216
    v_mul_f32 v28, s33, v28
    v_mul_f32 v29, s33, v29
    v_cvt_pk_bf16_f32 v86, v28, v29
    v_cvt_pk_bf16_f32 v216, v30, v31
    v_lshlrev_b32 v30, 16, v216
    v_and_b32 v31, 0xffff0000, v216
    v_mul_f32 v30, s33, v30
    v_mul_f32 v31, s33, v31
    v_cvt_pk_bf16_f32 v87, v30, v31
    v_cvt_pk_bf16_f32 v216, v36, v37
    v_lshlrev_b32 v36, 16, v216
    v_and_b32 v37, 0xffff0000, v216
    v_mul_f32 v36, s33, v36
    v_mul_f32 v37, s33, v37
    v_cvt_pk_bf16_f32 v88, v36, v37
    v_cvt_pk_bf16_f32 v216, v38, v39
    v_lshlrev_b32 v38, 16, v216
    v_and_b32 v39, 0xffff0000, v216
    v_mul_f32 v38, s33, v38
    v_mul_f32 v39, s33, v39
    v_cvt_pk_bf16_f32 v89, v38, v39
    v_cvt_pk_bf16_f32 v216, v44, v45
    v_lshlrev_b32 v44, 16, v216
    v_and_b32 v45, 0xffff0000, v216
    v_mul_f32 v44, s33, v44
    v_mul_f32 v45, s33, v45
    v_cvt_pk_bf16_f32 v90, v44, v45
    v_cvt_pk_bf16_f32 v216, v46, v47
    v_lshlrev_b32 v46, 16, v216
    v_and_b32 v47, 0xffff0000, v216
    v_mul_f32 v46, s33, v46
    v_mul_f32 v47, s33, v47
    v_cvt_pk_bf16_f32 v91, v46, v47
    v_cvt_pk_bf16_f32 v216, v52, v53
    v_lshlrev_b32 v52, 16, v216
    v_and_b32 v53, 0xffff0000, v216
    v_mul_f32 v52, s33, v52
    v_mul_f32 v53, s33, v53
    v_cvt_pk_bf16_f32 v92, v52, v53
    v_cvt_pk_bf16_f32 v216, v54, v55
    v_lshlrev_b32 v54, 16, v216
    v_and_b32 v55, 0xffff0000, v216
    v_mul_f32 v54, s33, v54
    v_mul_f32 v55, s33, v55
    v_cvt_pk_bf16_f32 v93, v54, v55
    v_cvt_pk_bf16_f32 v216, v60, v61
    v_lshlrev_b32 v60, 16, v216
    v_and_b32 v61, 0xffff0000, v216
    v_mul_f32 v60, s33, v60
    v_mul_f32 v61, s33, v61
    v_cvt_pk_bf16_f32 v94, v60, v61
    v_cvt_pk_bf16_f32 v216, v62, v63
    v_lshlrev_b32 v62, 16, v216
    v_and_b32 v63, 0xffff0000, v216
    v_mul_f32 v62, s33, v62
    v_mul_f32 v63, s33, v63
    v_cvt_pk_bf16_f32 v95, v62, v63
    s_nop 1
    v_permlane32_swap_b32 v64, v66
    v_permlane32_swap_b32 v65, v67
    v_permlane32_swap_b32 v68, v70
    v_permlane32_swap_b32 v69, v71
    v_permlane32_swap_b32 v72, v74
    v_permlane32_swap_b32 v73, v75
    v_permlane32_swap_b32 v76, v78
    v_permlane32_swap_b32 v77, v79
    v_permlane32_swap_b32 v80, v82
    v_permlane32_swap_b32 v81, v83
    v_permlane32_swap_b32 v84, v86
    v_permlane32_swap_b32 v85, v87
    v_permlane32_swap_b32 v88, v90
    v_permlane32_swap_b32 v89, v91
    v_permlane32_swap_b32 v92, v94
    v_permlane32_swap_b32 v93, v95
    s_nop 1
    v_permlane16_swap_b32 v64, v66
    v_permlane16_swap_b32 v65, v67
    v_permlane16_swap_b32 v68, v70
    v_permlane16_swap_b32 v69, v71
    v_permlane16_swap_b32 v72, v74
    v_permlane16_swap_b32 v73, v75
    v_permlane16_swap_b32 v76, v78
    v_permlane16_swap_b32 v77, v79
    v_permlane16_swap_b32 v80, v82
    v_permlane16_swap_b32 v81, v83
    v_permlane16_swap_b32 v84, v86
    v_permlane16_swap_b32 v85, v87
    v_permlane16_swap_b32 v88, v90
    v_permlane16_swap_b32 v89, v91
    v_permlane16_swap_b32 v92, v94
    v_permlane16_swap_b32 v93, v95
    v_mov_b32 v0, 0
    v_mov_b32 v1, 0
    v_mov_b32 v2, 0
    v_mov_b32 v3, 0
    v_mov_b32 v4, 0
    v_mov_b32 v5, 0
    v_mov_b32 v6, 0
    v_mov_b32 v7, 0
    v_mov_b32 v8, 0
    v_mov_b32 v9, 0
    v_mov_b32 v10, 0
    v_mov_b32 v11, 0
    v_mov_b32 v12, 0
    v_mov_b32 v13, 0
    v_mov_b32 v14, 0
    v_mov_b32 v15, 0
    v_mov_b32 v16, 0
    v_mov_b32 v17, 0
    v_mov_b32 v18, 0
    v_mov_b32 v19, 0
    v_mov_b32 v20, 0
    v_mov_b32 v21, 0
    v_mov_b32 v22, 0
    v_mov_b32 v23, 0
    v_mov_b32 v24, 0
    v_mov_b32 v25, 0
    v_mov_b32 v26, 0
    v_mov_b32 v27, 0
    v_mov_b32 v28, 0
    v_mov_b32 v29, 0
    v_mov_b32 v30, 0
    v_mov_b32 v31, 0
    v_mov_b32 v32, 0
    v_mov_b32 v33, 0
    v_mov_b32 v34, 0
    v_mov_b32 v35, 0
    v_mov_b32 v36, 0
    v_mov_b32 v37, 0
    v_mov_b32 v38, 0
    v_mov_b32 v39, 0
    v_mov_b32 v40, 0
    v_mov_b32 v41, 0
    v_mov_b32 v42, 0
    v_mov_b32 v43, 0
    v_mov_b32 v44, 0
    v_mov_b32 v45, 0
    v_mov_b32 v46, 0
    v_mov_b32 v47, 0
    v_mov_b32 v48, 0
    v_mov_b32 v49, 0
    v_mov_b32 v50, 0
    v_mov_b32 v51, 0
    v_mov_b32 v52, 0
    v_mov_b32 v53, 0
    v_mov_b32 v54, 0
    v_mov_b32 v55, 0
    v_mov_b32 v56, 0
    v_mov_b32 v57, 0
    v_mov_b32 v58, 0
    v_mov_b32 v59, 0
    v_mov_b32 v60, 0
    v_mov_b32 v61, 0
    v_mov_b32 v62, 0
    v_mov_b32 v63, 0
    v_mov_b32 v144, 0
    v_mov_b32 v145, 0
    v_mov_b32 v146, 0
    v_mov_b32 v147, 0
    v_mov_b32 v148, 0
    v_mov_b32 v149, 0
    v_mov_b32 v150, 0
    v_mov_b32 v151, 0
    v_mov_b32 v198, 0
    v_mov_b32 v199, 0
    s_waitcnt vmcnt(8)
    s_barrier
    ds_read_b128 v[160:163], v200 offset:0
    ds_read_b128 v[164:167], v201 offset:0
    ds_read_b128 v[168:171], v202 offset:0
    ds_read_b128 v[172:175], v203 offset:0
    ds_read_b128 v[176:179], v200 offset:4096
    ds_read_b128 v[180:183], v201 offset:4096
    ds_read_b128 v[184:187], v202 offset:4096
    ds_read_b128 v[188:191], v203 offset:4096
    s_waitcnt lgkmcnt(7)
    v_mfma_f32_16x16x32_bf16 v[96:99], v[160:163], v[64:67], v[144:147]
    v_mfma_f32_16x16x32_bf16 v[104:107], v[160:163], v[80:83], v[148:151]
    ds_read_b128 v[160:163], v200 offset:8192
    s_waitcnt lgkmcnt(7)
    v_mfma_f32_16x16x32_bf16 v[96:99], v[164:167], v[68:71], v[96:99]
    v_mfma_f32_16x16x32_bf16 v[104:107], v[164:167], v[84:87], v[104:107]
    ds_read_b128 v[164:167], v201 offset:8192
    s_waitcnt lgkmcnt(7)
    v_mfma_f32_16x16x32_bf16 v[96:99], v[168:171], v[72:75], v[96:99]
    v_mfma_f32_16x16x32_bf16 v[104:107], v[168:171], v[88:91], v[104:107]
    ds_read_b128 v[168:171], v202 offset:8192
    s_waitcnt lgkmcnt(7)
    v_mfma_f32_16x16x32_bf16 v[96:99], v[172:175], v[76:79], v[96:99]
    v_mfma_f32_16x16x32_bf16 v[104:107], v[172:175], v[92:95], v[104:107]
    ds_read_b128 v[172:175], v203 offset:8192
    s_waitcnt lgkmcnt(7)
    v_mfma_f32_16x16x32_bf16 v[100:103], v[176:179], v[64:67], v[144:147]
    v_mfma_f32_16x16x32_bf16 v[108:111], v[176:179], v[80:83], v[148:151]
    ds_read_b128 v[176:179], v200 offset:12288
    s_waitcnt lgkmcnt(7)
    v_mfma_f32_16x16x32_bf16 v[100:103], v[180:183], v[68:71], v[100:103]
    v_mfma_f32_16x16x32_bf16 v[108:111], v[180:183], v[84:87], v[108:111]
    ds_read_b128 v[180:183], v201 offset:12288
    s_waitcnt lgkmcnt(7)
    v_mfma_f32_16x16x32_bf16 v[100:103], v[184:187], v[72:75], v[100:103]
    v_mfma_f32_16x16x32_bf16 v[108:111], v[184:187], v[88:91], v[108:111]
    ds_read_b128 v[184:187], v202 offset:12288
    s_waitcnt lgkmcnt(7)
    v_mfma_f32_16x16x32_bf16 v[100:103], v[188:191], v[76:79], v[100:103]
    v_mfma_f32_16x16x32_bf16 v[108:111], v[188:191], v[92:95], v[108:111]
    ds_read_b128 v[188:191], v203 offset:12288
    s_nop 7
    v_max3_f32 v216, v96, v97, v98
    v_max3_f32 v216, v216, v99, v100
    v_max3_f32 v216, v216, v101, v102
    v_max_f32 v216, v216, v103
    v_mov_b32 v217, v216
    s_nop 1
    v_permlane16_swap_b32 v217, v216
    v_max_f32 v216, v216, v217
    v_mov_b32 v217, v216
    s_nop 1
    v_permlane32_swap_b32 v217, v216
    v_max_f32 v216, v216, v217
    v_sub_f32 v96, v96, v216
    v_sub_f32 v97, v97, v216
    v_sub_f32 v98, v98, v216
    v_sub_f32 v99, v99, v216
    v_sub_f32 v100, v100, v216
    v_sub_f32 v101, v101, v216
    v_sub_f32 v102, v102, v216
    v_sub_f32 v103, v103, v216
    v_sub_f32 v144, 0, v216
    v_sub_f32 v145, 0, v216
    v_sub_f32 v146, 0, v216
    v_sub_f32 v147, 0, v216
    v_max3_f32 v216, v104, v105, v106
    v_max3_f32 v216, v216, v107, v108
    v_max3_f32 v216, v216, v109, v110
    v_max_f32 v216, v216, v111
    v_mov_b32 v217, v216
    s_nop 1
    v_permlane16_swap_b32 v217, v216
    v_max_f32 v216, v216, v217
    v_mov_b32 v217, v216
    s_nop 1
    v_permlane32_swap_b32 v217, v216
    v_max_f32 v216, v216, v217
    v_sub_f32 v104, v104, v216
    v_sub_f32 v105, v105, v216
    v_sub_f32 v106, v106, v216
    v_sub_f32 v107, v107, v216
    v_sub_f32 v108, v108, v216
    v_sub_f32 v109, v109, v216
    v_sub_f32 v110, v110, v216
    v_sub_f32 v111, v111, v216
    v_sub_f32 v148, 0, v216
    v_sub_f32 v149, 0, v216
    v_sub_f32 v150, 0, v216
    v_sub_f32 v151, 0, v216
    s_nop 1
    s_waitcnt lgkmcnt(7)
    v_mfma_f32_16x16x32_bf16 v[112:115], v[160:163], v[64:67], v[144:147]
    v_exp_f32 v192, v96
    v_exp_f32 v193, v97
    v_mfma_f32_16x16x32_bf16 v[120:123], v[160:163], v[80:83], v[148:151]
    s_waitcnt vmcnt(2)
    s_barrier
    ds_read_b128 v[160:163], v200 offset:16384
    v_exp_f32 v194, v98
    v_exp_f32 v195, v99
    s_waitcnt lgkmcnt(7)
    v_mfma_f32_16x16x32_bf16 v[112:115], v[164:167], v[68:71], v[112:115]
    v_add_f32 v196, v192, v193
    v_cvt_pk_bf16_f32 v128, v192, v193
    v_exp_f32 v192, v100
    s_add_u32 m0, s25, 49152
    s_add_u32 s35, s24, 0
    buffer_load_dwordx4 v212, s[8:11], s35 offen lds
    v_mfma_f32_16x16x32_bf16 v[120:123], v[164:167], v[84:87], v[120:123]
    ds_read_b128 v[164:167], v201 offset:16384
    v_exp_f32 v193, v101
    v_add_f32 v196, v196, v194
    v_add_f32 v196, v196, v195
    s_waitcnt lgkmcnt(7)
    v_mfma_f32_16x16x32_bf16 v[112:115], v[168:171], v[72:75], v[112:115]
    v_cvt_pk_bf16_f32 v129, v194, v195
    v_exp_f32 v194, v102
    s_add_u32 m0, s25, 57344
    s_add_u32 s35, s24, 8192
    buffer_load_dwordx4 v212, s[8:11], s35 offen lds
    v_mfma_f32_16x16x32_bf16 v[120:123], v[168:171], v[88:91], v[120:123]
    ds_read_b128 v[168:171], v202 offset:16384
    v_exp_f32 v195, v103
    v_add_f32 v196, v196, v192
    v_add_f32 v196, v196, v193
    s_waitcnt lgkmcnt(7)
    v_mfma_f32_16x16x32_bf16 v[112:115], v[172:175], v[76:79], v[112:115]
    v_cvt_pk_bf16_f32 v130, v192, v193
    v_exp_f32 v192, v104
    s_add_u32 m0, s26, 55296
    s_sub_u32 s35, s24, 16384
    buffer_load_dwordx4 v213, s[12:15], s35 offen lds
    v_mfma_f32_16x16x32_bf16 v[120:123], v[172:175], v[92:95], v[120:123]
    ds_read_b128 v[172:175], v203 offset:16384
    v_exp_f32 v193, v105
    s_waitcnt lgkmcnt(7)
    v_mfma_f32_16x16x32_bf16 v[116:119], v[176:179], v[64:67], v[144:147]
    v_add_f32 v196, v196, v194
    v_add_f32 v196, v196, v195
    v_cvt_pk_bf16_f32 v131, v194, v195
    s_add_u32 m0, s26, 64512
    s_sub_u32 s35, s24, 8192
    buffer_load_dwordx4 v213, s[12:15], s35 offen lds
    v_mfma_f32_16x16x32_bf16 v[124:127], v[176:179], v[80:83], v[148:151]
    ds_read_b128 v[176:179], v200 offset:20480
    v_exp_f32 v194, v106
    v_exp_f32 v195, v107
    s_waitcnt lgkmcnt(7)
    v_mfma_f32_16x16x32_bf16 v[116:119], v[180:183], v[68:71], v[116:119]
    v_add_f32 v197, v192, v193
    v_cvt_pk_bf16_f32 v132, v192, v193
    v_exp_f32 v192, v108
    s_add_u32 s24, s24, 16384
    v_mfma_f32_16x16x32_bf16 v[124:127], v[180:183], v[84:87], v[124:127]
    ds_read_b128 v[180:183], v201 offset:20480
    v_exp_f32 v193, v109
    v_add_f32 v197, v197, v194
    v_add_f32 v197, v197, v195
    s_waitcnt lgkmcnt(7)
    v_mfma_f32_16x16x32_bf16 v[116:119], v[184:187], v[72:75], v[116:119]
    v_cvt_pk_bf16_f32 v133, v194, v195
    v_exp_f32 v194, v110
    buffer_load_dwordx4 v[224:227], v221, s[44:47], 0 offen offset:0
    v_mfma_f32_16x16x32_bf16 v[124:127], v[184:187], v[88:91], v[124:127]
    ds_read_b128 v[184:187], v202 offset:20480
    v_exp_f32 v195, v111
    v_add_f32 v197, v197, v192
    v_add_f32 v197, v197, v193
    s_waitcnt lgkmcnt(7)
    v_mfma_f32_16x16x32_bf16 v[116:119], v[188:191], v[76:79], v[116:119]
    v_cvt_pk_bf16_f32 v134, v192, v193
    v_add_f32 v197, v197, v194
    v_add_f32 v197, v197, v195
    buffer_load_dwordx4 v[224:227], v222, s[48:51], 0 offen offset:0
    v_mfma_f32_16x16x32_bf16 v[124:127], v[188:191], v[92:95], v[124:127]
    ds_read_b128 v[188:191], v203 offset:20480
    v_cvt_pk_bf16_f32 v135, v194, v195
    v_max_f32 v192, v196, v197
    v_cmp_lt_f32 vcc, s36, v192
    s_cbranch_vccz L_at_ok0
    s_call_b64 s[38:39], L_at_rare0
L_at_ok0:
    v_add_f32 v198, v198, v196
    v_add_f32 v199, v199, v197
    s_waitcnt lgkmcnt(7)
    v_mfma_f32_16x16x32_bf16 v[96:99], v[160:163], v[64:67], v[144:147]
    v_exp_f32 v192, v112
    v_mfma_f32_16x16x32_bf16 v[104:107], v[160:163], v[80:83], v[148:151]
    ds_read_b64_tr_b16 v[160:161], v204 offset:18432
    ds_read_b64_tr_b16 v[162:163], v204 offset:23040
    v_exp_f32 v193, v113
    s_waitcnt lgkmcnt(8)
    v_mfma_f32_16x16x32_bf16 v[96:99], v[164:167], v[68:71], v[96:99]
    v_exp_f32 v194, v114
    v_mfma_f32_16x16x32_bf16 v[104:107], v[164:167], v[84:87], v[104:107]
    ds_read_b64_tr_b16 v[164:165], v205 offset:18432
    ds_read_b64_tr_b16 v[166:167], v205 offset:23040
    v_exp_f32 v195, v115
    s_waitcnt lgkmcnt(9)
    v_mfma_f32_16x16x32_bf16 v[96:99], v[168:171], v[72:75], v[96:99]
    v_add_f32 v196, v192, v193
    v_cvt_pk_bf16_f32 v136, v192, v193
    v_mfma_f32_16x16x32_bf16 v[104:107], v[168:171], v[88:91], v[104:107]
    ds_read_b64_tr_b16 v[168:169], v206 offset:18432
    ds_read_b64_tr_b16 v[170:171], v206 offset:23040
    v_exp_f32 v192, v116
    s_waitcnt lgkmcnt(10)
    v_mfma_f32_16x16x32_bf16 v[96:99], v[172:175], v[76:79], v[96:99]
    v_exp_f32 v193, v117
    v_mfma_f32_16x16x32_bf16 v[104:107], v[172:175], v[92:95], v[104:107]
    ds_read_b64_tr_b16 v[172:173], v207 offset:18432
    ds_read_b64_tr_b16 v[174:175], v207 offset:23040
    v_add_f32 v196, v196, v194
    v_add_f32 v196, v196, v195
    s_waitcnt lgkmcnt(11)
    v_mfma_f32_16x16x32_bf16 v[100:103], v[176:179], v[64:67], v[144:147]
    v_cvt_pk_bf16_f32 v137, v194, v195
    v_mfma_f32_16x16x32_bf16 v[108:111], v[176:179], v[80:83], v[148:151]
    ds_read_b64_tr_b16 v[176:177], v204 offset:18560
    ds_read_b64_tr_b16 v[178:179], v204 offset:23168
    v_exp_f32 v194, v118
    s_waitcnt lgkmcnt(12)
    v_mfma_f32_16x16x32_bf16 v[100:103], v[180:183], v[68:71], v[100:103]
    v_exp_f32 v195, v119
    v_mfma_f32_16x16x32_bf16 v[108:111], v[180:183], v[84:87], v[108:111]
    ds_read_b64_tr_b16 v[180:181], v205 offset:18560
    ds_read_b64_tr_b16 v[182:183], v205 offset:23168
    v_add_f32 v196, v196, v192
    v_add_f32 v196, v196, v193
    s_waitcnt lgkmcnt(13)
    v_mfma_f32_16x16x32_bf16 v[100:103], v[184:187], v[72:75], v[100:103]
    v_cvt_pk_bf16_f32 v138, v192, v193
    v_mfma_f32_16x16x32_bf16 v[108:111], v[184:187], v[88:91], v[108:111]
    ds_read_b64_tr_b16 v[184:185], v206 offset:18560
    ds_read_b64_tr_b16 v[186:187], v206 offset:23168
    v_exp_f32 v192, v120
    s_waitcnt lgkmcnt(14)
    v_mfma_f32_16x16x32_bf16 v[100:103], v[188:191], v[76:79], v[100:103]
    v_exp_f32 v193, v121
    v_mfma_f32_16x16x32_bf16 v[108:111], v[188:191], v[92:95], v[108:111]
    ds_read_b64_tr_b16 v[188:189], v207 offset:18560
    ds_read_b64_tr_b16 v[190:191], v207 offset:23168
    s_waitcnt lgkmcnt(14)
    v_mfma_f32_16x16x32_bf16 v[0:3], v[160:163], v[128:131], v[0:3]
    v_add_f32 v196, v196, v194
    v_add_f32 v196, v196, v195
    v_mfma_f32_16x16x32_bf16 v[4:7], v[160:163], v[132:135], v[4:7]
    ds_read_b128 v[160:163], v200 offset:24576
    v_cvt_pk_bf16_f32 v139, v194, v195
    s_waitcnt lgkmcnt(13)
    v_mfma_f32_16x16x32_bf16 v[8:11], v[164:167], v[128:131], v[8:11]
    v_exp_f32 v194, v122
    v_mfma_f32_16x16x32_bf16 v[12:15], v[164:167], v[132:135], v[12:15]
    ds_read_b128 v[164:167], v201 offset:24576
    v_exp_f32 v195, v123
    s_waitcnt lgkmcnt(12)
    v_mfma_f32_16x16x32_bf16 v[16:19], v[168:171], v[128:131], v[16:19]
    v_add_f32 v197, v192, v193
    v_cvt_pk_bf16_f32 v140, v192, v193
    v_mfma_f32_16x16x32_bf16 v[20:23], v[168:171], v[132:135], v[20:23]
    ds_read_b128 v[168:171], v202 offset:24576
    v_exp_f32 v192, v124
    s_waitcnt lgkmcnt(11)
    v_mfma_f32_16x16x32_bf16 v[24:27], v[172:175], v[128:131], v[24:27]
    v_exp_f32 v193, v125
    v_mfma_f32_16x16x32_bf16 v[28:31], v[172:175], v[132:135], v[28:31]
    ds_read_b128 v[172:175], v203 offset:24576
    v_add_f32 v197, v197, v194
    v_add_f32 v197, v197, v195
    s_waitcnt lgkmcnt(10)
    v_mfma_f32_16x16x32_bf16 v[32:35], v[176:179], v[128:131], v[32:35]
    v_cvt_pk_bf16_f32 v141, v194, v195
    v_mfma_f32_16x16x32_bf16 v[36:39], v[176:179], v[132:135], v[36:39]
    ds_read_b128 v[176:179], v200 offset:28672
    v_exp_f32 v194, v126
    s_waitcnt lgkmcnt(9)
    v_mfma_f32_16x16x32_bf16 v[40:43], v[180:183], v[128:131], v[40:43]
    v_exp_f32 v195, v127
    v_mfma_f32_16x16x32_bf16 v[44:47], v[180:183], v[132:135], v[44:47]
    ds_read_b128 v[180:183], v201 offset:28672
    v_add_f32 v197, v197, v192
    v_add_f32 v197, v197, v193
    s_waitcnt lgkmcnt(8)
    v_mfma_f32_16x16x32_bf16 v[48:51], v[184:187], v[128:131], v[48:51]
    v_cvt_pk_bf16_f32 v142, v192, v193
    v_mfma_f32_16x16x32_bf16 v[52:55], v[184:187], v[132:135], v[52:55]
    ds_read_b128 v[184:187], v202 offset:28672
    v_add_f32 v197, v197, v194
    v_add_f32 v197, v197, v195
    s_waitcnt lgkmcnt(7)
    v_mfma_f32_16x16x32_bf16 v[56:59], v[188:191], v[128:131], v[56:59]
    v_cvt_pk_bf16_f32 v143, v194, v195
    v_mfma_f32_16x16x32_bf16 v[60:63], v[188:191], v[132:135], v[60:63]
    ds_read_b128 v[188:191], v203 offset:28672
    v_max_f32 v192, v196, v197
    v_cmp_lt_f32 vcc, s36, v192
    s_cbranch_vccz L_at_ok1
    s_call_b64 s[38:39], L_at_rare1
L_at_ok1:
    v_add_f32 v198, v198, v196
    v_add_f32 v199, v199, v197
    s_waitcnt lgkmcnt(7)
    v_mfma_f32_16x16x32_bf16 v[112:115], v[160:163], v[64:67], v[144:147]
    v_exp_f32 v192, v96
    v_mfma_f32_16x16x32_bf16 v[120:123], v[160:163], v[80:83], v[148:151]
    ds_read_b64_tr_b16 v[160:161], v204 offset:27648
    ds_read_b64_tr_b16 v[162:163], v204 offset:32256
    v_exp_f32 v193, v97
    s_waitcnt lgkmcnt(8)
    v_mfma_f32_16x16x32_bf16 v[112:115], v[164:167], v[68:71], v[112:115]
    v_exp_f32 v194, v98
    v_mfma_f32_16x16x32_bf16 v[120:123], v[164:167], v[84:87], v[120:123]
    ds_read_b64_tr_b16 v[164:165], v205 offset:27648
    ds_read_b64_tr_b16 v[166:167], v205 offset:32256
    v_exp_f32 v195, v99
    s_waitcnt lgkmcnt(9)
    v_mfma_f32_16x16x32_bf16 v[112:115], v[168:171], v[72:75], v[112:115]
    v_add_f32 v196, v192, v193
    v_cvt_pk_bf16_f32 v128, v192, v193
    v_mfma_f32_16x16x32_bf16 v[120:123], v[168:171], v[88:91], v[120:123]
    ds_read_b64_tr_b16 v[168:169], v206 offset:27648
    ds_read_b64_tr_b16 v[170:171], v206 offset:32256
    v_exp_f32 v192, v100
    s_waitcnt lgkmcnt(10)
    v_mfma_f32_16x16x32_bf16 v[112:115], v[172:175], v[76:79], v[112:115]
    v_exp_f32 v193, v101
    v_mfma_f32_16x16x32_bf16 v[120:123], v[172:175], v[92:95], v[120:123]
    ds_read_b64_tr_b16 v[172:173], v207 offset:27648
    ds_read_b64_tr_b16 v[174:175], v207 offset:32256
    v_add_f32 v196, v196, v194
    v_add_f32 v196, v196, v195
    s_waitcnt lgkmcnt(11)
    v_mfma_f32_16x16x32_bf16 v[116:119], v[176:179], v[64:67], v[144:147]
    v_cvt_pk_bf16_f32 v129, v194, v195
    v_mfma_f32_16x16x32_bf16 v[124:127], v[176:179], v[80:83], v[148:151]
    ds_read_b64_tr_b16 v[176:177], v204 offset:27776
    ds_read_b64_tr_b16 v[178:179], v204 offset:32384
    v_exp_f32 v194, v102
    s_waitcnt lgkmcnt(12)
    v_mfma_f32_16x16x32_bf16 v[116:119], v[180:183], v[68:71], v[116:119]
    v_exp_f32 v195, v103
    v_mfma_f32_16x16x32_bf16 v[124:127], v[180:183], v[84:87], v[124:127]
    ds_read_b64_tr_b16 v[180:181], v205 offset:27776
    ds_read_b64_tr_b16 v[182:183], v205 offset:32384
    v_add_f32 v196, v196, v192
    v_add_f32 v196, v196, v193
    s_waitcnt lgkmcnt(13)
    v_mfma_f32_16x16x32_bf16 v[116:119], v[184:187], v[72:75], v[116:119]
    v_cvt_pk_bf16_f32 v130, v192, v193
    v_mfma_f32_16x16x32_bf16 v[124:127], v[184:187], v[88:91], v[124:127]
    ds_read_b64_tr_b16 v[184:185], v206 offset:27776
    ds_read_b64_tr_b16 v[186:187], v206 offset:32384
    v_exp_f32 v192, v104
    s_waitcnt lgkmcnt(14)
    v_mfma_f32_16x16x32_bf16 v[116:119], v[188:191], v[76:79], v[116:119]
    v_exp_f32 v193, v105
    v_mfma_f32_16x16x32_bf16 v[124:127], v[188:191], v[92:95], v[124:127]
    ds_read_b64_tr_b16 v[188:189], v207 offset:27776
    ds_read_b64_tr_b16 v[190:191], v207 offset:32384
    s_waitcnt lgkmcnt(14)
    v_mfma_f32_16x16x32_bf16 v[0:3], v[160:163], v[136:139], v[0:3]
    v_add_f32 v196, v196, v194
    v_add_f32 v196, v196, v195
    v_mfma_f32_16x16x32_bf16 v[4:7], v[160:163], v[140:143], v[4:7]
    s_waitcnt vmcnt(4)
    s_barrier
    ds_read_b128 v[160:163], v200 offset:32768
    v_cvt_pk_bf16_f32 v131, v194, v195
    s_waitcnt lgkmcnt(13)
    v_mfma_f32_16x16x32_bf16 v[8:11], v[164:167], v[136:139], v[8:11]
    v_exp_f32 v194, v106
    s_add_u32 m0, s25, 0
    s_add_u32 s35, s24, 0
    buffer_load_dwordx4 v212, s[8:11], s35 offen lds
    v_mfma_f32_16x16x32_bf16 v[12:15], v[164:167], v[140:143], v[12:15]
    ds_read_b128 v[164:167], v201 offset:32768
    v_exp_f32 v195, v107
    s_waitcnt lgkmcnt(12)
    v_mfma_f32_16x16x32_bf16 v[16:19], v[168:171], v[136:139], v[16:19]
    v_add_f32 v197, v192, v193
    v_cvt_pk_bf16_f32 v132, v192, v193
    s_add_u32 m0, s25, 8192
    s_add_u32 s35, s24, 8192
    buffer_load_dwordx4 v212, s[8:11], s35 offen lds
    v_mfma_f32_16x16x32_bf16 v[20:23], v[168:171], v[140:143], v[20:23]
    ds_read_b128 v[168:171], v202 offset:32768
    v_exp_f32 v192, v108
    s_waitcnt lgkmcnt(11)
    v_mfma_f32_16x16x32_bf16 v[24:27], v[172:175], v[136:139], v[24:27]
    v_exp_f32 v193, v109
    s_add_u32 m0, s26, 0
    s_sub_u32 s35, s24, 16384
    buffer_load_dwordx4 v213, s[12:15], s35 offen lds
    v_mfma_f32_16x16x32_bf16 v[28:31], v[172:175], v[140:143], v[28:31]
    ds_read_b128 v[172:175], v203 offset:32768
    v_add_f32 v197, v197, v194
    v_add_f32 v197, v197, v195
    s_waitcnt lgkmcnt(10)
    v_mfma_f32_16x16x32_bf16 v[32:35], v[176:179], v[136:139], v[32:35]
    v_cvt_pk_bf16_f32 v133, v194, v195
    s_add_u32 m0, s26, 9216
    s_sub_u32 s35, s24, 8192
    buffer_load_dwordx4 v213, s[12:15], s35 offen lds
    v_mfma_f32_16x16x32_bf16 v[36:39], v[176:179], v[140:143], v[36:39]
    ds_read_b128 v[176:179], v200 offset:36864
    v_exp_f32 v194, v110
    s_waitcnt lgkmcnt(9)
    v_mfma_f32_16x16x32_bf16 v[40:43], v[180:183], v[136:139], v[40:43]
    v_exp_f32 v195, v111
    s_add_u32 s24, s24, 16384
    v_mfma_f32_16x16x32_bf16 v[44:47], v[180:183], v[140:143], v[44:47]
    ds_read_b128 v[180:183], v201 offset:36864
    v_add_f32 v197, v197, v192
    v_add_f32 v197, v197, v193
    s_waitcnt lgkmcnt(8)
    v_mfma_f32_16x16x32_bf16 v[48:51], v[184:187], v[136:139], v[48:51]
    v_cvt_pk_bf16_f32 v134, v192, v193
    buffer_load_dwordx4 v[224:227], v221, s[44:47], 0 offen offset:1024
    v_mfma_f32_16x16x32_bf16 v[52:55], v[184:187], v[140:143], v[52:55]
    ds_read_b128 v[184:187], v202 offset:36864
    v_add_f32 v197, v197, v194
    v_add_f32 v197, v197, v195
    s_waitcnt lgkmcnt(7)
    v_mfma_f32_16x16x32_bf16 v[56:59], v[188:191], v[136:139], v[56:59]
    v_cvt_pk_bf16_f32 v135, v194, v195
    buffer_load_dwordx4 v[224:227], v222, s[48:51], 0 offen offset:1024
    v_mfma_f32_16x16x32_bf16 v[60:63], v[188:191], v[140:143], v[60:63]
    ds_read_b128 v[188:191], v203 offset:36864
    v_max_f32 v192, v196, v197
    v_cmp_lt_f32 vcc, s36, v192
    s_cbranch_vccz L_at_ok2
    s_call_b64 s[38:39], L_at_rare0
L_at_ok2:
    v_add_f32 v198, v198, v196
    v_add_f32 v199, v199, v197
    s_waitcnt lgkmcnt(7)
    v_mfma_f32_16x16x32_bf16 v[96:99], v[160:163], v[64:67], v[144:147]
    v_exp_f32 v192, v112
    v_mfma_f32_16x16x32_bf16 v[104:107], v[160:163], v[80:83], v[148:151]
    ds_read_b64_tr_b16 v[160:161], v208 offset:0
    ds_read_b64_tr_b16 v[162:163], v208 offset:4608
    v_exp_f32 v193, v113
    s_waitcnt lgkmcnt(8)
    v_mfma_f32_16x16x32_bf16 v[96:99], v[164:167], v[68:71], v[96:99]
    v_exp_f32 v194, v114
    v_mfma_f32_16x16x32_bf16 v[104:107], v[164:167], v[84:87], v[104:107]
    ds_read_b64_tr_b16 v[164:165], v209 offset:0
    ds_read_b64_tr_b16 v[166:167], v209 offset:4608
    v_exp_f32 v195, v115
    s_waitcnt lgkmcnt(9)
    v_mfma_f32_16x16x32_bf16 v[96:99], v[168:171], v[72:75], v[96:99]
    v_add_f32 v196, v192, v193
    v_cvt_pk_bf16_f32 v136, v192, v193
    v_mfma_f32_16x16x32_bf16 v[104:107], v[168:171], v[88:91], v[104:107]
    ds_read_b64_tr_b16 v[168:169], v210 offset:0
    ds_read_b64_tr_b16 v[170:171], v210 offset:4608
    v_exp_f32 v192, v116
    s_waitcnt lgkmcnt(10)
    v_mfma_f32_16x16x32_bf16 v[96:99], v[172:175], v[76:79], v[96:99]
    v_exp_f32 v193, v117
    v_mfma_f32_16x16x32_bf16 v[104:107], v[172:175], v[92:95], v[104:107]
    ds_read_b64_tr_b16 v[172:173], v211 offset:0
    ds_read_b64_tr_b16 v[174:175], v211 offset:4608
    v_add_f32 v196, v196, v194
    v_add_f32 v196, v196, v195
    s_waitcnt lgkmcnt(11)
    v_mfma_f32_16x16x32_bf16 v[100:103], v[176:179], v[64:67], v[144:147]
    v_cvt_pk_bf16_f32 v137, v194, v195
    v_mfma_f32_16x16x32_bf16 v[108:111], v[176:179], v[80:83], v[148:151]
    ds_read_b64_tr_b16 v[176:177], v208 offset:128
    ds_read_b64_tr_b16 v[178:179], v208 offset:4736
    v_exp_f32 v194, v118
    s_waitcnt lgkmcnt(12)
    v_mfma_f32_16x16x32_bf16 v[100:103], v[180:183], v[68:71], v[100:103]
    v_exp_f32 v195, v119
    v_mfma_f32_16x16x32_bf16 v[108:111], v[180:183], v[84:87], v[108:111]
    ds_read_b64_tr_b16 v[180:181], v209 offset:128
    ds_read_b64_tr_b16 v[182:183], v209 offset:4736
    v_add_f32 v196, v196, v192
    v_add_f32 v196, v196, v193
    s_waitcnt lgkmcnt(13)
    v_mfma_f32_16x16x32_bf16 v[100:103], v[184:187], v[72:75], v[100:103]
    v_cvt_pk_bf16_f32 v138, v192, v193
    v_mfma_f32_16x16x32_bf16 v[108:111], v[184:187], v[88:91], v[108:111]
    ds_read_b64_tr_b16 v[184:185], v210 offset:128
    ds_read_b64_tr_b16 v[186:187], v210 offset:4736
    v_exp_f32 v192, v120
    s_waitcnt lgkmcnt(14)
    v_mfma_f32_16x16x32_bf16 v[100:103], v[188:191], v[76:79], v[100:103]
    v_exp_f32 v193, v121
    v_mfma_f32_16x16x32_bf16 v[108:111], v[188:191], v[92:95], v[108:111]
    ds_read_b64_tr_b16 v[188:189], v211 offset:128
    ds_read_b64_tr_b16 v[190:191], v211 offset:4736
    s_waitcnt lgkmcnt(14)
    v_mfma_f32_16x16x32_bf16 v[0:3], v[160:163], v[128:131], v[0:3]
    v_add_f32 v196, v196, v194
    v_add_f32 v196, v196, v195
    v_mfma_f32_16x16x32_bf16 v[4:7], v[160:163], v[132:135], v[4:7]
    ds_read_b128 v[160:163], v200 offset:40960
    v_cvt_pk_bf16_f32 v139, v194, v195
    s_waitcnt lgkmcnt(13)
    v_mfma_f32_16x16x32_bf16 v[8:11], v[164:167], v[128:131], v[8:11]
    v_exp_f32 v194, v122
    v_mfma_f32_16x16x32_bf16 v[12:15], v[164:167], v[132:135], v[12:15]
    ds_read_b128 v[164:167], v201 offset:40960
    v_exp_f32 v195, v123
    s_waitcnt lgkmcnt(12)
    v_mfma_f32_16x16x32_bf16 v[16:19], v[168:171], v[128:131], v[16:19]
    v_add_f32 v197, v192, v193
    v_cvt_pk_bf16_f32 v140, v192, v193
    v_mfma_f32_16x16x32_bf16 v[20:23], v[168:171], v[132:135], v[20:23]
    ds_read_b128 v[168:171], v202 offset:40960
    v_exp_f32 v192, v124
    s_waitcnt lgkmcnt(11)
    v_mfma_f32_16x16x32_bf16 v[24:27], v[172:175], v[128:131], v[24:27]
    v_exp_f32 v193, v125
    v_mfma_f32_16x16x32_bf16 v[28:31], v[172:175], v[132:135], v[28:31]
    ds_read_b128 v[172:175], v203 offset:40960
    v_add_f32 v197, v197, v194
    v_add_f32 v197, v197, v195
    s_waitcnt lgkmcnt(10)
    v_mfma_f32_16x16x32_bf16 v[32:35], v[176:179], v[128:131], v[32:35]
    v_cvt_pk_bf16_f32 v141, v194, v195
    v_mfma_f32_16x16x32_bf16 v[36:39], v[176:179], v[132:135], v[36:39]
    ds_read_b128 v[176:179], v200 offset:45056
    v_exp_f32 v194, v126
    s_waitcnt lgkmcnt(9)
    v_mfma_f32_16x16x32_bf16 v[40:43], v[180:183], v[128:131], v[40:43]
    v_exp_f32 v195, v127
    v_mfma_f32_16x16x32_bf16 v[44:47], v[180:183], v[132:135], v[44:47]
    ds_read_b128 v[180:183], v201 offset:45056
    v_add_f32 v197, v197, v192
    v_add_f32 v197, v197, v193
    s_waitcnt lgkmcnt(8)
    v_mfma_f32_16x16x32_bf16 v[48:51], v[184:187], v[128:131], v[48:51]
    v_cvt_pk_bf16_f32 v142, v192, v193
    v_mfma_f32_16x16x32_bf16 v[52:55], v[184:187], v[132:135], v[52:55]
    ds_read_b128 v[184:187], v202 offset:45056
    v_add_f32 v197, v197, v194
    v_add_f32 v197, v197, v195
    s_waitcnt lgkmcnt(7)
    v_mfma_f32_16x16x32_bf16 v[56:59], v[188:191], v[128:131], v[56:59]
    v_cvt_pk_bf16_f32 v143, v194, v195
    v_mfma_f32_16x16x32_bf16 v[60:63], v[188:191], v[132:135], v[60:63]
    ds_read_b128 v[188:191], v203 offset:45056
    v_max_f32 v192, v196, v197
    v_cmp_lt_f32 vcc, s36, v192
    s_cbranch_vccz L_at_ok3
    s_call_b64 s[38:39], L_at_rare1
L_at_ok3:
    v_add_f32 v198, v198, v196
    v_add_f32 v199, v199, v197
    s_waitcnt lgkmcnt(7)
    v_mfma_f32_16x16x32_bf16 v[112:115], v[160:163], v[64:67], v[144:147]
    v_exp_f32 v192, v96
    v_mfma_f32_16x16x32_bf16 v[120:123], v[160:163], v[80:83], v[148:151]
    ds_read_b64_tr_b16 v[160:161], v208 offset:9216
    ds_read_b64_tr_b16 v[162:163], v208 offset:13824
    v_exp_f32 v193, v97
    s_waitcnt lgkmcnt(8)
    v_mfma_f32_16x16x32_bf16 v[112:115], v[164:167], v[68:71], v[112:115]
    v_exp_f32 v194, v98
    v_mfma_f32_16x16x32_bf16 v[120:123], v[164:167], v[84:87], v[120:123]
    ds_read_b64_tr_b16 v[164:165], v209 offset:9216
    ds_read_b64_tr_b16 v[166:167], v209 offset:13824
    v_exp_f32 v195, v99
    s_waitcnt lgkmcnt(9)
    v_mfma_f32_16x16x32_bf16 v[112:115], v[168:171], v[72:75], v[112:115]
    v_add_f32 v196, v192, v193
    v_cvt_pk_bf16_f32 v128, v192, v193
    v_mfma_f32_16x16x32_bf16 v[120:123], v[168:171], v[88:91], v[120:123]
    ds_read_b64_tr_b16 v[168:169], v210 offset:9216
    ds_read_b64_tr_b16 v[170:171], v210 offset:13824
    v_exp_f32 v192, v100
    s_waitcnt lgkmcnt(10)
    v_mfma_f32_16x16x32_bf16 v[112:115], v[172:175], v[76:79], v[112:115]
    v_exp_f32 v193, v101
    v_mfma_f32_16x16x32_bf16 v[120:123], v[172:175], v[92:95], v[120:123]
    ds_read_b64_tr_b16 v[172:173], v211 offset:9216
    ds_read_b64_tr_b16 v[174:175], v211 offset:13824
    v_add_f32 v196, v196, v194
    v_add_f32 v196, v196, v195
    s_waitcnt lgkmcnt(11)
    v_mfma_f32_16x16x32_bf16 v[116:119], v[176:179], v[64:67], v[144:147]
    v_cvt_pk_bf16_f32 v129, v194, v195
    v_mfma_f32_16x16x32_bf16 v[124:127], v[176:179], v[80:83], v[148:151]
    ds_read_b64_tr_b16 v[176:177], v208 offset:9344
    ds_read_b64_tr_b16 v[178:179], v208 offset:13952
    v_exp_f32 v194, v102
    s_waitcnt lgkmcnt(12)
    v_mfma_f32_16x16x32_bf16 v[116:119], v[180:183], v[68:71], v[116:119]
    v_exp_f32 v195, v103
    v_mfma_f32_16x16x32_bf16 v[124:127], v[180:183], v[84:87], v[124:127]
    ds_read_b64_tr_b16 v[180:181], v209 offset:9344
    ds_read_b64_tr_b16 v[182:183], v209 offset:13952
    v_add_f32 v196, v196, v192
    v_add_f32 v196, v196, v193
    s_waitcnt lgkmcnt(13)
    v_mfma_f32_16x16x32_bf16 v[116:119], v[184:187], v[72:75], v[116:119]
    v_cvt_pk_bf16_f32 v130, v192, v193
    v_mfma_f32_16x16x32_bf16 v[124:127], v[184:187], v[88:91], v[124:127]
    ds_read_b64_tr_b16 v[184:185], v210 offset:9344
    ds_read_b64_tr_b16 v[186:187], v210 offset:13952
    v_exp_f32 v192, v104
    s_waitcnt lgkmcnt(14)
    v_mfma_f32_16x16x32_bf16 v[116:119], v[188:191], v[76:79], v[116:119]
    v_exp_f32 v193, v105
    v_mfma_f32_16x16x32_bf16 v[124:127], v[188:191], v[92:95], v[124:127]
    ds_read_b64_tr_b16 v[188:189], v211 offset:9344
    ds_read_b64_tr_b16 v[190:191], v211 offset:13952
    s_waitcnt lgkmcnt(14)
    v_mfma_f32_16x16x32_bf16 v[0:3], v[160:163], v[136:139], v[0:3]
    v_add_f32 v196, v196, v194
    v_add_f32 v196, v196, v195
    v_mfma_f32_16x16x32_bf16 v[4:7], v[160:163], v[140:143], v[4:7]
    s_waitcnt vmcnt(4)
    s_barrier
    ds_read_b128 v[160:163], v200 offset:49152
    v_cvt_pk_bf16_f32 v131, v194, v195
    s_waitcnt lgkmcnt(13)
    v_mfma_f32_16x16x32_bf16 v[8:11], v[164:167], v[136:139], v[8:11]
    v_exp_f32 v194, v106
    s_add_u32 m0, s25, 16384
    s_add_u32 s35, s24, 0
    buffer_load_dwordx4 v212, s[8:11], s35 offen lds
    v_mfma_f32_16x16x32_bf16 v[12:15], v[164:167], v[140:143], v[12:15]
    ds_read_b128 v[164:167], v201 offset:49152
    v_exp_f32 v195, v107
    s_waitcnt lgkmcnt(12)
    v_mfma_f32_16x16x32_bf16 v[16:19], v[168:171], v[136:139], v[16:19]
    v_add_f32 v197, v192, v193
    v_cvt_pk_bf16_f32 v132, v192, v193
    s_add_u32 m0, s25, 24576
    s_add_u32 s35, s24, 8192
    buffer_load_dwordx4 v212, s[8:11], s35 offen lds
    v_mfma_f32_16x16x32_bf16 v[20:23], v[168:171], v[140:143], v[20:23]
    ds_read_b128 v[168:171], v202 offset:49152
    v_exp_f32 v192, v108
    s_waitcnt lgkmcnt(11)
    v_mfma_f32_16x16x32_bf16 v[24:27], v[172:175], v[136:139], v[24:27]
    v_exp_f32 v193, v109
    s_add_u32 m0, s26, 18432
    s_sub_u32 s35, s24, 16384
    buffer_load_dwordx4 v213, s[12:15], s35 offen lds
    v_mfma_f32_16x16x32_bf16 v[28:31], v[172:175], v[140:143], v[28:31]
    ds_read_b128 v[172:175], v203 offset:49152
    v_add_f32 v197, v197, v194
    v_add_f32 v197, v197, v195
    s_waitcnt lgkmcnt(10)
    v_mfma_f32_16x16x32_bf16 v[32:35], v[176:179], v[136:139], v[32:35]
    v_cvt_pk_bf16_f32 v133, v194, v195
    s_add_u32 m0, s26, 27648
    s_sub_u32 s35, s24, 8192
    buffer_load_dwordx4 v213, s[12:15], s35 offen lds
    v_mfma_f32_16x16x32_bf16 v[36:39], v[176:179], v[140:143], v[36:39]
    ds_read_b128 v[176:179], v200 offset:53248
    v_exp_f32 v194, v110
    s_waitcnt lgkmcnt(9)
    v_mfma_f32_16x16x32_bf16 v[40:43], v[180:183], v[136:139], v[40:43]
    v_exp_f32 v195, v111
    s_add_u32 s24, s24, 16384
    v_mfma_f32_16x16x32_bf16 v[44:47], v[180:183], v[140:143], v[44:47]
    ds_read_b128 v[180:183], v201 offset:53248
    v_add_f32 v197, v197, v192
    v_add_f32 v197, v197, v193
    s_waitcnt lgkmcnt(8)
    v_mfma_f32_16x16x32_bf16 v[48:51], v[184:187], v[136:139], v[48:51]
    v_cvt_pk_bf16_f32 v134, v192, v193
    buffer_load_dwordx4 v[224:227], v221, s[44:47], 0 offen offset:2048
    v_mfma_f32_16x16x32_bf16 v[52:55], v[184:187], v[140:143], v[52:55]
    ds_read_b128 v[184:187], v202 offset:53248
    v_add_f32 v197, v197, v194
    v_add_f32 v197, v197, v195
    s_waitcnt lgkmcnt(7)
    v_mfma_f32_16x16x32_bf16 v[56:59], v[188:191], v[136:139], v[56:59]
    v_cvt_pk_bf16_f32 v135, v194, v195
    buffer_load_dwordx4 v[224:227], v222, s[48:51], 0 offen offset:2048
    v_mfma_f32_16x16x32_bf16 v[60:63], v[188:191], v[140:143], v[60:63]
    ds_read_b128 v[188:191], v203 offset:53248
    v_max_f32 v192, v196, v197
    v_cmp_lt_f32 vcc, s36, v192
    s_cbranch_vccz L_at_ok4
    s_call_b64 s[38:39], L_at_rare0
L_at_ok4:
    v_add_f32 v198, v198, v196
    v_add_f32 v199, v199, v197
    s_waitcnt lgkmcnt(7)
    v_mfma_f32_16x16x32_bf16 v[96:99], v[160:163], v[64:67], v[144:147]
    v_exp_f32 v192, v112
    v_mfma_f32_16x16x32_bf16 v[104:107], v[160:163], v[80:83], v[148:151]
    ds_read_b64_tr_b16 v[160:161], v208 offset:18432
    ds_read_b64_tr_b16 v[162:163], v208 offset:23040
    v_exp_f32 v193, v113
    s_waitcnt lgkmcnt(8)
    v_mfma_f32_16x16x32_bf16 v[96:99], v[164:167], v[68:71], v[96:99]
    v_exp_f32 v194, v114
    v_mfma_f32_16x16x32_bf16 v[104:107], v[164:167], v[84:87], v[104:107]
    ds_read_b64_tr_b16 v[164:165], v209 offset:18432
    ds_read_b64_tr_b16 v[166:167], v209 offset:23040
    v_exp_f32 v195, v115
    s_waitcnt lgkmcnt(9)
    v_mfma_f32_16x16x32_bf16 v[96:99], v[168:171], v[72:75], v[96:99]
    v_add_f32 v196, v192, v193
    v_cvt_pk_bf16_f32 v136, v192, v193
    v_mfma_f32_16x16x32_bf16 v[104:107], v[168:171], v[88:91], v[104:107]
    ds_read_b64_tr_b16 v[168:169], v210 offset:18432
    ds_read_b64_tr_b16 v[170:171], v210 offset:23040
    v_exp_f32 v192, v116
    s_waitcnt lgkmcnt(10)
    v_mfma_f32_16x16x32_bf16 v[96:99], v[172:175], v[76:79], v[96:99]
    v_exp_f32 v193, v117
    v_mfma_f32_16x16x32_bf16 v[104:107], v[172:175], v[92:95], v[104:107]
    ds_read_b64_tr_b16 v[172:173], v211 offset:18432
    ds_read_b64_tr_b16 v[174:175], v211 offset:23040
    v_add_f32 v196, v196, v194
    v_add_f32 v196, v196, v195
    s_waitcnt lgkmcnt(11)
    v_mfma_f32_16x16x32_bf16 v[100:103], v[176:179], v[64:67], v[144:147]
    v_cvt_pk_bf16_f32 v137, v194, v195
    v_mfma_f32_16x16x32_bf16 v[108:111], v[176:179], v[80:83], v[148:151]
    ds_read_b64_tr_b16 v[176:177], v208 offset:18560
    ds_read_b64_tr_b16 v[178:179], v208 offset:23168
    v_exp_f32 v194, v118
    s_waitcnt lgkmcnt(12)
    v_mfma_f32_16x16x32_bf16 v[100:103], v[180:183], v[68:71], v[100:103]
    v_exp_f32 v195, v119
    v_mfma_f32_16x16x32_bf16 v[108:111], v[180:183], v[84:87], v[108:111]
    ds_read_b64_tr_b16 v[180:181], v209 offset:18560
    ds_read_b64_tr_b16 v[182:183], v209 offset:23168
    v_add_f32 v196, v196, v192
    v_add_f32 v196, v196, v193
    s_waitcnt lgkmcnt(13)
    v_mfma_f32_16x16x32_bf16 v[100:103], v[184:187], v[72:75], v[100:103]
    v_cvt_pk_bf16_f32 v138, v192, v193
    v_mfma_f32_16x16x32_bf16 v[108:111], v[184:187], v[88:91], v[108:111]
    ds_read_b64_tr_b16 v[184:185], v210 offset:18560
    ds_read_b64_tr_b16 v[186:187], v210 offset:23168
    v_exp_f32 v192, v120
    s_waitcnt lgkmcnt(14)
    v_mfma_f32_16x16x32_bf16 v[100:103], v[188:191], v[76:79], v[100:103]
    v_exp_f32 v193, v121
    v_mfma_f32_16x16x32_bf16 v[108:111], v[188:191], v[92:95], v[108:111]
    ds_read_b64_tr_b16 v[188:189], v211 offset:18560
    ds_read_b64_tr_b16 v[190:191], v211 offset:23168
    s_waitcnt lgkmcnt(14)
    v_mfma_f32_16x16x32_bf16 v[0:3], v[160:163], v[128:131], v[0:3]
    v_add_f32 v196, v196, v194
    v_add_f32 v196, v196, v195
    v_mfma_f32_16x16x32_bf16 v[4:7], v[160:163], v[132:135], v[4:7]
    ds_read_b128 v[160:163], v200 offset:57344
    v_cvt_pk_bf16_f32 v139, v194, v195
    s_waitcnt lgkmcnt(13)
    v_mfma_f32_16x16x32_bf16 v[8:11], v[164:167], v[128:131], v[8:11]
    v_exp_f32 v194, v122
    v_mfma_f32_16x16x32_bf16 v[12:15], v[164:167], v[132:135], v[12:15]
    ds_read_b128 v[164:167], v201 offset:57344
    v_exp_f32 v195, v123
    s_waitcnt lgkmcnt(12)
    v_mfma_f32_16x16x32_bf16 v[16:19], v[168:171], v[128:131], v[16:19]
    v_add_f32 v197, v192, v193
    v_cvt_pk_bf16_f32 v140, v192, v193
    v_mfma_f32_16x16x32_bf16 v[20:23], v[168:171], v[132:135], v[20:23]
    ds_read_b128 v[168:171], v202 offset:57344
    v_exp_f32 v192, v124
    s_waitcnt lgkmcnt(11)
    v_mfma_f32_16x16x32_bf16 v[24:27], v[172:175], v[128:131], v[24:27]
    v_exp_f32 v193, v125
    v_mfma_f32_16x16x32_bf16 v[28:31], v[172:175], v[132:135], v[28:31]
    ds_read_b128 v[172:175], v203 offset:57344
    v_add_f32 v197, v197, v194
    v_add_f32 v197, v197, v195
    s_waitcnt lgkmcnt(10)
    v_mfma_f32_16x16x32_bf16 v[32:35], v[176:179], v[128:131], v[32:35]
    v_cvt_pk_bf16_f32 v141, v194, v195
    v_mfma_f32_16x16x32_bf16 v[36:39], v[176:179], v[132:135], v[36:39]
    ds_read_b128 v[176:179], v200 offset:61440
    v_exp_f32 v194, v126
    s_waitcnt lgkmcnt(9)
    v_mfma_f32_16x16x32_bf16 v[40:43], v[180:183], v[128:131], v[40:43]
    v_exp_f32 v195, v127
    v_mfma_f32_16x16x32_bf16 v[44:47], v[180:183], v[132:135], v[44:47]
    ds_read_b128 v[180:183], v201 offset:61440
    v_add_f32 v197, v197, v192
    v_add_f32 v197, v197, v193
    s_waitcnt lgkmcnt(8)
    v_mfma_f32_16x16x32_bf16 v[48:51], v[184:187], v[128:131], v[48:51]
    v_cvt_pk_bf16_f32 v142, v192, v193
    v_mfma_f32_16x16x32_bf16 v[52:55], v[184:187], v[132:135], v[52:55]
    ds_read_b128 v[184:187], v202 offset:61440
    v_add_f32 v197, v197, v194
    v_add_f32 v197, v197, v195
    s_waitcnt lgkmcnt(7)
    v_mfma_f32_16x16x32_bf16 v[56:59], v[188:191], v[128:131], v[56:59]
    v_cvt_pk_bf16_f32 v143, v194, v195
    v_mfma_f32_16x16x32_bf16 v[60:63], v[188:191], v[132:135], v[60:63]
    ds_read_b128 v[188:191], v203 offset:61440
    v_max_f32 v192, v196, v197
    v_cmp_lt_f32 vcc, s36, v192
    s_cbranch_vccz L_at_ok5
    s_call_b64 s[38:39], L_at_rare1
L_at_ok5:
    v_add_f32 v198, v198, v196
    v_add_f32 v199, v199, v197
    s_waitcnt lgkmcnt(7)
    v_mfma_f32_16x16x32_bf16 v[112:115], v[160:163], v[64:67], v[144:147]
    v_exp_f32 v192, v96
    v_mfma_f32_16x16x32_bf16 v[120:123], v[160:163], v[80:83], v[148:151]
    ds_read_b64_tr_b16 v[160:161], v208 offset:27648
    ds_read_b64_tr_b16 v[162:163], v208 offset:32256
    v_exp_f32 v193, v97
    s_waitcnt lgkmcnt(8)
    v_mfma_f32_16x16x32_bf16 v[112:115], v[164:167], v[68:71], v[112:115]
    v_exp_f32 v194, v98
    v_mfma_f32_16x16x32_bf16 v[120:123], v[164:167], v[84:87], v[120:123]
    ds_read_b64_tr_b16 v[164:165], v209 offset:27648
    ds_read_b64_tr_b16 v[166:167], v209 offset:32256
    v_exp_f32 v195, v99
    s_waitcnt lgkmcnt(9)
    v_mfma_f32_16x16x32_bf16 v[112:115], v[168:171], v[72:75], v[112:115]
    v_add_f32 v196, v192, v193
    v_cvt_pk_bf16_f32 v128, v192, v193
    v_mfma_f32_16x16x32_bf16 v[120:123], v[168:171], v[88:91], v[120:123]
    ds_read_b64_tr_b16 v[168:169], v210 offset:27648
    ds_read_b64_tr_b16 v[170:171], v210 offset:32256
    v_exp_f32 v192, v100
    s_waitcnt lgkmcnt(10)
    v_mfma_f32_16x16x32_bf16 v[112:115], v[172:175], v[76:79], v[112:115]
    v_exp_f32 v193, v101
    v_mfma_f32_16x16x32_bf16 v[120:123], v[172:175], v[92:95], v[120:123]
    ds_read_b64_tr_b16 v[172:173], v211 offset:27648
    ds_read_b64_tr_b16 v[174:175], v211 offset:32256
    v_add_f32 v196, v196, v194
    v_add_f32 v196, v196, v195
    s_waitcnt lgkmcnt(11)
    v_mfma_f32_16x16x32_bf16 v[116:119], v[176:179], v[64:67], v[144:147]
    v_cvt_pk_bf16_f32 v129, v194, v195
    v_mfma_f32_16x16x32_bf16 v[124:127], v[176:179], v[80:83], v[148:151]
    ds_read_b64_tr_b16 v[176:177], v208 offset:27776
    ds_read_b64_tr_b16 v[178:179], v208 offset:32384
    v_exp_f32 v194, v102
    s_waitcnt lgkmcnt(12)
    v_mfma_f32_16x16x32_bf16 v[116:119], v[180:183], v[68:71], v[116:119]
    v_exp_f32 v195, v103
    v_mfma_f32_16x16x32_bf16 v[124:127], v[180:183], v[84:87], v[124:127]
    ds_read_b64_tr_b16 v[180:181], v209 offset:27776
    ds_read_b64_tr_b16 v[182:183], v209 offset:32384
    v_add_f32 v196, v196, v192
    v_add_f32 v196, v196, v193
    s_waitcnt lgkmcnt(13)
    v_mfma_f32_16x16x32_bf16 v[116:119], v[184:187], v[72:75], v[116:119]
    v_cvt_pk_bf16_f32 v130, v192, v193
    v_mfma_f32_16x16x32_bf16 v[124:127], v[184:187], v[88:91], v[124:127]
    ds_read_b64_tr_b16 v[184:185], v210 offset:27776
    ds_read_b64_tr_b16 v[186:187], v210 offset:32384
    v_exp_f32 v192, v104
    s_waitcnt lgkmcnt(14)
    v_mfma_f32_16x16x32_bf16 v[116:119], v[188:191], v[76:79], v[116:119]
    v_exp_f32 v193, v105
    v_mfma_f32_16x16x32_bf16 v[124:127], v[188:191], v[92:95], v[124:127]
    ds_read_b64_tr_b16 v[188:189], v211 offset:27776
    ds_read_b64_tr_b16 v[190:191], v211 offset:32384
    s_waitcnt lgkmcnt(14)
    v_mfma_f32_16x16x32_bf16 v[0:3], v[160:163], v[136:139], v[0:3]
    v_add_f32 v196, v196, v194
    v_add_f32 v196, v196, v195
    v_mfma_f32_16x16x32_bf16 v[4:7], v[160:163], v[140:143], v[4:7]
    s_waitcnt vmcnt(4)
    s_barrier
    ds_read_b128 v[160:163], v200 offset:0
    v_cvt_pk_bf16_f32 v131, v194, v195
    s_waitcnt lgkmcnt(13)
    v_mfma_f32_16x16x32_bf16 v[8:11], v[164:167], v[136:139], v[8:11]
    v_exp_f32 v194, v106
    s_add_u32 m0, s25, 32768
    s_add_u32 s35, s24, 0
    buffer_load_dwordx4 v212, s[8:11], s35 offen lds
    v_mfma_f32_16x16x32_bf16 v[12:15], v[164:167], v[140:143], v[12:15]
    ds_read_b128 v[164:167], v201 offset:0
    v_exp_f32 v195, v107
    s_waitcnt lgkmcnt(12)
    v_mfma_f32_16x16x32_bf16 v[16:19], v[168:171], v[136:139], v[16:19]
    v_add_f32 v197, v192, v193
    v_cvt_pk_bf16_f32 v132, v192, v193
    s_add_u32 m0, s25, 40960
    s_add_u32 s35, s24, 8192
    buffer_load_dwordx4 v212, s[8:11], s35 offen lds
    v_mfma_f32_16x16x32_bf16 v[20:23], v[168:171], v[140:143], v[20:23]
    ds_read_b128 v[168:171], v202 offset:0
    v_exp_f32 v192, v108
    s_waitcnt lgkmcnt(11)
    v_mfma_f32_16x16x32_bf16 v[24:27], v[172:175], v[136:139], v[24:27]
    v_exp_f32 v193, v109
    s_add_u32 m0, s26, 36864
    s_sub_u32 s35, s24, 16384
    buffer_load_dwordx4 v213, s[12:15], s35 offen lds
    v_mfma_f32_16x16x32_bf16 v[28:31], v[172:175], v[140:143], v[28:31]
    ds_read_b128 v[172:175], v203 offset:0
    v_add_f32 v197, v197, v194
    v_add_f32 v197, v197, v195
    s_waitcnt lgkmcnt(10)
    v_mfma_f32_16x16x32_bf16 v[32:35], v[176:179], v[136:139], v[32:35]
    v_cvt_pk_bf16_f32 v133, v194, v195
    s_add_u32 m0, s26, 46080
    s_sub_u32 s35, s24, 8192
    buffer_load_dwordx4 v213, s[12:15], s35 offen lds
    v_mfma_f32_16x16x32_bf16 v[36:39], v[176:179], v[140:143], v[36:39]
    ds_read_b128 v[176:179], v200 offset:4096
    v_exp_f32 v194, v110
    s_waitcnt lgkmcnt(9)
    v_mfma_f32_16x16x32_bf16 v[40:43], v[180:183], v[136:139], v[40:43]
    v_exp_f32 v195, v111
    s_add_u32 s24, s24, 16384
    v_mfma_f32_16x16x32_bf16 v[44:47], v[180:183], v[140:143], v[44:47]
    ds_read_b128 v[180:183], v201 offset:4096
    v_add_f32 v197, v197, v192
    v_add_f32 v197, v197, v193
    s_waitcnt lgkmcnt(8)
    v_mfma_f32_16x16x32_bf16 v[48:51], v[184:187], v[136:139], v[48:51]
    v_cvt_pk_bf16_f32 v134, v192, v193
    buffer_load_dwordx4 v[224:227], v221, s[44:47], 0 offen offset:3072
    v_mfma_f32_16x16x32_bf16 v[52:55], v[184:187], v[140:143], v[52:55]
    ds_read_b128 v[184:187], v202 offset:4096
    v_add_f32 v197, v197, v194
    v_add_f32 v197, v197, v195
    s_waitcnt lgkmcnt(7)
    v_mfma_f32_16x16x32_bf16 v[56:59], v[188:191], v[136:139], v[56:59]
    v_cvt_pk_bf16_f32 v135, v194, v195
    buffer_load_dwordx4 v[224:227], v222, s[48:51], 0 offen offset:2560
    v_mfma_f32_16x16x32_bf16 v[60:63], v[188:191], v[140:143], v[60:63]
    ds_read_b128 v[188:191], v203 offset:4096
    v_max_f32 v192, v196, v197
    v_cmp_lt_f32 vcc, s36, v192
    s_cbranch_vccz L_at_ok6
    s_call_b64 s[38:39], L_at_rare0
L_at_ok6:
    v_add_f32 v198, v198, v196
    v_add_f32 v199, v199, v197
    s_mov_b32 s27, 7
L_at_loop:
    s_waitcnt lgkmcnt(7)
    v_mfma_f32_16x16x32_bf16 v[96:99], v[160:163], v[64:67], v[144:147]
    v_exp_f32 v192, v112
    v_mfma_f32_16x16x32_bf16 v[104:107], v[160:163], v[80:83], v[148:151]
    ds_read_b64_tr_b16 v[160:161], v204 offset:0
    ds_read_b64_tr_b16 v[162:163], v204 offset:4608
    v_exp_f32 v193, v113
    s_waitcnt lgkmcnt(8)
    v_mfma_f32_16x16x32_bf16 v[96:99], v[164:167], v[68:71], v[96:99]
    v_exp_f32 v194, v114
    v_mfma_f32_16x16x32_bf16 v[104:107], v[164:167], v[84:87], v[104:107]
    ds_read_b64_tr_b16 v[164:165], v205 offset:0
    ds_read_b64_tr_b16 v[166:167], v205 offset:4608
    v_exp_f32 v195, v115
    s_waitcnt lgkmcnt(9)
    v_mfma_f32_16x16x32_bf16 v[96:99], v[168:171], v[72:75], v[96:99]
    v_add_f32 v196, v192, v193
    v_cvt_pk_bf16_f32 v136, v192, v193
    v_mfma_f32_16x16x32_bf16 v[104:107], v[168:171], v[88:91], v[104:107]
    ds_read_b64_tr_b16 v[168:169], v206 offset:0
    ds_read_b64_tr_b16 v[170:171], v206 offset:4608
    v_exp_f32 v192, v116
    s_waitcnt lgkmcnt(10)
    v_mfma_f32_16x16x32_bf16 v[96:99], v[172:175], v[76:79], v[96:99]
    v_exp_f32 v193, v117
    v_mfma_f32_16x16x32_bf16 v[104:107], v[172:175], v[92:95], v[104:107]
    ds_read_b64_tr_b16 v[172:173], v207 offset:0
    ds_read_b64_tr_b16 v[174:175], v207 offset:4608
    v_add_f32 v196, v196, v194
    v_add_f32 v196, v196, v195
    s_waitcnt lgkmcnt(11)
    v_mfma_f32_16x16x32_bf16 v[100:103], v[176:179], v[64:67], v[144:147]
    v_cvt_pk_bf16_f32 v137, v194, v195
    v_mfma_f32_16x16x32_bf16 v[108:111], v[176:179], v[80:83], v[148:151]
    ds_read_b64_tr_b16 v[176:177], v204 offset:128
    ds_read_b64_tr_b16 v[178:179], v204 offset:4736
    v_exp_f32 v194, v118
    s_waitcnt lgkmcnt(12)
    v_mfma_f32_16x16x32_bf16 v[100:103], v[180:183], v[68:71], v[100:103]
    v_exp_f32 v195, v119
    v_mfma_f32_16x16x32_bf16 v[108:111], v[180:183], v[84:87], v[108:111]
    ds_read_b64_tr_b16 v[180:181], v205 offset:128
    ds_read_b64_tr_b16 v[182:183], v205 offset:4736
    v_add_f32 v196, v196, v192
    v_add_f32 v196, v196, v193
    s_waitcnt lgkmcnt(13)
    v_mfma_f32_16x16x32_bf16 v[100:103], v[184:187], v[72:75], v[100:103]
    v_cvt_pk_bf16_f32 v138, v192, v193
    v_mfma_f32_16x16x32_bf16 v[108:111], v[184:187], v[88:91], v[108:111]
    ds_read_b64_tr_b16 v[184:185], v206 offset:128
    ds_read_b64_tr_b16 v[186:187], v206 offset:4736
    v_exp_f32 v192, v120
    s_waitcnt lgkmcnt(14)
    v_mfma_f32_16x16x32_bf16 v[100:103], v[188:191], v[76:79], v[100:103]
    v_exp_f32 v193, v121
    v_mfma_f32_16x16x32_bf16 v[108:111], v[188:191], v[92:95], v[108:111]
    ds_read_b64_tr_b16 v[188:189], v207 offset:128
    ds_read_b64_tr_b16 v[190:191], v207 offset:4736
    s_waitcnt lgkmcnt(14)
    v_mfma_f32_16x16x32_bf16 v[0:3], v[160:163], v[128:131], v[0:3]
    v_add_f32 v196, v196, v194
    v_add_f32 v196, v196, v195
    v_mfma_f32_16x16x32_bf16 v[4:7], v[160:163], v[132:135], v[4:7]
    ds_read_b128 v[160:163], v200 offset:8192
    v_cvt_pk_bf16_f32 v139, v194, v195
    s_waitcnt lgkmcnt(13)
    v_mfma_f32_16x16x32_bf16 v[8:11], v[164:167], v[128:131], v[8:11]
    v_exp_f32 v194, v122
    v_mfma_f32_16x16x32_bf16 v[12:15], v[164:167], v[132:135], v[12:15]
    ds_read_b128 v[164:167], v201 offset:8192
    v_exp_f32 v195, v123
    s_waitcnt lgkmcnt(12)
    v_mfma_f32_16x16x32_bf16 v[16:19], v[168:171], v[128:131], v[16:19]
    v_add_f32 v197, v192, v193
    v_cvt_pk_bf16_f32 v140, v192, v193
    v_mfma_f32_16x16x32_bf16 v[20:23], v[168:171], v[132:135], v[20:23]
    ds_read_b128 v[168:171], v202 offset:8192
    v_exp_f32 v192, v124
    s_waitcnt lgkmcnt(11)
    v_mfma_f32_16x16x32_bf16 v[24:27], v[172:175], v[128:131], v[24:27]
    v_exp_f32 v193, v125
    v_mfma_f32_16x16x32_bf16 v[28:31], v[172:175], v[132:135], v[28:31]
    ds_read_b128 v[172:175], v203 offset:8192
    v_add_f32 v197, v197, v194
    v_add_f32 v197, v197, v195
    s_waitcnt lgkmcnt(10)
    v_mfma_f32_16x16x32_bf16 v[32:35], v[176:179], v[128:131], v[32:35]
    v_cvt_pk_bf16_f32 v141, v194, v195
    v_mfma_f32_16x16x32_bf16 v[36:39], v[176:179], v[132:135], v[36:39]
    ds_read_b128 v[176:179], v200 offset:12288
    v_exp_f32 v194, v126
    s_waitcnt lgkmcnt(9)
    v_mfma_f32_16x16x32_bf16 v[40:43], v[180:183], v[128:131], v[40:43]
    v_exp_f32 v195, v127
    v_mfma_f32_16x16x32_bf16 v[44:47], v[180:183], v[132:135], v[44:47]
    ds_read_b128 v[180:183], v201 offset:12288
    v_add_f32 v197, v197, v192
    v_add_f32 v197, v197, v193
    s_waitcnt lgkmcnt(8)
    v_mfma_f32_16x16x32_bf16 v[48:51], v[184:187], v[128:131], v[48:51]
    v_cvt_pk_bf16_f32 v142, v192, v193
    v_mfma_f32_16x16x32_bf16 v[52:55], v[184:187], v[132:135], v[52:55]
    ds_read_b128 v[184:187], v202 offset:12288
    v_add_f32 v197, v197, v194
    v_add_f32 v197, v197, v195
    s_waitcnt lgkmcnt(7)
    v_mfma_f32_16x16x32_bf16 v[56:59], v[188:191], v[128:131], v[56:59]
    v_cvt_pk_bf16_f32 v143, v194, v195
    v_mfma_f32_16x16x32_bf16 v[60:63], v[188:191], v[132:135], v[60:63]
    ds_read_b128 v[188:191], v203 offset:12288
    v_max_f32 v192, v196, v197
    v_cmp_lt_f32 vcc, s36, v192
    s_cbranch_vccz L_at_ok7
    s_call_b64 s[38:39], L_at_rare1
L_at_ok7:
    v_add_f32 v198, v198, v196
    v_add_f32 v199, v199, v197
    s_waitcnt lgkmcnt(7)
    v_mfma_f32_16x16x32_bf16 v[112:115], v[160:163], v[64:67], v[144:147]
    v_exp_f32 v192, v96
    v_mfma_f32_16x16x32_bf16 v[120:123], v[160:163], v[80:83], v[148:151]
    ds_read_b64_tr_b16 v[160:161], v204 offset:9216
    ds_read_b64_tr_b16 v[162:163], v204 offset:13824
    v_exp_f32 v193, v97
    s_waitcnt lgkmcnt(8)
    v_mfma_f32_16x16x32_bf16 v[112:115], v[164:167], v[68:71], v[112:115]
    v_exp_f32 v194, v98
    v_mfma_f32_16x16x32_bf16 v[120:123], v[164:167], v[84:87], v[120:123]
    ds_read_b64_tr_b16 v[164:165], v205 offset:9216
    ds_read_b64_tr_b16 v[166:167], v205 offset:13824
    v_exp_f32 v195, v99
    s_waitcnt lgkmcnt(9)
    v_mfma_f32_16x16x32_bf16 v[112:115], v[168:171], v[72:75], v[112:115]
    v_add_f32 v196, v192, v193
    v_cvt_pk_bf16_f32 v128, v192, v193
    v_mfma_f32_16x16x32_bf16 v[120:123], v[168:171], v[88:91], v[120:123]
    ds_read_b64_tr_b16 v[168:169], v206 offset:9216
    ds_read_b64_tr_b16 v[170:171], v206 offset:13824
    v_exp_f32 v192, v100
    s_waitcnt lgkmcnt(10)
    v_mfma_f32_16x16x32_bf16 v[112:115], v[172:175], v[76:79], v[112:115]
    v_exp_f32 v193, v101
    v_mfma_f32_16x16x32_bf16 v[120:123], v[172:175], v[92:95], v[120:123]
    ds_read_b64_tr_b16 v[172:173], v207 offset:9216
    ds_read_b64_tr_b16 v[174:175], v207 offset:13824
    v_add_f32 v196, v196, v194
    v_add_f32 v196, v196, v195
    s_waitcnt lgkmcnt(11)
    v_mfma_f32_16x16x32_bf16 v[116:119], v[176:179], v[64:67], v[144:147]
    v_cvt_pk_bf16_f32 v129, v194, v195
    v_mfma_f32_16x16x32_bf16 v[124:127], v[176:179], v[80:83], v[148:151]
    ds_read_b64_tr_b16 v[176:177], v204 offset:9344
    ds_read_b64_tr_b16 v[178:179], v204 offset:13952
    v_exp_f32 v194, v102
    s_waitcnt lgkmcnt(12)
    v_mfma_f32_16x16x32_bf16 v[116:119], v[180:183], v[68:71], v[116:119]
    v_exp_f32 v195, v103
    v_mfma_f32_16x16x32_bf16 v[124:127], v[180:183], v[84:87], v[124:127]
    ds_read_b64_tr_b16 v[180:181], v205 offset:9344
    ds_read_b64_tr_b16 v[182:183], v205 offset:13952
    v_add_f32 v196, v196, v192
    v_add_f32 v196, v196, v193
    s_waitcnt lgkmcnt(13)
    v_mfma_f32_16x16x32_bf16 v[116:119], v[184:187], v[72:75], v[116:119]
    v_cvt_pk_bf16_f32 v130, v192, v193
    v_mfma_f32_16x16x32_bf16 v[124:127], v[184:187], v[88:91], v[124:127]
    ds_read_b64_tr_b16 v[184:185], v206 offset:9344
    ds_read_b64_tr_b16 v[186:187], v206 offset:13952
    v_exp_f32 v192, v104
    s_waitcnt lgkmcnt(14)
    v_mfma_f32_16x16x32_bf16 v[116:119], v[188:191], v[76:79], v[116:119]
    v_exp_f32 v193, v105
    v_mfma_f32_16x16x32_bf16 v[124:127], v[188:191], v[92:95], v[124:127]
    ds_read_b64_tr_b16 v[188:189], v207 offset:9344
    ds_read_b64_tr_b16 v[190:191], v207 offset:13952
    s_waitcnt lgkmcnt(14)
    v_mfma_f32_16x16x32_bf16 v[0:3], v[160:163], v[136:139], v[0:3]
    v_add_f32 v196, v196, v194
    v_add_f32 v196, v196, v195
    v_mfma_f32_16x16x32_bf16 v[4:7], v[160:163], v[140:143], v[4:7]
    s_waitcnt vmcnt(4)
    s_barrier
    ds_read_b128 v[160:163], v200 offset:16384
    v_cvt_pk_bf16_f32 v131, v194, v195
    s_waitcnt lgkmcnt(13)
    v_mfma_f32_16x16x32_bf16 v[8:11], v[164:167], v[136:139], v[8:11]
    v_exp_f32 v194, v106
    s_add_u32 m0, s25, 49152
    s_add_u32 s35, s24, 0
    buffer_load_dwordx4 v212, s[8:11], s35 offen lds
    v_mfma_f32_16x16x32_bf16 v[12:15], v[164:167], v[140:143], v[12:15]
    ds_read_b128 v[164:167], v201 offset:16384
    v_exp_f32 v195, v107
    s_waitcnt lgkmcnt(12)
    v_mfma_f32_16x16x32_bf16 v[16:19], v[168:171], v[136:139], v[16:19]
    v_add_f32 v197, v192, v193
    v_cvt_pk_bf16_f32 v132, v192, v193
    s_add_u32 m0, s25, 57344
    s_add_u32 s35, s24, 8192
    buffer_load_dwordx4 v212, s[8:11], s35 offen lds
    v_mfma_f32_16x16x32_bf16 v[20:23], v[168:171], v[140:143], v[20:23]
    ds_read_b128 v[168:171], v202 offset:16384
    v_exp_f32 v192, v108
    s_waitcnt lgkmcnt(11)
    v_mfma_f32_16x16x32_bf16 v[24:27], v[172:175], v[136:139], v[24:27]
    v_exp_f32 v193, v109
    s_add_u32 m0, s26, 55296
    s_sub_u32 s35, s24, 16384
    buffer_load_dwordx4 v213, s[12:15], s35 offen lds
    v_mfma_f32_16x16x32_bf16 v[28:31], v[172:175], v[140:143], v[28:31]
    ds_read_b128 v[172:175], v203 offset:16384
    v_add_f32 v197, v197, v194
    v_add_f32 v197, v197, v195
    s_waitcnt lgkmcnt(10)
    v_mfma_f32_16x16x32_bf16 v[32:35], v[176:179], v[136:139], v[32:35]
    v_cvt_pk_bf16_f32 v133, v194, v195
    s_add_u32 m0, s26, 64512
    s_sub_u32 s35, s24, 8192
    buffer_load_dwordx4 v213, s[12:15], s35 offen lds
    v_mfma_f32_16x16x32_bf16 v[36:39], v[176:179], v[140:143], v[36:39]
    ds_read_b128 v[176:179], v200 offset:20480
    v_exp_f32 v194, v110
    s_waitcnt lgkmcnt(9)
    v_mfma_f32_16x16x32_bf16 v[40:43], v[180:183], v[136:139], v[40:43]
    v_exp_f32 v195, v111
    s_add_u32 s24, s24, 16384
    v_mfma_f32_16x16x32_bf16 v[44:47], v[180:183], v[140:143], v[44:47]
    ds_read_b128 v[180:183], v201 offset:20480
    v_add_f32 v197, v197, v192
    v_add_f32 v197, v197, v193
    s_waitcnt lgkmcnt(8)
    v_mfma_f32_16x16x32_bf16 v[48:51], v[184:187], v[136:139], v[48:51]
    v_cvt_pk_bf16_f32 v134, v192, v193
    buffer_load_dwordx2 v[224:225], v223, s[92:95], s83 offen
    v_mfma_f32_16x16x32_bf16 v[52:55], v[184:187], v[140:143], v[52:55]
    ds_read_b128 v[184:187], v202 offset:20480
    v_add_f32 v197, v197, v194
    v_add_f32 v197, v197, v195
    s_waitcnt lgkmcnt(7)
    v_mfma_f32_16x16x32_bf16 v[56:59], v[188:191], v[136:139], v[56:59]
    v_cvt_pk_bf16_f32 v135, v194, v195
    v_mfma_f32_16x16x32_bf16 v[60:63], v[188:191], v[140:143], v[60:63]
    ds_read_b128 v[188:191], v203 offset:20480
    v_max_f32 v192, v196, v197
    v_cmp_lt_f32 vcc, s36, v192
    s_cbranch_vccz L_at_ok8
    s_call_b64 s[38:39], L_at_rare0
L_at_ok8:
    v_add_f32 v198, v198, v196
    v_add_f32 v199, v199, v197
    s_waitcnt lgkmcnt(7)
    v_mfma_f32_16x16x32_bf16 v[96:99], v[160:163], v[64:67], v[144:147]
    v_exp_f32 v192, v112
    v_mfma_f32_16x16x32_bf16 v[104:107], v[160:163], v[80:83], v[148:151]
    ds_read_b64_tr_b16 v[160:161], v204 offset:18432
    ds_read_b64_tr_b16 v[162:163], v204 offset:23040
    v_exp_f32 v193, v113
    s_waitcnt lgkmcnt(8)
    v_mfma_f32_16x16x32_bf16 v[96:99], v[164:167], v[68:71], v[96:99]
    v_exp_f32 v194, v114
    v_mfma_f32_16x16x32_bf16 v[104:107], v[164:167], v[84:87], v[104:107]
    ds_read_b64_tr_b16 v[164:165], v205 offset:18432
    ds_read_b64_tr_b16 v[166:167], v205 offset:23040
    v_exp_f32 v195, v115
    s_waitcnt lgkmcnt(9)
    v_mfma_f32_16x16x32_bf16 v[96:99], v[168:171], v[72:75], v[96:99]
    v_add_f32 v196, v192, v193
    v_cvt_pk_bf16_f32 v136, v192, v193
    v_mfma_f32_16x16x32_bf16 v[104:107], v[168:171], v[88:91], v[104:107]
    ds_read_b64_tr_b16 v[168:169], v206 offset:18432
    ds_read_b64_tr_b16 v[170:171], v206 offset:23040
    v_exp_f32 v192, v116
    s_waitcnt lgkmcnt(10)
    v_mfma_f32_16x16x32_bf16 v[96:99], v[172:175], v[76:79], v[96:99]
    v_exp_f32 v193, v117
    v_mfma_f32_16x16x32_bf16 v[104:107], v[172:175], v[92:95], v[104:107]
    ds_read_b64_tr_b16 v[172:173], v207 offset:18432
    ds_read_b64_tr_b16 v[174:175], v207 offset:23040
    v_add_f32 v196, v196, v194
    v_add_f32 v196, v196, v195
    s_waitcnt lgkmcnt(11)
    v_mfma_f32_16x16x32_bf16 v[100:103], v[176:179], v[64:67], v[144:147]
    v_cvt_pk_bf16_f32 v137, v194, v195
    v_mfma_f32_16x16x32_bf16 v[108:111], v[176:179], v[80:83], v[148:151]
    ds_read_b64_tr_b16 v[176:177], v204 offset:18560
    ds_read_b64_tr_b16 v[178:179], v204 offset:23168
    v_exp_f32 v194, v118
    s_waitcnt lgkmcnt(12)
    v_mfma_f32_16x16x32_bf16 v[100:103], v[180:183], v[68:71], v[100:103]
    v_exp_f32 v195, v119
    v_mfma_f32_16x16x32_bf16 v[108:111], v[180:183], v[84:87], v[108:111]
    ds_read_b64_tr_b16 v[180:181], v205 offset:18560
    ds_read_b64_tr_b16 v[182:183], v205 offset:23168
    v_add_f32 v196, v196, v192
    v_add_f32 v196, v196, v193
    s_waitcnt lgkmcnt(13)
    v_mfma_f32_16x16x32_bf16 v[100:103], v[184:187], v[72:75], v[100:103]
    v_cvt_pk_bf16_f32 v138, v192, v193
    v_mfma_f32_16x16x32_bf16 v[108:111], v[184:187], v[88:91], v[108:111]
    ds_read_b64_tr_b16 v[184:185], v206 offset:18560
    ds_read_b64_tr_b16 v[186:187], v206 offset:23168
    v_exp_f32 v192, v120
    s_waitcnt lgkmcnt(14)
    v_mfma_f32_16x16x32_bf16 v[100:103], v[188:191], v[76:79], v[100:103]
    v_exp_f32 v193, v121
    v_mfma_f32_16x16x32_bf16 v[108:111], v[188:191], v[92:95], v[108:111]
    ds_read_b64_tr_b16 v[188:189], v207 offset:18560
    ds_read_b64_tr_b16 v[190:191], v207 offset:23168
    s_waitcnt lgkmcnt(14)
    v_mfma_f32_16x16x32_bf16 v[0:3], v[160:163], v[128:131], v[0:3]
    v_add_f32 v196, v196, v194
    v_add_f32 v196, v196, v195
    v_mfma_f32_16x16x32_bf16 v[4:7], v[160:163], v[132:135], v[4:7]
    ds_read_b128 v[160:163], v200 offset:24576
    v_cvt_pk_bf16_f32 v139, v194, v195
    s_waitcnt lgkmcnt(13)
    v_mfma_f32_16x16x32_bf16 v[8:11], v[164:167], v[128:131], v[8:11]
    v_exp_f32 v194, v122
    v_mfma_f32_16x16x32_bf16 v[12:15], v[164:167], v[132:135], v[12:15]
    ds_read_b128 v[164:167], v201 offset:24576
    v_exp_f32 v195, v123
    s_waitcnt lgkmcnt(12)
    v_mfma_f32_16x16x32_bf16 v[16:19], v[168:171], v[128:131], v[16:19]
    v_add_f32 v197, v192, v193
    v_cvt_pk_bf16_f32 v140, v192, v193
    v_mfma_f32_16x16x32_bf16 v[20:23], v[168:171], v[132:135], v[20:23]
    ds_read_b128 v[168:171], v202 offset:24576
    v_exp_f32 v192, v124
    s_waitcnt lgkmcnt(11)
    v_mfma_f32_16x16x32_bf16 v[24:27], v[172:175], v[128:131], v[24:27]
    v_exp_f32 v193, v125
    v_mfma_f32_16x16x32_bf16 v[28:31], v[172:175], v[132:135], v[28:31]
    ds_read_b128 v[172:175], v203 offset:24576
    v_add_f32 v197, v197, v194
    v_add_f32 v197, v197, v195
    s_waitcnt lgkmcnt(10)
    v_mfma_f32_16x16x32_bf16 v[32:35], v[176:179], v[128:131], v[32:35]
    v_cvt_pk_bf16_f32 v141, v194, v195
    v_mfma_f32_16x16x32_bf16 v[36:39], v[176:179], v[132:135], v[36:39]
    ds_read_b128 v[176:179], v200 offset:28672
    v_exp_f32 v194, v126
    s_waitcnt lgkmcnt(9)
    v_mfma_f32_16x16x32_bf16 v[40:43], v[180:183], v[128:131], v[40:43]
    v_exp_f32 v195, v127
    v_mfma_f32_16x16x32_bf16 v[44:47], v[180:183], v[132:135], v[44:47]
    ds_read_b128 v[180:183], v201 offset:28672
    v_add_f32 v197, v197, v192
    v_add_f32 v197, v197, v193
    s_waitcnt lgkmcnt(8)
    v_mfma_f32_16x16x32_bf16 v[48:51], v[184:187], v[128:131], v[48:51]
    v_cvt_pk_bf16_f32 v142, v192, v193
    v_mfma_f32_16x16x32_bf16 v[52:55], v[184:187], v[132:135], v[52:55]
    ds_read_b128 v[184:187], v202 offset:28672
    v_add_f32 v197, v197, v194
    v_add_f32 v197, v197, v195
    s_waitcnt lgkmcnt(7)
    v_mfma_f32_16x16x32_bf16 v[56:59], v[188:191], v[128:131], v[56:59]
    v_cvt_pk_bf16_f32 v143, v194, v195
    v_mfma_f32_16x16x32_bf16 v[60:63], v[188:191], v[132:135], v[60:63]
    ds_read_b128 v[188:191], v203 offset:28672
    v_max_f32 v192, v196, v197
    v_cmp_lt_f32 vcc, s36, v192
    s_cbranch_vccz L_at_ok9
    s_call_b64 s[38:39], L_at_rare1
L_at_ok9:
    v_add_f32 v198, v198, v196
    v_add_f32 v199, v199, v197
    s_waitcnt lgkmcnt(7)
    v_mfma_f32_16x16x32_bf16 v[112:115], v[160:163], v[64:67], v[144:147]
    v_exp_f32 v192, v96
    v_mfma_f32_16x16x32_bf16 v[120:123], v[160:163], v[80:83], v[148:151]
    ds_read_b64_tr_b16 v[160:161], v204 offset:27648
    ds_read_b64_tr_b16 v[162:163], v204 offset:32256
    v_exp_f32 v193, v97
    s_waitcnt lgkmcnt(8)
    v_mfma_f32_16x16x32_bf16 v[112:115], v[164:167], v[68:71], v[112:115]
    v_exp_f32 v194, v98
    v_mfma_f32_16x16x32_bf16 v[120:123], v[164:167], v[84:87], v[120:123]
    ds_read_b64_tr_b16 v[164:165], v205 offset:27648
    ds_read_b64_tr_b16 v[166:167], v205 offset:32256
    v_exp_f32 v195, v99
    s_waitcnt lgkmcnt(9)
    v_mfma_f32_16x16x32_bf16 v[112:115], v[168:171], v[72:75], v[112:115]
    v_add_f32 v196, v192, v193
    v_cvt_pk_bf16_f32 v128, v192, v193
    v_mfma_f32_16x16x32_bf16 v[120:123], v[168:171], v[88:91], v[120:123]
    ds_read_b64_tr_b16 v[168:169], v206 offset:27648
    ds_read_b64_tr_b16 v[170:171], v206 offset:32256
    v_exp_f32 v192, v100
    s_waitcnt lgkmcnt(10)
    v_mfma_f32_16x16x32_bf16 v[112:115], v[172:175], v[76:79], v[112:115]
    v_exp_f32 v193, v101
    v_mfma_f32_16x16x32_bf16 v[120:123], v[172:175], v[92:95], v[120:123]
    ds_read_b64_tr_b16 v[172:173], v207 offset:27648
    ds_read_b64_tr_b16 v[174:175], v207 offset:32256
    v_add_f32 v196, v196, v194
    v_add_f32 v196, v196, v195
    s_waitcnt lgkmcnt(11)
    v_mfma_f32_16x16x32_bf16 v[116:119], v[176:179], v[64:67], v[144:147]
    v_cvt_pk_bf16_f32 v129, v194, v195
    v_mfma_f32_16x16x32_bf16 v[124:127], v[176:179], v[80:83], v[148:151]
    ds_read_b64_tr_b16 v[176:177], v204 offset:27776
    ds_read_b64_tr_b16 v[178:179], v204 offset:32384
    v_exp_f32 v194, v102
    s_waitcnt lgkmcnt(12)
    v_mfma_f32_16x16x32_bf16 v[116:119], v[180:183], v[68:71], v[116:119]
    v_exp_f32 v195, v103
    v_mfma_f32_16x16x32_bf16 v[124:127], v[180:183], v[84:87], v[124:127]
    ds_read_b64_tr_b16 v[180:181], v205 offset:27776
    ds_read_b64_tr_b16 v[182:183], v205 offset:32384
    v_add_f32 v196, v196, v192
    v_add_f32 v196, v196, v193
    s_waitcnt lgkmcnt(13)
    v_mfma_f32_16x16x32_bf16 v[116:119], v[184:187], v[72:75], v[116:119]
    v_cvt_pk_bf16_f32 v130, v192, v193
    v_mfma_f32_16x16x32_bf16 v[124:127], v[184:187], v[88:91], v[124:127]
    ds_read_b64_tr_b16 v[184:185], v206 offset:27776
    ds_read_b64_tr_b16 v[186:187], v206 offset:32384
    v_exp_f32 v192, v104
    s_waitcnt lgkmcnt(14)
    v_mfma_f32_16x16x32_bf16 v[116:119], v[188:191], v[76:79], v[116:119]
    v_exp_f32 v193, v105
    v_mfma_f32_16x16x32_bf16 v[124:127], v[188:191], v[92:95], v[124:127]
    ds_read_b64_tr_b16 v[188:189], v207 offset:27776
    ds_read_b64_tr_b16 v[190:191], v207 offset:32384
    s_waitcnt lgkmcnt(14)
    v_mfma_f32_16x16x32_bf16 v[0:3], v[160:163], v[136:139], v[0:3]
    v_add_f32 v196, v196, v194
    v_add_f32 v196, v196, v195
    v_mfma_f32_16x16x32_bf16 v[4:7], v[160:163], v[140:143], v[4:7]
    s_waitcnt vmcnt(4)
    s_barrier
    ds_read_b128 v[160:163], v200 offset:32768
    v_cvt_pk_bf16_f32 v131, v194, v195
    s_waitcnt lgkmcnt(13)
    v_mfma_f32_16x16x32_bf16 v[8:11], v[164:167], v[136:139], v[8:11]
    v_exp_f32 v194, v106
    s_add_u32 m0, s25, 0
    s_add_u32 s35, s24, 0
    buffer_load_dwordx4 v212, s[8:11], s35 offen lds
    v_mfma_f32_16x16x32_bf16 v[12:15], v[164:167], v[140:143], v[12:15]
    ds_read_b128 v[164:167], v201 offset:32768
    v_exp_f32 v195, v107
    s_waitcnt lgkmcnt(12)
    v_mfma_f32_16x16x32_bf16 v[16:19], v[168:171], v[136:139], v[16:19]
    v_add_f32 v197, v192, v193
    v_cvt_pk_bf16_f32 v132, v192, v193
    s_add_u32 m0, s25, 8192
    s_add_u32 s35, s24, 8192
    buffer_load_dwordx4 v212, s[8:11], s35 offen lds
    v_mfma_f32_16x16x32_bf16 v[20:23], v[168:171], v[140:143], v[20:23]
    ds_read_b128 v[168:171], v202 offset:32768
    v_exp_f32 v192, v108
    s_waitcnt lgkmcnt(11)
    v_mfma_f32_16x16x32_bf16 v[24:27], v[172:175], v[136:139], v[24:27]
    v_exp_f32 v193, v109
    s_add_u32 m0, s26, 0
    s_sub_u32 s35, s24, 16384
    buffer_load_dwordx4 v213, s[12:15], s35 offen lds
    v_mfma_f32_16x16x32_bf16 v[28:31], v[172:175], v[140:143], v[28:31]
    ds_read_b128 v[172:175], v203 offset:32768
    v_add_f32 v197, v197, v194
    v_add_f32 v197, v197, v195
    s_waitcnt lgkmcnt(10)
    v_mfma_f32_16x16x32_bf16 v[32:35], v[176:179], v[136:139], v[32:35]
    v_cvt_pk_bf16_f32 v133, v194, v195
    s_add_u32 m0, s26, 9216
    s_sub_u32 s35, s24, 8192
    buffer_load_dwordx4 v213, s[12:15], s35 offen lds
    v_mfma_f32_16x16x32_bf16 v[36:39], v[176:179], v[140:143], v[36:39]
    ds_read_b128 v[176:179], v200 offset:36864
    v_exp_f32 v194, v110
    s_waitcnt lgkmcnt(9)
    v_mfma_f32_16x16x32_bf16 v[40:43], v[180:183], v[136:139], v[40:43]
    v_exp_f32 v195, v111
    s_add_u32 s24, s24, 16384
    v_mfma_f32_16x16x32_bf16 v[44:47], v[180:183], v[140:143], v[44:47]
    ds_read_b128 v[180:183], v201 offset:36864
    v_add_f32 v197, v197, v192
    v_add_f32 v197, v197, v193
    s_waitcnt lgkmcnt(8)
    v_mfma_f32_16x16x32_bf16 v[48:51], v[184:187], v[136:139], v[48:51]
    v_cvt_pk_bf16_f32 v134, v192, v193
    v_mfma_f32_16x16x32_bf16 v[52:55], v[184:187], v[140:143], v[52:55]
    ds_read_b128 v[184:187], v202 offset:36864
    v_add_f32 v197, v197, v194
    v_add_f32 v197, v197, v195
    s_waitcnt lgkmcnt(7)
    v_mfma_f32_16x16x32_bf16 v[56:59], v[188:191], v[136:139], v[56:59]
    v_cvt_pk_bf16_f32 v135, v194, v195
    v_mfma_f32_16x16x32_bf16 v[60:63], v[188:191], v[140:143], v[60:63]
    ds_read_b128 v[188:191], v203 offset:36864
    v_max_f32 v192, v196, v197
    v_cmp_lt_f32 vcc, s36, v192
    s_cbranch_vccz L_at_ok10
    s_call_b64 s[38:39], L_at_rare0
L_at_ok10:
    v_add_f32 v198, v198, v196
    v_add_f32 v199, v199, v197
    s_waitcnt lgkmcnt(7)
    v_mfma_f32_16x16x32_bf16 v[96:99], v[160:163], v[64:67], v[144:147]
    v_exp_f32 v192, v112
    v_mfma_f32_16x16x32_bf16 v[104:107], v[160:163], v[80:83], v[148:151]
    ds_read_b64_tr_b16 v[160:161], v208 offset:0
    ds_read_b64_tr_b16 v[162:163], v208 offset:4608
    v_exp_f32 v193, v113
    s_waitcnt lgkmcnt(8)
    v_mfma_f32_16x16x32_bf16 v[96:99], v[164:167], v[68:71], v[96:99]
    v_exp_f32 v194, v114
    v_mfma_f32_16x16x32_bf16 v[104:107], v[164:167], v[84:87], v[104:107]
    ds_read_b64_tr_b16 v[164:165], v209 offset:0
    ds_read_b64_tr_b16 v[166:167], v209 offset:4608
    v_exp_f32 v195, v115
    s_waitcnt lgkmcnt(9)
    v_mfma_f32_16x16x32_bf16 v[96:99], v[168:171], v[72:75], v[96:99]
    v_add_f32 v196, v192, v193
    v_cvt_pk_bf16_f32 v136, v192, v193
    v_mfma_f32_16x16x32_bf16 v[104:107], v[168:171], v[88:91], v[104:107]
    ds_read_b64_tr_b16 v[168:169], v210 offset:0
    ds_read_b64_tr_b16 v[170:171], v210 offset:4608
    v_exp_f32 v192, v116
    s_waitcnt lgkmcnt(10)
    v_mfma_f32_16x16x32_bf16 v[96:99], v[172:175], v[76:79], v[96:99]
    v_exp_f32 v193, v117
    v_mfma_f32_16x16x32_bf16 v[104:107], v[172:175], v[92:95], v[104:107]
    ds_read_b64_tr_b16 v[172:173], v211 offset:0
    ds_read_b64_tr_b16 v[174:175], v211 offset:4608
    v_add_f32 v196, v196, v194
    v_add_f32 v196, v196, v195
    s_waitcnt lgkmcnt(11)
    v_mfma_f32_16x16x32_bf16 v[100:103], v[176:179], v[64:67], v[144:147]
    v_cvt_pk_bf16_f32 v137, v194, v195
    v_mfma_f32_16x16x32_bf16 v[108:111], v[176:179], v[80:83], v[148:151]
    ds_read_b64_tr_b16 v[176:177], v208 offset:128
    ds_read_b64_tr_b16 v[178:179], v208 offset:4736
    v_exp_f32 v194, v118
    s_waitcnt lgkmcnt(12)
    v_mfma_f32_16x16x32_bf16 v[100:103], v[180:183], v[68:71], v[100:103]
    v_exp_f32 v195, v119
    v_mfma_f32_16x16x32_bf16 v[108:111], v[180:183], v[84:87], v[108:111]
    ds_read_b64_tr_b16 v[180:181], v209 offset:128
    ds_read_b64_tr_b16 v[182:183], v209 offset:4736
    v_add_f32 v196, v196, v192
    v_add_f32 v196, v196, v193
    s_waitcnt lgkmcnt(13)
    v_mfma_f32_16x16x32_bf16 v[100:103], v[184:187], v[72:75], v[100:103]
    v_cvt_pk_bf16_f32 v138, v192, v193
    v_mfma_f32_16x16x32_bf16 v[108:111], v[184:187], v[88:91], v[108:111]
    ds_read_b64_tr_b16 v[184:185], v210 offset:128
    ds_read_b64_tr_b16 v[186:187], v210 offset:4736
    v_exp_f32 v192, v120
    s_waitcnt lgkmcnt(14)
    v_mfma_f32_16x16x32_bf16 v[100:103], v[188:191], v[76:79], v[100:103]
    v_exp_f32 v193, v121
    v_mfma_f32_16x16x32_bf16 v[108:111], v[188:191], v[92:95], v[108:111]
    ds_read_b64_tr_b16 v[188:189], v211 offset:128
    ds_read_b64_tr_b16 v[190:191], v211 offset:4736
    s_waitcnt lgkmcnt(14)
    v_mfma_f32_16x16x32_bf16 v[0:3], v[160:163], v[128:131], v[0:3]
    v_add_f32 v196, v196, v194
    v_add_f32 v196, v196, v195
    v_mfma_f32_16x16x32_bf16 v[4:7], v[160:163], v[132:135], v[4:7]
    ds_read_b128 v[160:163], v200 offset:40960
    v_cvt_pk_bf16_f32 v139, v194, v195
    s_waitcnt lgkmcnt(13)
    v_mfma_f32_16x16x32_bf16 v[8:11], v[164:167], v[128:131], v[8:11]
    v_exp_f32 v194, v122
    v_mfma_f32_16x16x32_bf16 v[12:15], v[164:167], v[132:135], v[12:15]
    ds_read_b128 v[164:167], v201 offset:40960
    v_exp_f32 v195, v123
    s_waitcnt lgkmcnt(12)
    v_mfma_f32_16x16x32_bf16 v[16:19], v[168:171], v[128:131], v[16:19]
    v_add_f32 v197, v192, v193
    v_cvt_pk_bf16_f32 v140, v192, v193
    v_mfma_f32_16x16x32_bf16 v[20:23], v[168:171], v[132:135], v[20:23]
    ds_read_b128 v[168:171], v202 offset:40960
    v_exp_f32 v192, v124
    s_waitcnt lgkmcnt(11)
    v_mfma_f32_16x16x32_bf16 v[24:27], v[172:175], v[128:131], v[24:27]
    v_exp_f32 v193, v125
    v_mfma_f32_16x16x32_bf16 v[28:31], v[172:175], v[132:135], v[28:31]
    ds_read_b128 v[172:175], v203 offset:40960
    v_add_f32 v197, v197, v194
    v_add_f32 v197, v197, v195
    s_waitcnt lgkmcnt(10)
    v_mfma_f32_16x16x32_bf16 v[32:35], v[176:179], v[128:131], v[32:35]
    v_cvt_pk_bf16_f32 v141, v194, v195
    v_mfma_f32_16x16x32_bf16 v[36:39], v[176:179], v[132:135], v[36:39]
    ds_read_b128 v[176:179], v200 offset:45056
    v_exp_f32 v194, v126
    s_waitcnt lgkmcnt(9)
    v_mfma_f32_16x16x32_bf16 v[40:43], v[180:183], v[128:131], v[40:43]
    v_exp_f32 v195, v127
    v_mfma_f32_16x16x32_bf16 v[44:47], v[180:183], v[132:135], v[44:47]
    ds_read_b128 v[180:183], v201 offset:45056
    v_add_f32 v197, v197, v192
    v_add_f32 v197, v197, v193
    s_waitcnt lgkmcnt(8)
    v_mfma_f32_16x16x32_bf16 v[48:51], v[184:187], v[128:131], v[48:51]
    v_cvt_pk_bf16_f32 v142, v192, v193
    v_mfma_f32_16x16x32_bf16 v[52:55], v[184:187], v[132:135], v[52:55]
    ds_read_b128 v[184:187], v202 offset:45056
    v_add_f32 v197, v197, v194
    v_add_f32 v197, v197, v195
    s_waitcnt lgkmcnt(7)
    v_mfma_f32_16x16x32_bf16 v[56:59], v[188:191], v[128:131], v[56:59]
    v_cvt_pk_bf16_f32 v143, v194, v195
    v_mfma_f32_16x16x32_bf16 v[60:63], v[188:191], v[132:135], v[60:63]
    ds_read_b128 v[188:191], v203 offset:45056
    v_max_f32 v192, v196, v197
    v_cmp_lt_f32 vcc, s36, v192
    s_cbranch_vccz L_at_ok11
    s_call_b64 s[38:39], L_at_rare1
L_at_ok11:
    v_add_f32 v198, v198, v196
    v_add_f32 v199, v199, v197
    s_waitcnt lgkmcnt(7)
    v_mfma_f32_16x16x32_bf16 v[112:115], v[160:163], v[64:67], v[144:147]
    v_exp_f32 v192, v96
    v_mfma_f32_16x16x32_bf16 v[120:123], v[160:163], v[80:83], v[148:151]
    ds_read_b64_tr_b16 v[160:161], v208 offset:9216
    ds_read_b64_tr_b16 v[162:163], v208 offset:13824
    v_exp_f32 v193, v97
    s_waitcnt lgkmcnt(8)
    v_mfma_f32_16x16x32_bf16 v[112:115], v[164:167], v[68:71], v[112:115]
    v_exp_f32 v194, v98
    v_mfma_f32_16x16x32_bf16 v[120:123], v[164:167], v[84:87], v[120:123]
    ds_read_b64_tr_b16 v[164:165], v209 offset:9216
    ds_read_b64_tr_b16 v[166:167], v209 offset:13824
    v_exp_f32 v195, v99
    s_waitcnt lgkmcnt(9)
    v_mfma_f32_16x16x32_bf16 v[112:115], v[168:171], v[72:75], v[112:115]
    v_add_f32 v196, v192, v193
    v_cvt_pk_bf16_f32 v128, v192, v193
    v_mfma_f32_16x16x32_bf16 v[120:123], v[168:171], v[88:91], v[120:123]
    ds_read_b64_tr_b16 v[168:169], v210 offset:9216
    ds_read_b64_tr_b16 v[170:171], v210 offset:13824
    v_exp_f32 v192, v100
    s_waitcnt lgkmcnt(10)
    v_mfma_f32_16x16x32_bf16 v[112:115], v[172:175], v[76:79], v[112:115]
    v_exp_f32 v193, v101
    v_mfma_f32_16x16x32_bf16 v[120:123], v[172:175], v[92:95], v[120:123]
    ds_read_b64_tr_b16 v[172:173], v211 offset:9216
    ds_read_b64_tr_b16 v[174:175], v211 offset:13824
    v_add_f32 v196, v196, v194
    v_add_f32 v196, v196, v195
    s_waitcnt lgkmcnt(11)
    v_mfma_f32_16x16x32_bf16 v[116:119], v[176:179], v[64:67], v[144:147]
    v_cvt_pk_bf16_f32 v129, v194, v195
    v_mfma_f32_16x16x32_bf16 v[124:127], v[176:179], v[80:83], v[148:151]
    ds_read_b64_tr_b16 v[176:177], v208 offset:9344
    ds_read_b64_tr_b16 v[178:179], v208 offset:13952
    v_exp_f32 v194, v102
    s_waitcnt lgkmcnt(12)
    v_mfma_f32_16x16x32_bf16 v[116:119], v[180:183], v[68:71], v[116:119]
    v_exp_f32 v195, v103
    v_mfma_f32_16x16x32_bf16 v[124:127], v[180:183], v[84:87], v[124:127]
    ds_read_b64_tr_b16 v[180:181], v209 offset:9344
    ds_read_b64_tr_b16 v[182:183], v209 offset:13952
    v_add_f32 v196, v196, v192
    v_add_f32 v196, v196, v193
    s_waitcnt lgkmcnt(13)
    v_mfma_f32_16x16x32_bf16 v[116:119], v[184:187], v[72:75], v[116:119]
    v_cvt_pk_bf16_f32 v130, v192, v193
    v_mfma_f32_16x16x32_bf16 v[124:127], v[184:187], v[88:91], v[124:127]
    ds_read_b64_tr_b16 v[184:185], v210 offset:9344
    ds_read_b64_tr_b16 v[186:187], v210 offset:13952
    v_exp_f32 v192, v104
    s_waitcnt lgkmcnt(14)
    v_mfma_f32_16x16x32_bf16 v[116:119], v[188:191], v[76:79], v[116:119]
    v_exp_f32 v193, v105
    v_mfma_f32_16x16x32_bf16 v[124:127], v[188:191], v[92:95], v[124:127]
    ds_read_b64_tr_b16 v[188:189], v211 offset:9344
    ds_read_b64_tr_b16 v[190:191], v211 offset:13952
    s_waitcnt lgkmcnt(14)
    v_mfma_f32_16x16x32_bf16 v[0:3], v[160:163], v[136:139], v[0:3]
    v_add_f32 v196, v196, v194
    v_add_f32 v196, v196, v195
    v_mfma_f32_16x16x32_bf16 v[4:7], v[160:163], v[140:143], v[4:7]
    s_waitcnt vmcnt(4)
    s_barrier
    ds_read_b128 v[160:163], v200 offset:49152
    v_cvt_pk_bf16_f32 v131, v194, v195
    s_waitcnt lgkmcnt(13)
    v_mfma_f32_16x16x32_bf16 v[8:11], v[164:167], v[136:139], v[8:11]
    v_exp_f32 v194, v106
    s_add_u32 m0, s25, 16384
    s_add_u32 s35, s24, 0
    buffer_load_dwordx4 v212, s[8:11], s35 offen lds
    v_mfma_f32_16x16x32_bf16 v[12:15], v[164:167], v[140:143], v[12:15]
    ds_read_b128 v[164:167], v201 offset:49152
    v_exp_f32 v195, v107
    s_waitcnt lgkmcnt(12)
    v_mfma_f32_16x16x32_bf16 v[16:19], v[168:171], v[136:139], v[16:19]
    v_add_f32 v197, v192, v193
    v_cvt_pk_bf16_f32 v132, v192, v193
    s_add_u32 m0, s25, 24576
    s_add_u32 s35, s24, 8192
    buffer_load_dwordx4 v212, s[8:11], s35 offen lds
    v_mfma_f32_16x16x32_bf16 v[20:23], v[168:171], v[140:143], v[20:23]
    ds_read_b128 v[168:171], v202 offset:49152
    v_exp_f32 v192, v108
    s_waitcnt lgkmcnt(11)
    v_mfma_f32_16x16x32_bf16 v[24:27], v[172:175], v[136:139], v[24:27]
    v_exp_f32 v193, v109
    s_add_u32 m0, s26, 18432
    s_sub_u32 s35, s24, 16384
    buffer_load_dwordx4 v213, s[12:15], s35 offen lds
    v_mfma_f32_16x16x32_bf16 v[28:31], v[172:175], v[140:143], v[28:31]
    ds_read_b128 v[172:175], v203 offset:49152
    v_add_f32 v197, v197, v194
    v_add_f32 v197, v197, v195
    s_waitcnt lgkmcnt(10)
    v_mfma_f32_16x16x32_bf16 v[32:35], v[176:179], v[136:139], v[32:35]
    v_cvt_pk_bf16_f32 v133, v194, v195
    s_add_u32 m0, s26, 27648
    s_sub_u32 s35, s24, 8192
    buffer_load_dwordx4 v213, s[12:15], s35 offen lds
    v_mfma_f32_16x16x32_bf16 v[36:39], v[176:179], v[140:143], v[36:39]
    ds_read_b128 v[176:179], v200 offset:53248
    v_exp_f32 v194, v110
    s_waitcnt lgkmcnt(9)
    v_mfma_f32_16x16x32_bf16 v[40:43], v[180:183], v[136:139], v[40:43]
    v_exp_f32 v195, v111
    s_add_u32 s24, s24, 16384
    v_mfma_f32_16x16x32_bf16 v[44:47], v[180:183], v[140:143], v[44:47]
    ds_read_b128 v[180:183], v201 offset:53248
    v_add_f32 v197, v197, v192
    v_add_f32 v197, v197, v193
    s_waitcnt lgkmcnt(8)
    v_mfma_f32_16x16x32_bf16 v[48:51], v[184:187], v[136:139], v[48:51]
    v_cvt_pk_bf16_f32 v134, v192, v193
    buffer_load_dwordx2 v[224:225], v223, s[96:99], s83 offen
    s_add_u32 s83, s83, 512
    v_mfma_f32_16x16x32_bf16 v[52:55], v[184:187], v[140:143], v[52:55]
    ds_read_b128 v[184:187], v202 offset:53248
    v_add_f32 v197, v197, v194
    v_add_f32 v197, v197, v195
    s_waitcnt lgkmcnt(7)
    v_mfma_f32_16x16x32_bf16 v[56:59], v[188:191], v[136:139], v[56:59]
    v_cvt_pk_bf16_f32 v135, v194, v195
    v_mfma_f32_16x16x32_bf16 v[60:63], v[188:191], v[140:143], v[60:63]
    ds_read_b128 v[188:191], v203 offset:53248
    v_max_f32 v192, v196, v197
    v_cmp_lt_f32 vcc, s36, v192
    s_cbranch_vccz L_at_ok12
    s_call_b64 s[38:39], L_at_rare0
L_at_ok12:
    v_add_f32 v198, v198, v196
    v_add_f32 v199, v199, v197
    s_waitcnt lgkmcnt(7)
    v_mfma_f32_16x16x32_bf16 v[96:99], v[160:163], v[64:67], v[144:147]
    v_exp_f32 v192, v112
    v_mfma_f32_16x16x32_bf16 v[104:107], v[160:163], v[80:83], v[148:151]
    ds_read_b64_tr_b16 v[160:161], v208 offset:18432
    ds_read_b64_tr_b16 v[162:163], v208 offset:23040
    v_exp_f32 v193, v113
    s_waitcnt lgkmcnt(8)
    v_mfma_f32_16x16x32_bf16 v[96:99], v[164:167], v[68:71], v[96:99]
    v_exp_f32 v194, v114
    v_mfma_f32_16x16x32_bf16 v[104:107], v[164:167], v[84:87], v[104:107]
    ds_read_b64_tr_b16 v[164:165], v209 offset:18432
    ds_read_b64_tr_b16 v[166:167], v209 offset:23040
    v_exp_f32 v195, v115
    s_waitcnt lgkmcnt(9)
    v_mfma_f32_16x16x32_bf16 v[96:99], v[168:171], v[72:75], v[96:99]
    v_add_f32 v196, v192, v193
    v_cvt_pk_bf16_f32 v136, v192, v193
    v_mfma_f32_16x16x32_bf16 v[104:107], v[168:171], v[88:91], v[104:107]
    ds_read_b64_tr_b16 v[168:169], v210 offset:18432
    ds_read_b64_tr_b16 v[170:171], v210 offset:23040
    v_exp_f32 v192, v116
    s_waitcnt lgkmcnt(10)
    v_mfma_f32_16x16x32_bf16 v[96:99], v[172:175], v[76:79], v[96:99]
    v_exp_f32 v193, v117
    v_mfma_f32_16x16x32_bf16 v[104:107], v[172:175], v[92:95], v[104:107]
    ds_read_b64_tr_b16 v[172:173], v211 offset:18432
    ds_read_b64_tr_b16 v[174:175], v211 offset:23040
    v_add_f32 v196, v196, v194
    v_add_f32 v196, v196, v195
    s_waitcnt lgkmcnt(11)
    v_mfma_f32_16x16x32_bf16 v[100:103], v[176:179], v[64:67], v[144:147]
    v_cvt_pk_bf16_f32 v137, v194, v195
    v_mfma_f32_16x16x32_bf16 v[108:111], v[176:179], v[80:83], v[148:151]
    ds_read_b64_tr_b16 v[176:177], v208 offset:18560
    ds_read_b64_tr_b16 v[178:179], v208 offset:23168
    v_exp_f32 v194, v118
    s_waitcnt lgkmcnt(12)
    v_mfma_f32_16x16x32_bf16 v[100:103], v[180:183], v[68:71], v[100:103]
    v_exp_f32 v195, v119
    v_mfma_f32_16x16x32_bf16 v[108:111], v[180:183], v[84:87], v[108:111]
    ds_read_b64_tr_b16 v[180:181], v209 offset:18560
    ds_read_b64_tr_b16 v[182:183], v209 offset:23168
    v_add_f32 v196, v196, v192
    v_add_f32 v196, v196, v193
    s_waitcnt lgkmcnt(13)
    v_mfma_f32_16x16x32_bf16 v[100:103], v[184:187], v[72:75], v[100:103]
    v_cvt_pk_bf16_f32 v138, v192, v193
    v_mfma_f32_16x16x32_bf16 v[108:111], v[184:187], v[88:91], v[108:111]
    ds_read_b64_tr_b16 v[184:185], v210 offset:18560
    ds_read_b64_tr_b16 v[186:187], v210 offset:23168
    v_exp_f32 v192, v120
    s_waitcnt lgkmcnt(14)
    v_mfma_f32_16x16x32_bf16 v[100:103], v[188:191], v[76:79], v[100:103]
    v_exp_f32 v193, v121
    v_mfma_f32_16x16x32_bf16 v[108:111], v[188:191], v[92:95], v[108:111]
    ds_read_b64_tr_b16 v[188:189], v211 offset:18560
    ds_read_b64_tr_b16 v[190:191], v211 offset:23168
    s_waitcnt lgkmcnt(14)
    v_mfma_f32_16x16x32_bf16 v[0:3], v[160:163], v[128:131], v[0:3]
    v_add_f32 v196, v196, v194
    v_add_f32 v196, v196, v195
    v_mfma_f32_16x16x32_bf16 v[4:7], v[160:163], v[132:135], v[4:7]
    ds_read_b128 v[160:163], v200 offset:57344
    v_cvt_pk_bf16_f32 v139, v194, v195
    s_waitcnt lgkmcnt(13)
    v_mfma_f32_16x16x32_bf16 v[8:11], v[164:167], v[128:131], v[8:11]
    v_exp_f32 v194, v122
    v_mfma_f32_16x16x32_bf16 v[12:15], v[164:167], v[132:135], v[12:15]
    ds_read_b128 v[164:167], v201 offset:57344
    v_exp_f32 v195, v123
    s_waitcnt lgkmcnt(12)
    v_mfma_f32_16x16x32_bf16 v[16:19], v[168:171], v[128:131], v[16:19]
    v_add_f32 v197, v192, v193
    v_cvt_pk_bf16_f32 v140, v192, v193
    v_mfma_f32_16x16x32_bf16 v[20:23], v[168:171], v[132:135], v[20:23]
    ds_read_b128 v[168:171], v202 offset:57344
    v_exp_f32 v192, v124
    s_waitcnt lgkmcnt(11)
    v_mfma_f32_16x16x32_bf16 v[24:27], v[172:175], v[128:131], v[24:27]
    v_exp_f32 v193, v125
    v_mfma_f32_16x16x32_bf16 v[28:31], v[172:175], v[132:135], v[28:31]
    ds_read_b128 v[172:175], v203 offset:57344
    v_add_f32 v197, v197, v194
    v_add_f32 v197, v197, v195
    s_waitcnt lgkmcnt(10)
    v_mfma_f32_16x16x32_bf16 v[32:35], v[176:179], v[128:131], v[32:35]
    v_cvt_pk_bf16_f32 v141, v194, v195
    v_mfma_f32_16x16x32_bf16 v[36:39], v[176:179], v[132:135], v[36:39]
    ds_read_b128 v[176:179], v200 offset:61440
    v_exp_f32 v194, v126
    s_waitcnt lgkmcnt(9)
    v_mfma_f32_16x16x32_bf16 v[40:43], v[180:183], v[128:131], v[40:43]
    v_exp_f32 v195, v127
    v_mfma_f32_16x16x32_bf16 v[44:47], v[180:183], v[132:135], v[44:47]
    ds_read_b128 v[180:183], v201 offset:61440
    v_add_f32 v197, v197, v192
    v_add_f32 v197, v197, v193
    s_waitcnt lgkmcnt(8)
    v_mfma_f32_16x16x32_bf16 v[48:51], v[184:187], v[128:131], v[48:51]
    v_cvt_pk_bf16_f32 v142, v192, v193
    v_mfma_f32_16x16x32_bf16 v[52:55], v[184:187], v[132:135], v[52:55]
    ds_read_b128 v[184:187], v202 offset:61440
    v_add_f32 v197, v197, v194
    v_add_f32 v197, v197, v195
    s_waitcnt lgkmcnt(7)
    v_mfma_f32_16x16x32_bf16 v[56:59], v[188:191], v[128:131], v[56:59]
    v_cvt_pk_bf16_f32 v143, v194, v195
    v_mfma_f32_16x16x32_bf16 v[60:63], v[188:191], v[132:135], v[60:63]
    ds_read_b128 v[188:191], v203 offset:61440
    v_max_f32 v192, v196, v197
    v_cmp_lt_f32 vcc, s36, v192
    s_cbranch_vccz L_at_ok13
    s_call_b64 s[38:39], L_at_rare1
L_at_ok13:
    v_add_f32 v198, v198, v196
    v_add_f32 v199, v199, v197
    s_waitcnt lgkmcnt(7)
    v_mfma_f32_16x16x32_bf16 v[112:115], v[160:163], v[64:67], v[144:147]
    v_exp_f32 v192, v96
    v_mfma_f32_16x16x32_bf16 v[120:123], v[160:163], v[80:83], v[148:151]
    ds_read_b64_tr_b16 v[160:161], v208 offset:27648
    ds_read_b64_tr_b16 v[162:163], v208 offset:32256
    v_exp_f32 v193, v97
    s_waitcnt lgkmcnt(8)
    v_mfma_f32_16x16x32_bf16 v[112:115], v[164:167], v[68:71], v[112:115]
    v_exp_f32 v194, v98
    v_mfma_f32_16x16x32_bf16 v[120:123], v[164:167], v[84:87], v[120:123]
    ds_read_b64_tr_b16 v[164:165], v209 offset:27648
    ds_read_b64_tr_b16 v[166:167], v209 offset:32256
    v_exp_f32 v195, v99
    s_waitcnt lgkmcnt(9)
    v_mfma_f32_16x16x32_bf16 v[112:115], v[168:171], v[72:75], v[112:115]
    v_add_f32 v196, v192, v193
    v_cvt_pk_bf16_f32 v128, v192, v193
    v_mfma_f32_16x16x32_bf16 v[120:123], v[168:171], v[88:91], v[120:123]
    ds_read_b64_tr_b16 v[168:169], v210 offset:27648
    ds_read_b64_tr_b16 v[170:171], v210 offset:32256
    v_exp_f32 v192, v100
    s_waitcnt lgkmcnt(10)
    v_mfma_f32_16x16x32_bf16 v[112:115], v[172:175], v[76:79], v[112:115]
    v_exp_f32 v193, v101
    v_mfma_f32_16x16x32_bf16 v[120:123], v[172:175], v[92:95], v[120:123]
    ds_read_b64_tr_b16 v[172:173], v211 offset:27648
    ds_read_b64_tr_b16 v[174:175], v211 offset:32256
    v_add_f32 v196, v196, v194
    v_add_f32 v196, v196, v195
    s_waitcnt lgkmcnt(11)
    v_mfma_f32_16x16x32_bf16 v[116:119], v[176:179], v[64:67], v[144:147]
    v_cvt_pk_bf16_f32 v129, v194, v195
    v_mfma_f32_16x16x32_bf16 v[124:127], v[176:179], v[80:83], v[148:151]
    ds_read_b64_tr_b16 v[176:177], v208 offset:27776
    ds_read_b64_tr_b16 v[178:179], v208 offset:32384
    v_exp_f32 v194, v102
    s_waitcnt lgkmcnt(12)
    v_mfma_f32_16x16x32_bf16 v[116:119], v[180:183], v[68:71], v[116:119]
    v_exp_f32 v195, v103
    v_mfma_f32_16x16x32_bf16 v[124:127], v[180:183], v[84:87], v[124:127]
    ds_read_b64_tr_b16 v[180:181], v209 offset:27776
    ds_read_b64_tr_b16 v[182:183], v209 offset:32384
    v_add_f32 v196, v196, v192
    v_add_f32 v196, v196, v193
    s_waitcnt lgkmcnt(13)
    v_mfma_f32_16x16x32_bf16 v[116:119], v[184:187], v[72:75], v[116:119]
    v_cvt_pk_bf16_f32 v130, v192, v193
    v_mfma_f32_16x16x32_bf16 v[124:127], v[184:187], v[88:91], v[124:127]
    ds_read_b64_tr_b16 v[184:185], v210 offset:27776
    ds_read_b64_tr_b16 v[186:187], v210 offset:32384
    v_exp_f32 v192, v104
    s_waitcnt lgkmcnt(14)
    v_mfma_f32_16x16x32_bf16 v[116:119], v[188:191], v[76:79], v[116:119]
    v_exp_f32 v193, v105
    v_mfma_f32_16x16x32_bf16 v[124:127], v[188:191], v[92:95], v[124:127]
    ds_read_b64_tr_b16 v[188:189], v211 offset:27776
    ds_read_b64_tr_b16 v[190:191], v211 offset:32384
    s_waitcnt lgkmcnt(14)
    v_mfma_f32_16x16x32_bf16 v[0:3], v[160:163], v[136:139], v[0:3]
    v_add_f32 v196, v196, v194
    v_add_f32 v196, v196, v195
    v_mfma_f32_16x16x32_bf16 v[4:7], v[160:163], v[140:143], v[4:7]
    s_waitcnt vmcnt(4)
    s_barrier
    ds_read_b128 v[160:163], v200 offset:0
    v_cvt_pk_bf16_f32 v131, v194, v195
    s_waitcnt lgkmcnt(13)
    v_mfma_f32_16x16x32_bf16 v[8:11], v[164:167], v[136:139], v[8:11]
    v_exp_f32 v194, v106
    s_add_u32 m0, s25, 32768
    s_add_u32 s35, s24, 0
    buffer_load_dwordx4 v212, s[8:11], s35 offen lds
    v_mfma_f32_16x16x32_bf16 v[12:15], v[164:167], v[140:143], v[12:15]
    ds_read_b128 v[164:167], v201 offset:0
    v_exp_f32 v195, v107
    s_waitcnt lgkmcnt(12)
    v_mfma_f32_16x16x32_bf16 v[16:19], v[168:171], v[136:139], v[16:19]
    v_add_f32 v197, v192, v193
    v_cvt_pk_bf16_f32 v132, v192, v193
    s_add_u32 m0, s25, 40960
    s_add_u32 s35, s24, 8192
    buffer_load_dwordx4 v212, s[8:11], s35 offen lds
    v_mfma_f32_16x16x32_bf16 v[20:23], v[168:171], v[140:143], v[20:23]
    ds_read_b128 v[168:171], v202 offset:0
    v_exp_f32 v192, v108
    s_waitcnt lgkmcnt(11)
    v_mfma_f32_16x16x32_bf16 v[24:27], v[172:175], v[136:139], v[24:27]
    v_exp_f32 v193, v109
    s_add_u32 m0, s26, 36864
    s_sub_u32 s35, s24, 16384
    buffer_load_dwordx4 v213, s[12:15], s35 offen lds
    v_mfma_f32_16x16x32_bf16 v[28:31], v[172:175], v[140:143], v[28:31]
    ds_read_b128 v[172:175], v203 offset:0
    v_add_f32 v197, v197, v194
    v_add_f32 v197, v197, v195
    s_waitcnt lgkmcnt(10)
    v_mfma_f32_16x16x32_bf16 v[32:35], v[176:179], v[136:139], v[32:35]
    v_cvt_pk_bf16_f32 v133, v194, v195
    s_add_u32 m0, s26, 46080
    s_sub_u32 s35, s24, 8192
    buffer_load_dwordx4 v213, s[12:15], s35 offen lds
    v_mfma_f32_16x16x32_bf16 v[36:39], v[176:179], v[140:143], v[36:39]
    ds_read_b128 v[176:179], v200 offset:4096
    v_exp_f32 v194, v110
    s_waitcnt lgkmcnt(9)
    v_mfma_f32_16x16x32_bf16 v[40:43], v[180:183], v[136:139], v[40:43]
    v_exp_f32 v195, v111
    s_add_u32 s24, s24, 16384
    v_mfma_f32_16x16x32_bf16 v[44:47], v[180:183], v[140:143], v[44:47]
    ds_read_b128 v[180:183], v201 offset:4096
    v_add_f32 v197, v197, v192
    v_add_f32 v197, v197, v193
    s_waitcnt lgkmcnt(8)
    v_mfma_f32_16x16x32_bf16 v[48:51], v[184:187], v[136:139], v[48:51]
    v_cvt_pk_bf16_f32 v134, v192, v193
    v_mfma_f32_16x16x32_bf16 v[52:55], v[184:187], v[140:143], v[52:55]
    ds_read_b128 v[184:187], v202 offset:4096
    v_add_f32 v197, v197, v194
    v_add_f32 v197, v197, v195
    s_waitcnt lgkmcnt(7)
    v_mfma_f32_16x16x32_bf16 v[56:59], v[188:191], v[136:139], v[56:59]
    v_cvt_pk_bf16_f32 v135, v194, v195
    v_mfma_f32_16x16x32_bf16 v[60:63], v[188:191], v[140:143], v[60:63]
    ds_read_b128 v[188:191], v203 offset:4096
    v_max_f32 v192, v196, v197
    v_cmp_lt_f32 vcc, s36, v192
    s_cbranch_vccz L_at_ok14
    s_call_b64 s[38:39], L_at_rare0
L_at_ok14:
    v_add_f32 v198, v198, v196
    v_add_f32 v199, v199, v197
    s_sub_u32 s27, s27, 1
    s_cmp_lg_u32 s27, 0
    s_cbranch_scc1 L_at_loop
    s_waitcnt lgkmcnt(0)
    ds_read_b64_tr_b16 v[160:161], v204 offset:0
    ds_read_b64_tr_b16 v[162:163], v204 offset:4608
    ds_read_b64_tr_b16 v[164:165], v205 offset:0
    ds_read_b64_tr_b16 v[166:167], v205 offset:4608
    ds_read_b64_tr_b16 v[168:169], v206 offset:0
    ds_read_b64_tr_b16 v[170:171], v206 offset:4608
    ds_read_b64_tr_b16 v[172:173], v207 offset:0
    ds_read_b64_tr_b16 v[174:175], v207 offset:4608
    ds_read_b64_tr_b16 v[176:177], v204 offset:128
    ds_read_b64_tr_b16 v[178:179], v204 offset:4736
    ds_read_b64_tr_b16 v[180:181], v205 offset:128
    ds_read_b64_tr_b16 v[182:183], v205 offset:4736
    ds_read_b64_tr_b16 v[184:185], v206 offset:128
    ds_read_b64_tr_b16 v[186:187], v206 offset:4736
    ds_read_b64_tr_b16 v[188:189], v207 offset:128
    ds_read_b64_tr_b16 v[190:191], v207 offset:4736
    s_waitcnt lgkmcnt(14)
    v_mfma_f32_16x16x32_bf16 v[0:3], v[160:163], v[128:131], v[0:3]
    v_exp_f32 v192, v112
    v_exp_f32 v193, v113
    v_mfma_f32_16x16x32_bf16 v[4:7], v[160:163], v[132:135], v[4:7]
    ds_read_b64_tr_b16 v[160:161], v204 offset:9216
    ds_read_b64_tr_b16 v[162:163], v204 offset:13824
    v_exp_f32 v194, v114
    v_exp_f32 v195, v115
    s_waitcnt lgkmcnt(14)
    v_mfma_f32_16x16x32_bf16 v[8:11], v[164:167], v[128:131], v[8:11]
    v_add_f32 v196, v192, v193
    v_cvt_pk_bf16_f32 v136, v192, v193
    v_exp_f32 v192, v116
    v_mfma_f32_16x16x32_bf16 v[12:15], v[164:167], v[132:135], v[12:15]
    ds_read_b64_tr_b16 v[164:165], v205 offset:9216
    ds_read_b64_tr_b16 v[166:167], v205 offset:13824
    v_exp_f32 v193, v117
    v_add_f32 v196, v196, v194
    v_add_f32 v196, v196, v195
    s_waitcnt lgkmcnt(14)
    v_mfma_f32_16x16x32_bf16 v[16:19], v[168:171], v[128:131], v[16:19]
    v_cvt_pk_bf16_f32 v137, v194, v195
    v_exp_f32 v194, v118
    v_mfma_f32_16x16x32_bf16 v[20:23], v[168:171], v[132:135], v[20:23]
    ds_read_b64_tr_b16 v[168:169], v206 offset:9216
    ds_read_b64_tr_b16 v[170:171], v206 offset:13824
    v_exp_f32 v195, v119
    v_add_f32 v196, v196, v192
    v_add_f32 v196, v196, v193
    s_waitcnt lgkmcnt(14)
    v_mfma_f32_16x16x32_bf16 v[24:27], v[172:175], v[128:131], v[24:27]
    v_cvt_pk_bf16_f32 v138, v192, v193
    v_exp_f32 v192, v120
    v_mfma_f32_16x16x32_bf16 v[28:31], v[172:175], v[132:135], v[28:31]
    ds_read_b64_tr_b16 v[172:173], v207 offset:9216
    ds_read_b64_tr_b16 v[174:175], v207 offset:13824
    v_exp_f32 v193, v121
    s_waitcnt lgkmcnt(14)
    v_mfma_f32_16x16x32_bf16 v[32:35], v[176:179], v[128:131], v[32:35]
    v_add_f32 v196, v196, v194
    v_add_f32 v196, v196, v195
    v_cvt_pk_bf16_f32 v139, v194, v195
    v_mfma_f32_16x16x32_bf16 v[36:39], v[176:179], v[132:135], v[36:39]
    ds_read_b64_tr_b16 v[176:177], v204 offset:9344
    ds_read_b64_tr_b16 v[178:179], v204 offset:13952
    v_exp_f32 v194, v122
    v_exp_f32 v195, v123
    s_waitcnt lgkmcnt(14)
    v_mfma_f32_16x16x32_bf16 v[40:43], v[180:183], v[128:131], v[40:43]
    v_add_f32 v197, v192, v193
    v_cvt_pk_bf16_f32 v140, v192, v193
    v_exp_f32 v192, v124
    v_mfma_f32_16x16x32_bf16 v[44:47], v[180:183], v[132:135], v[44:47]
    ds_read_b64_tr_b16 v[180:181], v205 offset:9344
    ds_read_b64_tr_b16 v[182:183], v205 offset:13952
    v_exp_f32 v193, v125
    v_add_f32 v197, v197, v194
    v_add_f32 v197, v197, v195
    s_waitcnt lgkmcnt(14)
    v_mfma_f32_16x16x32_bf16 v[48:51], v[184:187], v[128:131], v[48:51]
    v_cvt_pk_bf16_f32 v141, v194, v195
    v_exp_f32 v194, v126
    v_mfma_f32_16x16x32_bf16 v[52:55], v[184:187], v[132:135], v[52:55]
    ds_read_b64_tr_b16 v[184:185], v206 offset:9344
    ds_read_b64_tr_b16 v[186:187], v206 offset:13952
    v_exp_f32 v195, v127
    v_add_f32 v197, v197, v192
    v_add_f32 v197, v197, v193
    s_waitcnt lgkmcnt(14)
    v_mfma_f32_16x16x32_bf16 v[56:59], v[188:191], v[128:131], v[56:59]
    v_cvt_pk_bf16_f32 v142, v192, v193
    v_add_f32 v197, v197, v194
    v_add_f32 v197, v197, v195
    v_mfma_f32_16x16x32_bf16 v[60:63], v[188:191], v[132:135], v[60:63]
    ds_read_b64_tr_b16 v[188:189], v207 offset:9344
    ds_read_b64_tr_b16 v[190:191], v207 offset:13952
    v_cvt_pk_bf16_f32 v143, v194, v195
    v_max_f32 v192, v196, v197
    v_cmp_lt_f32 vcc, s36, v192
    s_cbranch_vccz L_at_ok15
    s_call_b64 s[38:39], L_at_rare1
L_at_ok15:
    v_add_f32 v198, v198, v196
    v_add_f32 v199, v199, v197
    s_waitcnt lgkmcnt(14)
    v_mfma_f32_16x16x32_bf16 v[0:3], v[160:163], v[136:139], v[0:3]
    v_mfma_f32_16x16x32_bf16 v[4:7], v[160:163], v[140:143], v[4:7]
    s_waitcnt lgkmcnt(12)
    v_mfma_f32_16x16x32_bf16 v[8:11], v[164:167], v[136:139], v[8:11]
    v_mfma_f32_16x16x32_bf16 v[12:15], v[164:167], v[140:143], v[12:15]
    s_waitcnt lgkmcnt(10)
    v_mfma_f32_16x16x32_bf16 v[16:19], v[168:171], v[136:139], v[16:19]
    v_mfma_f32_16x16x32_bf16 v[20:23], v[168:171], v[140:143], v[20:23]
    s_waitcnt lgkmcnt(8)
    v_mfma_f32_16x16x32_bf16 v[24:27], v[172:175], v[136:139], v[24:27]
    v_mfma_f32_16x16x32_bf16 v[28:31], v[172:175], v[140:143], v[28:31]
    s_waitcnt lgkmcnt(6)
    v_mfma_f32_16x16x32_bf16 v[32:35], v[176:179], v[136:139], v[32:35]
    v_mfma_f32_16x16x32_bf16 v[36:39], v[176:179], v[140:143], v[36:39]
    s_waitcnt lgkmcnt(4)
    v_mfma_f32_16x16x32_bf16 v[40:43], v[180:183], v[136:139], v[40:43]
    v_mfma_f32_16x16x32_bf16 v[44:47], v[180:183], v[140:143], v[44:47]
    s_waitcnt lgkmcnt(2)
    v_mfma_f32_16x16x32_bf16 v[48:51], v[184:187], v[136:139], v[48:51]
    v_mfma_f32_16x16x32_bf16 v[52:55], v[184:187], v[140:143], v[52:55]
    s_waitcnt lgkmcnt(0)
    v_mfma_f32_16x16x32_bf16 v[56:59], v[188:191], v[136:139], v[56:59]
    v_mfma_f32_16x16x32_bf16 v[60:63], v[188:191], v[140:143], v[60:63]
    s_waitcnt vmcnt(0)
    s_cmp_lt_u32 s2, 224
    s_cbranch_scc1 L_at_gu2
    s_nop 7
    v_mov_b32 v217, v198
    s_nop 1
    v_permlane16_swap_b32 v217, v198
    v_add_f32 v198, v198, v217
    v_mov_b32 v217, v198
    s_nop 1
    v_permlane32_swap_b32 v217, v198
    v_add_f32 v198, v198, v217
    v_rcp_f32 v218, v198
    v_mov_b32 v217, v199
    s_nop 1
    v_permlane16_swap_b32 v217, v199
    v_add_f32 v199, v199, v217
    v_mov_b32 v217, v199
    s_nop 1
    v_permlane32_swap_b32 v217, v199
    v_add_f32 v199, v199, v217
    v_rcp_f32 v219, v199
    s_nop 0
    v_mul_f32 v0, v0, v218
    v_mul_f32 v8, v8, v218
    v_mul_f32 v1, v1, v218
    v_mul_f32 v9, v9, v218
    v_mul_f32 v2, v2, v218
    v_mul_f32 v10, v10, v218
    v_mul_f32 v3, v3, v218
    v_mul_f32 v11, v11, v218
    v_cvt_pk_bf16_f32 v96, v0, v1
    v_cvt_pk_bf16_f32 v97, v2, v3
    v_cvt_pk_bf16_f32 v98, v8, v9
    v_cvt_pk_bf16_f32 v99, v10, v11
    s_mov_b32 s63, 0
    s_nop 0
    v_permlane16_swap_b32 v96, v98
    v_permlane16_swap_b32 v97, v99
    buffer_store_dwordx4 v[96:99], v220, s[64:67], s63 offen
    v_mul_f32 v16, v16, v218
    v_mul_f32 v24, v24, v218
    v_mul_f32 v17, v17, v218
    v_mul_f32 v25, v25, v218
    v_mul_f32 v18, v18, v218
    v_mul_f32 v26, v26, v218
    v_mul_f32 v19, v19, v218
    v_mul_f32 v27, v27, v218
    v_cvt_pk_bf16_f32 v100, v16, v17
    v_cvt_pk_bf16_f32 v101, v18, v19
    v_cvt_pk_bf16_f32 v102, v24, v25
    v_cvt_pk_bf16_f32 v103, v26, v27
    s_mov_b32 s63, 1024
    s_nop 0
    v_permlane16_swap_b32 v100, v102
    v_permlane16_swap_b32 v101, v103
    buffer_store_dwordx4 v[100:103], v220, s[64:67], s63 offen
    v_mul_f32 v32, v32, v218
    v_mul_f32 v40, v40, v218
    v_mul_f32 v33, v33, v218
    v_mul_f32 v41, v41, v218
    v_mul_f32 v34, v34, v218
    v_mul_f32 v42, v42, v218
    v_mul_f32 v35, v35, v218
    v_mul_f32 v43, v43, v218
    v_cvt_pk_bf16_f32 v104, v32, v33
    v_cvt_pk_bf16_f32 v105, v34, v35
    v_cvt_pk_bf16_f32 v106, v40, v41
    v_cvt_pk_bf16_f32 v107, v42, v43
    s_mov_b32 s63, 2048
    s_nop 0
    v_permlane16_swap_b32 v104, v106
    v_permlane16_swap_b32 v105, v107
    buffer_store_dwordx4 v[104:107], v220, s[64:67], s63 offen
    v_mul_f32 v48, v48, v218
    v_mul_f32 v56, v56, v218
    v_mul_f32 v49, v49, v218
    v_mul_f32 v57, v57, v218
    v_mul_f32 v50, v50, v218
    v_mul_f32 v58, v58, v218
    v_mul_f32 v51, v51, v218
    v_mul_f32 v59, v59, v218
    v_cvt_pk_bf16_f32 v108, v48, v49
    v_cvt_pk_bf16_f32 v109, v50, v51
    v_cvt_pk_bf16_f32 v110, v56, v57
    v_cvt_pk_bf16_f32 v111, v58, v59
    s_mov_b32 s63, 3072
    s_nop 0
    v_permlane16_swap_b32 v108, v110
    v_permlane16_swap_b32 v109, v111
    buffer_store_dwordx4 v[108:111], v220, s[64:67], s63 offen
    v_mul_f32 v4, v4, v219
    v_mul_f32 v12, v12, v219
    v_mul_f32 v5, v5, v219
    v_mul_f32 v13, v13, v219
    v_mul_f32 v6, v6, v219
    v_mul_f32 v14, v14, v219
    v_mul_f32 v7, v7, v219
    v_mul_f32 v15, v15, v219
    v_cvt_pk_bf16_f32 v112, v4, v5
    v_cvt_pk_bf16_f32 v113, v6, v7
    v_cvt_pk_bf16_f32 v114, v12, v13
    v_cvt_pk_bf16_f32 v115, v14, v15
    s_mov_b32 s63, 131072
    s_nop 0
    v_permlane16_swap_b32 v112, v114
    v_permlane16_swap_b32 v113, v115
    buffer_store_dwordx4 v[112:115], v220, s[64:67], s63 offen
    v_mul_f32 v20, v20, v219
    v_mul_f32 v28, v28, v219
    v_mul_f32 v21, v21, v219
    v_mul_f32 v29, v29, v219
    v_mul_f32 v22, v22, v219
    v_mul_f32 v30, v30, v219
    v_mul_f32 v23, v23, v219
    v_mul_f32 v31, v31, v219
    v_cvt_pk_bf16_f32 v116, v20, v21
    v_cvt_pk_bf16_f32 v117, v22, v23
    v_cvt_pk_bf16_f32 v118, v28, v29
    v_cvt_pk_bf16_f32 v119, v30, v31
    s_mov_b32 s63, 132096
    s_nop 0
    v_permlane16_swap_b32 v116, v118
    v_permlane16_swap_b32 v117, v119
    buffer_store_dwordx4 v[116:119], v220, s[64:67], s63 offen
    v_mul_f32 v36, v36, v219
    v_mul_f32 v44, v44, v219
    v_mul_f32 v37, v37, v219
    v_mul_f32 v45, v45, v219
    v_mul_f32 v38, v38, v219
    v_mul_f32 v46, v46, v219
    v_mul_f32 v39, v39, v219
    v_mul_f32 v47, v47, v219
    v_cvt_pk_bf16_f32 v120, v36, v37
    v_cvt_pk_bf16_f32 v121, v38, v39
    v_cvt_pk_bf16_f32 v122, v44, v45
    v_cvt_pk_bf16_f32 v123, v46, v47
    s_mov_b32 s63, 133120
    s_nop 0
    v_permlane16_swap_b32 v120, v122
    v_permlane16_swap_b32 v121, v123
    buffer_store_dwordx4 v[120:123], v220, s[64:67], s63 offen
    v_mul_f32 v52, v52, v219
    v_mul_f32 v60, v60, v219
    v_mul_f32 v53, v53, v219
    v_mul_f32 v61, v61, v219
    v_mul_f32 v54, v54, v219
    v_mul_f32 v62, v62, v219
    v_mul_f32 v55, v55, v219
    v_mul_f32 v63, v63, v219
    v_cvt_pk_bf16_f32 v124, v52, v53
    v_cvt_pk_bf16_f32 v125, v54, v55
    v_cvt_pk_bf16_f32 v126, v60, v61
    v_cvt_pk_bf16_f32 v127, v62, v63
    s_mov_b32 s63, 134144
    s_nop 0
    v_permlane16_swap_b32 v124, v126
    v_permlane16_swap_b32 v125, v127
    buffer_store_dwordx4 v[124:127], v220, s[64:67], s63 offen
L_at_done:
    s_endpgm
L_at_rare0:
    s_nop 7
    v_max3_f32 v216, v96, v97, v98
    v_max3_f32 v216, v216, v99, v100
    v_max3_f32 v216, v216, v101, v102
    v_max_f32 v216, v216, v103
    v_mov_b32 v217, v216
    s_nop 1
    v_permlane16_swap_b32 v217, v216
    v_max_f32 v216, v216, v217
    v_mov_b32 v217, v216
    s_nop 1
    v_permlane32_swap_b32 v217, v216
    v_max_f32 v216, v216, v217
    v_max_f32 v216, 0, v216
    v_sub_f32 v217, 0, v216
    v_exp_f32 v217, v217
    v_sub_f32 v144, v144, v216
    v_sub_f32 v145, v145, v216
    v_sub_f32 v146, v146, v216
    v_sub_f32 v147, v147, v216
    v_sub_f32 v96, v96, v216
    v_sub_f32 v112, v112, v216
    v_sub_f32 v97, v97, v216
    v_sub_f32 v113, v113, v216
    v_sub_f32 v98, v98, v216
    v_sub_f32 v114, v114, v216
    v_sub_f32 v99, v99, v216
    v_sub_f32 v115, v115, v216
    v_sub_f32 v100, v100, v216
    v_sub_f32 v116, v116, v216
    v_sub_f32 v101, v101, v216
    v_sub_f32 v117, v117, v216
    v_sub_f32 v102, v102, v216
    v_sub_f32 v118, v118, v216
    v_sub_f32 v103, v103, v216
    v_sub_f32 v119, v119, v216
    v_mul_f32 v0, v0, v217
    v_mul_f32 v1, v1, v217
    v_mul_f32 v2, v2, v217
    v_mul_f32 v3, v3, v217
    v_mul_f32 v8, v8, v217
    v_mul_f32 v9, v9, v217
    v_mul_f32 v10, v10, v217
    v_mul_f32 v11, v11, v217
    v_mul_f32 v16, v16, v217
    v_mul_f32 v17, v17, v217
    v_mul_f32 v18, v18, v217
    v_mul_f32 v19, v19, v217
    v_mul_f32 v24, v24, v217
    v_mul_f32 v25, v25, v217
    v_mul_f32 v26, v26, v217
    v_mul_f32 v27, v27, v217
    v_mul_f32 v32, v32, v217
    v_mul_f32 v33, v33, v217
    v_mul_f32 v34, v34, v217
    v_mul_f32 v35, v35, v217
    v_mul_f32 v40, v40, v217
    v_mul_f32 v41, v41, v217
    v_mul_f32 v42, v42, v217
    v_mul_f32 v43, v43, v217
    v_mul_f32 v48, v48, v217
    v_mul_f32 v49, v49, v217
    v_mul_f32 v50, v50, v217
    v_mul_f32 v51, v51, v217
    v_mul_f32 v56, v56, v217
    v_mul_f32 v57, v57, v217
    v_mul_f32 v58, v58, v217
    v_mul_f32 v59, v59, v217
    v_mul_f32 v198, v198, v217
    v_max3_f32 v216, v104, v105, v106
    v_max3_f32 v216, v216, v107, v108
    v_max3_f32 v216, v216, v109, v110
    v_max_f32 v216, v216, v111
    v_mov_b32 v217, v216
    s_nop 1
    v_permlane16_swap_b32 v217, v216
    v_max_f32 v216, v216, v217
    v_mov_b32 v217, v216
    s_nop 1
    v_permlane32_swap_b32 v217, v216
    v_max_f32 v216, v216, v217
    v_max_f32 v216, 0, v216
    v_sub_f32 v217, 0, v216
    v_exp_f32 v217, v217
    v_sub_f32 v148, v148, v216
    v_sub_f32 v149, v149, v216
    v_sub_f32 v150, v150, v216
    v_sub_f32 v151, v151, v216
    v_sub_f32 v104, v104, v216
    v_sub_f32 v120, v120, v216
    v_sub_f32 v105, v105, v216
    v_sub_f32 v121, v121, v216
    v_sub_f32 v106, v106, v216
    v_sub_f32 v122, v122, v216
    v_sub_f32 v107, v107, v216
    v_sub_f32 v123, v123, v216
    v_sub_f32 v108, v108, v216
    v_sub_f32 v124, v124, v216
    v_sub_f32 v109, v109, v216
    v_sub_f32 v125, v125, v216
    v_sub_f32 v110, v110, v216
    v_sub_f32 v126, v126, v216
    v_sub_f32 v111, v111, v216
    v_sub_f32 v127, v127, v216
    v_mul_f32 v4, v4, v217
    v_mul_f32 v5, v5, v217
    v_mul_f32 v6, v6, v217
    v_mul_f32 v7, v7, v217
    v_mul_f32 v12, v12, v217
    v_mul_f32 v13, v13, v217
    v_mul_f32 v14, v14, v217
    v_mul_f32 v15, v15, v217
    v_mul_f32 v20, v20, v217
    v_mul_f32 v21, v21, v217
    v_mul_f32 v22, v22, v217
    v_mul_f32 v23, v23, v217
    v_mul_f32 v28, v28, v217
    v_mul_f32 v29, v29, v217
    v_mul_f32 v30, v30, v217
    v_mul_f32 v31, v31, v217
    v_mul_f32 v36, v36, v217
    v_mul_f32 v37, v37, v217
    v_mul_f32 v38, v38, v217
    v_mul_f32 v39, v39, v217
    v_mul_f32 v44, v44, v217
    v_mul_f32 v45, v45, v217
    v_mul_f32 v46, v46, v217
    v_mul_f32 v47, v47, v217
    v_mul_f32 v52, v52, v217
    v_mul_f32 v53, v53, v217
    v_mul_f32 v54, v54, v217
    v_mul_f32 v55, v55, v217
    v_mul_f32 v60, v60, v217
    v_mul_f32 v61, v61, v217
    v_mul_f32 v62, v62, v217
    v_mul_f32 v63, v63, v217
    v_mul_f32 v199, v199, v217
    v_exp_f32 v192, v96
    s_nop 0
    v_exp_f32 v193, v97
    s_nop 0
    v_exp_f32 v194, v98
    s_nop 0
    v_exp_f32 v195, v99
    s_nop 0
    v_add_f32 v196, v192, v193
    v_cvt_pk_bf16_f32 v128, v192, v193
    v_exp_f32 v192, v100
    s_nop 0
    v_exp_f32 v193, v101
    s_nop 0
    v_add_f32 v196, v196, v194
    v_add_f32 v196, v196, v195
    v_cvt_pk_bf16_f32 v129, v194, v195
    v_exp_f32 v194, v102
    s_nop 0
    v_exp_f32 v195, v103
    s_nop 0
    v_add_f32 v196, v196, v192
    v_add_f32 v196, v196, v193
    v_cvt_pk_bf16_f32 v130, v192, v193
    v_exp_f32 v192, v104
    s_nop 0
    v_exp_f32 v193, v105
    s_nop 0
    v_add_f32 v196, v196, v194
    v_add_f32 v196, v196, v195
    v_cvt_pk_bf16_f32 v131, v194, v195
    v_exp_f32 v194, v106
    s_nop 0
    v_exp_f32 v195, v107
    s_nop 0
    v_add_f32 v197, v192, v193
    v_cvt_pk_bf16_f32 v132, v192, v193
    v_exp_f32 v192, v108
    s_nop 0
    v_exp_f32 v193, v109
    s_nop 0
    v_add_f32 v197, v197, v194
    v_add_f32 v197, v197, v195
    v_cvt_pk_bf16_f32 v133, v194, v195
    v_exp_f32 v194, v110
    s_nop 0
    v_exp_f32 v195, v111
    s_nop 0
    v_add_f32 v197, v197, v192
    v_add_f32 v197, v197, v193
    v_cvt_pk_bf16_f32 v134, v192, v193
    v_add_f32 v197, v197, v194
    v_add_f32 v197, v197, v195
    v_cvt_pk_bf16_f32 v135, v194, v195
    s_nop 1
    s_setpc_b64 s[38:39]
L_at_rare1:
    s_nop 7
    v_max3_f32 v216, v112, v113, v114
    v_max3_f32 v216, v216, v115, v116
    v_max3_f32 v216, v216, v117, v118
    v_max_f32 v216, v216, v119
    v_mov_b32 v217, v216
    s_nop 1
    v_permlane16_swap_b32 v217, v216
    v_max_f32 v216, v216, v217
    v_mov_b32 v217, v216
    s_nop 1
    v_permlane32_swap_b32 v217, v216
    v_max_f32 v216, v216, v217
    v_max_f32 v216, 0, v216
    v_sub_f32 v217, 0, v216
    v_exp_f32 v217, v217
    v_sub_f32 v144, v144, v216
    v_sub_f32 v145, v145, v216
    v_sub_f32 v146, v146, v216
    v_sub_f32 v147, v147, v216
    v_sub_f32 v112, v112, v216
    v_sub_f32 v96, v96, v216
    v_sub_f32 v113, v113, v216
    v_sub_f32 v97, v97, v216
    v_sub_f32 v114, v114, v216
    v_sub_f32 v98, v98, v216
    v_sub_f32 v115, v115, v216
    v_sub_f32 v99, v99, v216
    v_sub_f32 v116, v116, v216
    v_sub_f32 v100, v100, v216
    v_sub_f32 v117, v117, v216
    v_sub_f32 v101, v101, v216
    v_sub_f32 v118, v118, v216
    v_sub_f32 v102, v102, v216
    v_sub_f32 v119, v119, v216
    v_sub_f32 v103, v103, v216
    v_mul_f32 v0, v0, v217
    v_mul_f32 v1, v1, v217
    v_mul_f32 v2, v2, v217
    v_mul_f32 v3, v3, v217
    v_mul_f32 v8, v8, v217
    v_mul_f32 v9, v9, v217
    v_mul_f32 v10, v10, v217
    v_mul_f32 v11, v11, v217
    v_mul_f32 v16, v16, v217
    v_mul_f32 v17, v17, v217
    v_mul_f32 v18, v18, v217
    v_mul_f32 v19, v19, v217
    v_mul_f32 v24, v24, v217
    v_mul_f32 v25, v25, v217
    v_mul_f32 v26, v26, v217
    v_mul_f32 v27, v27, v217
    v_mul_f32 v32, v32, v217
    v_mul_f32 v33, v33, v217
    v_mul_f32 v34, v34, v217
    v_mul_f32 v35, v35, v217
    v_mul_f32 v40, v40, v217
    v_mul_f32 v41, v41, v217
    v_mul_f32 v42, v42, v217
    v_mul_f32 v43, v43, v217
    v_mul_f32 v48, v48, v217
    v_mul_f32 v49, v49, v217
    v_mul_f32 v50, v50, v217
    v_mul_f32 v51, v51, v217
    v_mul_f32 v56, v56, v217
    v_mul_f32 v57, v57, v217
    v_mul_f32 v58, v58, v217
    v_mul_f32 v59, v59, v217
    v_mul_f32 v198, v198, v217
    v_max3_f32 v216, v120, v121, v122
    v_max3_f32 v216, v216, v123, v124
    v_max3_f32 v216, v216, v125, v126
    v_max_f32 v216, v216, v127
    v_mov_b32 v217, v216
    s_nop 1
    v_permlane16_swap_b32 v217, v216
    v_max_f32 v216, v216, v217
    v_mov_b32 v217, v216
    s_nop 1
    v_permlane32_swap_b32 v217, v216
    v_max_f32 v216, v216, v217
    v_max_f32 v216, 0, v216
    v_sub_f32 v217, 0, v216
    v_exp_f32 v217, v217
    v_sub_f32 v148, v148, v216
    v_sub_f32 v149, v149, v216
    v_sub_f32 v150, v150, v216
    v_sub_f32 v151, v151, v216
    v_sub_f32 v120, v120, v216
    v_sub_f32 v104, v104, v216
    v_sub_f32 v121, v121, v216
    v_sub_f32 v105, v105, v216
    v_sub_f32 v122, v122, v216
    v_sub_f32 v106, v106, v216
    v_sub_f32 v123, v123, v216
    v_sub_f32 v107, v107, v216
    v_sub_f32 v124, v124, v216
    v_sub_f32 v108, v108, v216
    v_sub_f32 v125, v125, v216
    v_sub_f32 v109, v109, v216
    v_sub_f32 v126, v126, v216
    v_sub_f32 v110, v110, v216
    v_sub_f32 v127, v127, v216
    v_sub_f32 v111, v111, v216
    v_mul_f32 v4, v4, v217
    v_mul_f32 v5, v5, v217
    v_mul_f32 v6, v6, v217
    v_mul_f32 v7, v7, v217
    v_mul_f32 v12, v12, v217
    v_mul_f32 v13, v13, v217
    v_mul_f32 v14, v14, v217
    v_mul_f32 v15, v15, v217
    v_mul_f32 v20, v20, v217
    v_mul_f32 v21, v21, v217
    v_mul_f32 v22, v22, v217
    v_mul_f32 v23, v23, v217
    v_mul_f32 v28, v28, v217
    v_mul_f32 v29, v29, v217
    v_mul_f32 v30, v30, v217
    v_mul_f32 v31, v31, v217
    v_mul_f32 v36, v36, v217
    v_mul_f32 v37, v37, v217
    v_mul_f32 v38, v38, v217
    v_mul_f32 v39, v39, v217
    v_mul_f32 v44, v44, v217
    v_mul_f32 v45, v45, v217
    v_mul_f32 v46, v46, v217
    v_mul_f32 v47, v47, v217
    v_mul_f32 v52, v52, v217
    v_mul_f32 v53, v53, v217
    v_mul_f32 v54, v54, v217
    v_mul_f32 v55, v55, v217
    v_mul_f32 v60, v60, v217
    v_mul_f32 v61, v61, v217
    v_mul_f32 v62, v62, v217
    v_mul_f32 v63, v63, v217
    v_mul_f32 v199, v199, v217
    v_exp_f32 v192, v112
    s_nop 0
    v_exp_f32 v193, v113
    s_nop 0
    v_exp_f32 v194, v114
    s_nop 0
    v_exp_f32 v195, v115
    s_nop 0
    v_add_f32 v196, v192, v193
    v_cvt_pk_bf16_f32 v136, v192, v193
    v_exp_f32 v192, v116
    s_nop 0
    v_exp_f32 v193, v117
    s_nop 0
    v_add_f32 v196, v196, v194
    v_add_f32 v196, v196, v195
    v_cvt_pk_bf16_f32 v137, v194, v195
    v_exp_f32 v194, v118
    s_nop 0
    v_exp_f32 v195, v119
    s_nop 0
    v_add_f32 v196, v196, v192
    v_add_f32 v196, v196, v193
    v_cvt_pk_bf16_f32 v138, v192, v193
    v_exp_f32 v192, v120
    s_nop 0
    v_exp_f32 v193, v121
    s_nop 0
    v_add_f32 v196, v196, v194
    v_add_f32 v196, v196, v195
    v_cvt_pk_bf16_f32 v139, v194, v195
    v_exp_f32 v194, v122
    s_nop 0
    v_exp_f32 v195, v123
    s_nop 0
    v_add_f32 v197, v192, v193
    v_cvt_pk_bf16_f32 v140, v192, v193
    v_exp_f32 v192, v124
    s_nop 0
    v_exp_f32 v193, v125
    s_nop 0
    v_add_f32 v197, v197, v194
    v_add_f32 v197, v197, v195
    v_cvt_pk_bf16_f32 v141, v194, v195
    v_exp_f32 v194, v126
    s_nop 0
    v_exp_f32 v195, v127
    s_nop 0
    v_add_f32 v197, v197, v192
    v_add_f32 v197, v197, v193
    v_cvt_pk_bf16_f32 v142, v192, v193
    v_add_f32 v197, v197, v194
    v_add_f32 v197, v197, v195
    v_cvt_pk_bf16_f32 v143, v194, v195
    s_nop 1
    s_setpc_b64 s[38:39]
L_at_gu2:
    s_barrier
    s_load_dwordx2 s[4:5], s[0:1], 88
    s_load_dwordx2 s[6:7], s[0:1], 48
    s_load_dwordx2 s[28:29], s[0:1], 56
    s_load_dwordx2 s[58:59], s[0:1], 24
    s_and_b32 s3, s2, 7
    s_mul_i32 s3, s3, 28
    s_lshr_b32 s30, s2, 3
    s_add_u32 s3, s3, s30
    s_lshr_b32 s31, s3, 3
    s_and_b32 s30, s3, 7
    v_mov_b32 v224, v214
    v_mov_b32 v225, v215
    s_nop 0
    v_readfirstlane_b32 s32, v225
    s_waitcnt lgkmcnt(0)
    s_mov_b32 s8, s4
    s_mov_b32 s9, s5
    s_and_b32 s9, s9, 0xffff
    s_mov_b32 s10, 0x400000
    s_mov_b32 s11, 0x00020000
    s_mov_b32 s12, s6
    s_mov_b32 s13, s7
    s_and_b32 s13, s13, 0xffff
    s_mov_b32 s14, 0x700000
    s_mov_b32 s15, 0x00020000
    s_mov_b32 s16, s28
    s_mov_b32 s17, s29
    s_and_b32 s17, s17, 0xffff
    s_mov_b32 s18, 0x700000
    s_mov_b32 s19, 0x00020000
    s_add_u32 s20, s4, 0x1400000
    s_addc_u32 s21, s5, 0
    s_and_b32 s21, s21, 0xffff
    s_mov_b32 s22, 0xe00000
    s_mov_b32 s23, 0x00020000
    s_mov_b32 s41, 2048
    s_mov_b32 s42, 32
    v_lshrrev_b32 v231, 2, v224
    v_lshrrev_b32 v232, 4, v224
    v_sub_u32 v232, 0, v232
    v_xor_b32 v232, v232, v224
    v_and_b32 v232, 3, v232
    v_mul_u32_u24 v233, 16, v225
    v_add_u32 v231, v231, v233
    s_mul_i32 s33, s30, 256
    v_add_u32 v231, s33, v231
    v_mul_lo_u32 v231, v231, s41
    v_lshl_add_u32 v226, v232, 4, v231
    v_lshrrev_b32 v231, 4, v224
    v_and_b32 v232, 15, v224
    v_lshlrev_b32 v233, 1, v231
    v_xor_b32 v232, v232, v233
    v_bfe_u32 v233, v225, 1, 1
    v_lshlrev_b32 v233, 3, v233
    v_xor_b32 v232, v232, v233
    v_lshl_add_u32 v231, v225, 2, v231
    s_mov_b32 s33, 7168
    v_mul_lo_u32 v231, v231, s33
    v_lshl_add_u32 v227, v232, 4, v231
    s_mov_b32 s24, 0
    s_lshl_b32 s25, s31, 8
    s_mov_b32 s34, s25
    s_lshl_b32 s26, s32, 10
    s_mul_i32 s46, s41, 128
    s_mov_b32 s47, 0
    s_mov_b32 s48, 0
    s_add_u32 m0, s26, 0
    s_mov_b32 s35, s24
    buffer_load_dwordx4 v226, s[8:11], s35 offen lds
    s_add_u32 m0, s26, 8192
    s_add_u32 s35, s35, s46
    buffer_load_dwordx4 v226, s[8:11], s35 offen lds
    s_add_u32 m0, s26, 16384
    s_add_u32 s35, s25, 0
    buffer_load_dwordx4 v227, s[12:15], s35 offen lds
    s_add_u32 m0, s26, 24576
    s_add_u32 s35, s34, 0
    buffer_load_dwordx4 v227, s[16:19], s35 offen lds
    s_add_u32 s24, s24, 64
    s_add_u32 s25, s25, 229376
    s_add_u32 s34, s34, 229376
    s_add_u32 s26, s26, 32768
    s_add_u32 s47, s47, 1
    s_cmp_eq_u32 s47, 5
    s_cselect_b32 s35, 163840, 0
    s_cselect_b32 s47, 0, s47
    s_sub_u32 s26, s26, s35
    s_add_u32 m0, s26, 0
    s_mov_b32 s35, s24
    buffer_load_dwordx4 v226, s[8:11], s35 offen lds
    s_add_u32 m0, s26, 8192
    s_add_u32 s35, s35, s46
    buffer_load_dwordx4 v226, s[8:11], s35 offen lds
    s_add_u32 m0, s26, 16384
    s_add_u32 s35, s25, 0
    buffer_load_dwordx4 v227, s[12:15], s35 offen lds
    s_add_u32 m0, s26, 24576
    s_add_u32 s35, s34, 0
    buffer_load_dwordx4 v227, s[16:19], s35 offen lds
    s_add_u32 s24, s24, 64
    s_add_u32 s25, s25, 229376
    s_add_u32 s34, s34, 229376
    s_add_u32 s26, s26, 32768
    s_add_u32 s47, s47, 1
    s_cmp_eq_u32 s47, 5
    s_cselect_b32 s35, 163840, 0
    s_cselect_b32 s47, 0, s47
    s_sub_u32 s26, s26, s35
    s_add_u32 m0, s26, 0
    s_mov_b32 s35, s24
    buffer_load_dwordx4 v226, s[8:11], s35 offen lds
    s_add_u32 m0, s26, 8192
    s_add_u32 s35, s35, s46
    buffer_load_dwordx4 v226, s[8:11], s35 offen lds
    s_add_u32 m0, s26, 16384
    s_add_u32 s35, s25, 0
    buffer_load_dwordx4 v227, s[12:15], s35 offen lds
    s_add_u32 m0, s26, 24576
    s_add_u32 s35, s34, 0
    buffer_load_dwordx4 v227, s[16:19], s35 offen lds
    s_add_u32 s24, s24, 64
    s_add_u32 s25, s25, 229376
    s_add_u32 s34, s34, 229376
    s_add_u32 s26, s26, 32768
    s_add_u32 s47, s47, 1
    s_cmp_eq_u32 s47, 5
    s_cselect_b32 s35, 163840, 0
    s_cselect_b32 s47, 0, s47
    s_sub_u32 s26, s26, s35
    s_add_u32 m0, s26, 0
    s_mov_b32 s35, s24
    buffer_load_dwordx4 v226, s[8:11], s35 offen lds
    s_add_u32 m0, s26, 8192
    s_add_u32 s35, s35, s46
    buffer_load_dwordx4 v226, s[8:11], s35 offen lds
    s_add_u32 m0, s26, 16384
    s_add_u32 s35, s25, 0
    buffer_load_dwordx4 v227, s[12:15], s35 offen lds
    s_add_u32 m0, s26, 24576
    s_add_u32 s35, s34, 0
    buffer_load_dwordx4 v227, s[16:19], s35 offen lds
    s_add_u32 s24, s24, 64
    s_add_u32 s25, s25, 229376
    s_add_u32 s34, s34, 229376
    s_add_u32 s26, s26, 32768
    s_add_u32 s47, s47, 1
    s_cmp_eq_u32 s47, 5
    s_cselect_b32 s35, 163840, 0
    s_cselect_b32 s47, 0, s47
    s_sub_u32 s26, s26, s35
    s_add_u32 m0, s26, 0
    s_mov_b32 s35, s24
    buffer_load_dwordx4 v226, s[8:11], s35 offen lds
    s_add_u32 m0, s26, 8192
    s_add_u32 s35, s35, s46
    buffer_load_dwordx4 v226, s[8:11], s35 offen lds
    s_add_u32 m0, s26, 16384
    s_add_u32 s35, s25, 0
    buffer_load_dwordx4 v227, s[12:15], s35 offen lds
    s_add_u32 m0, s26, 24576
    s_add_u32 s35, s34, 0
    buffer_load_dwordx4 v227, s[16:19], s35 offen lds
    s_add_u32 s24, s24, 64
    s_add_u32 s25, s25, 229376
    s_add_u32 s34, s34, 229376
    s_add_u32 s26, s26, 32768
    s_add_u32 s47, s47, 1
    s_cmp_eq_u32 s47, 5
    s_cselect_b32 s35, 163840, 0
    s_cselect_b32 s47, 0, s47
    s_sub_u32 s26, s26, s35
    s_nop 7
    v_mov_b32 v217, v198
    s_nop 1
    v_permlane16_swap_b32 v217, v198
    v_add_f32 v198, v198, v217
    v_mov_b32 v217, v198
    s_nop 1
    v_permlane32_swap_b32 v217, v198
    v_add_f32 v198, v198, v217
    v_rcp_f32 v218, v198
    v_mov_b32 v217, v199
    s_nop 1
    v_permlane16_swap_b32 v217, v199
    v_add_f32 v199, v199, v217
    v_mov_b32 v217, v199
    s_nop 1
    v_permlane32_swap_b32 v217, v199
    v_add_f32 v199, v199, v217
    v_rcp_f32 v219, v199
    s_nop 0
    v_mul_f32 v0, v0, v218
    v_mul_f32 v8, v8, v218
    v_mul_f32 v1, v1, v218
    v_mul_f32 v9, v9, v218
    v_mul_f32 v2, v2, v218
    v_mul_f32 v10, v10, v218
    v_mul_f32 v3, v3, v218
    v_mul_f32 v11, v11, v218
    v_cvt_pk_bf16_f32 v96, v0, v1
    v_cvt_pk_bf16_f32 v97, v2, v3
    v_cvt_pk_bf16_f32 v98, v8, v9
    v_cvt_pk_bf16_f32 v99, v10, v11
    s_mov_b32 s63, 0
    s_nop 0
    v_permlane16_swap_b32 v96, v98
    v_permlane16_swap_b32 v97, v99
    buffer_store_dwordx4 v[96:99], v220, s[64:67], s63 offen
    v_mul_f32 v16, v16, v218
    v_mul_f32 v24, v24, v218
    v_mul_f32 v17, v17, v218
    v_mul_f32 v25, v25, v218
    v_mul_f32 v18, v18, v218
    v_mul_f32 v26, v26, v218
    v_mul_f32 v19, v19, v218
    v_mul_f32 v27, v27, v218
    v_cvt_pk_bf16_f32 v100, v16, v17
    v_cvt_pk_bf16_f32 v101, v18, v19
    v_cvt_pk_bf16_f32 v102, v24, v25
    v_cvt_pk_bf16_f32 v103, v26, v27
    s_mov_b32 s63, 1024
    s_nop 0
    v_permlane16_swap_b32 v100, v102
    v_permlane16_swap_b32 v101, v103
    buffer_store_dwordx4 v[100:103], v220, s[64:67], s63 offen
    v_mul_f32 v32, v32, v218
    v_mul_f32 v40, v40, v218
    v_mul_f32 v33, v33, v218
    v_mul_f32 v41, v41, v218
    v_mul_f32 v34, v34, v218
    v_mul_f32 v42, v42, v218
    v_mul_f32 v35, v35, v218
    v_mul_f32 v43, v43, v218
    v_cvt_pk_bf16_f32 v104, v32, v33
    v_cvt_pk_bf16_f32 v105, v34, v35
    v_cvt_pk_bf16_f32 v106, v40, v41
    v_cvt_pk_bf16_f32 v107, v42, v43
    s_mov_b32 s63, 2048
    s_nop 0
    v_permlane16_swap_b32 v104, v106
    v_permlane16_swap_b32 v105, v107
    buffer_store_dwordx4 v[104:107], v220, s[64:67], s63 offen
    v_mul_f32 v48, v48, v218
    v_mul_f32 v56, v56, v218
    v_mul_f32 v49, v49, v218
    v_mul_f32 v57, v57, v218
    v_mul_f32 v50, v50, v218
    v_mul_f32 v58, v58, v218
    v_mul_f32 v51, v51, v218
    v_mul_f32 v59, v59, v218
    v_cvt_pk_bf16_f32 v108, v48, v49
    v_cvt_pk_bf16_f32 v109, v50, v51
    v_cvt_pk_bf16_f32 v110, v56, v57
    v_cvt_pk_bf16_f32 v111, v58, v59
    s_mov_b32 s63, 3072
    s_nop 0
    v_permlane16_swap_b32 v108, v110
    v_permlane16_swap_b32 v109, v111
    buffer_store_dwordx4 v[108:111], v220, s[64:67], s63 offen
    v_mul_f32 v4, v4, v219
    v_mul_f32 v12, v12, v219
    v_mul_f32 v5, v5, v219
    v_mul_f32 v13, v13, v219
    v_mul_f32 v6, v6, v219
    v_mul_f32 v14, v14, v219
    v_mul_f32 v7, v7, v219
    v_mul_f32 v15, v15, v219
    v_cvt_pk_bf16_f32 v112, v4, v5
    v_cvt_pk_bf16_f32 v113, v6, v7
    v_cvt_pk_bf16_f32 v114, v12, v13
    v_cvt_pk_bf16_f32 v115, v14, v15
    s_mov_b32 s63, 131072
    s_nop 0
    v_permlane16_swap_b32 v112, v114
    v_permlane16_swap_b32 v113, v115
    buffer_store_dwordx4 v[112:115], v220, s[64:67], s63 offen
    v_mul_f32 v20, v20, v219
    v_mul_f32 v28, v28, v219
    v_mul_f32 v21, v21, v219
    v_mul_f32 v29, v29, v219
    v_mul_f32 v22, v22, v219
    v_mul_f32 v30, v30, v219
    v_mul_f32 v23, v23, v219
    v_mul_f32 v31, v31, v219
    v_cvt_pk_bf16_f32 v116, v20, v21
    v_cvt_pk_bf16_f32 v117, v22, v23
    v_cvt_pk_bf16_f32 v118, v28, v29
    v_cvt_pk_bf16_f32 v119, v30, v31
    s_mov_b32 s63, 132096
    s_nop 0
    v_permlane16_swap_b32 v116, v118
    v_permlane16_swap_b32 v117, v119
    buffer_store_dwordx4 v[116:119], v220, s[64:67], s63 offen
    v_mul_f32 v36, v36, v219
    v_mul_f32 v44, v44, v219
    v_mul_f32 v37, v37, v219
    v_mul_f32 v45, v45, v219
    v_mul_f32 v38, v38, v219
    v_mul_f32 v46, v46, v219
    v_mul_f32 v39, v39, v219
    v_mul_f32 v47, v47, v219
    v_cvt_pk_bf16_f32 v120, v36, v37
    v_cvt_pk_bf16_f32 v121, v38, v39
    v_cvt_pk_bf16_f32 v122, v44, v45
    v_cvt_pk_bf16_f32 v123, v46, v47
    s_mov_b32 s63, 133120
    s_nop 0
    v_permlane16_swap_b32 v120, v122
    v_permlane16_swap_b32 v121, v123
    buffer_store_dwordx4 v[120:123], v220, s[64:67], s63 offen
    v_mul_f32 v52, v52, v219
    v_mul_f32 v60, v60, v219
    v_mul_f32 v53, v53, v219
    v_mul_f32 v61, v61, v219
    v_mul_f32 v54, v54, v219
    v_mul_f32 v62, v62, v219
    v_mul_f32 v55, v55, v219
    v_mul_f32 v63, v63, v219
    v_cvt_pk_bf16_f32 v124, v52, v53
    v_cvt_pk_bf16_f32 v125, v54, v55
    v_cvt_pk_bf16_f32 v126, v60, v61
    v_cvt_pk_bf16_f32 v127, v62, v63
    s_mov_b32 s63, 134144
    s_nop 0
    v_permlane16_swap_b32 v124, v126
    v_permlane16_swap_b32 v125, v127
    buffer_store_dwordx4 v[124:127], v220, s[64:67], s63 offen
    v_and_b32 v231, 15, v224
    v_bfe_u32 v232, v225, 2, 1
    v_mul_u32_u24 v232, 128, v232
    v_add_u32 v231, v231, v232
    v_lshrrev_b32 v232, 4, v224
    v_bfe_u32 v233, v224, 2, 2
    v_sub_u32 v233, 0, v233
    v_xor_b32 v232, v232, v233
    v_and_b32 v232, 3, v232
    v_lshlrev_b32 v231, 6, v231
    v_lshl_add_u32 v228, v232, 4, v231
    v_bfe_u32 v231, v224, 2, 2
    v_lshrrev_b32 v232, 4, v224
    v_lshl_add_u32 v232, v232, 3, v231
    v_lshlrev_b32 v232, 8, v232
    v_bfe_u32 v233, v224, 1, 1
    v_lshl_add_u32 v232, v233, 4, v232
    v_and_b32 v233, 1, v224
    v_lshl_add_u32 v232, v233, 3, v232
    v_add_u32 v232, 0x4000, v232
    v_lshlrev_b32 v231, 1, v231
    v_bfe_u32 v233, v224, 4, 1
    v_lshl_add_u32 v231, v233, 3, v231
    v_and_b32 v233, 3, v225
    v_mul_u32_u24 v233, 4, v233
    v_xor_b32 v231, v231, v233
    v_xor_b32 v233, 0, v231
    v_lshl_add_u32 v229, v233, 4, v232
    v_xor_b32 v233, 2, v231
    v_lshl_add_u32 v230, v233, 4, v232
    s_waitcnt vmcnt(24)
    s_barrier
    ds_read_b64_tr_b16 v[128:129], v229 offset:0
    ds_read_b64_tr_b16 v[130:131], v229 offset:1024
    ds_read_b64_tr_b16 v[132:133], v230 offset:0
    ds_read_b64_tr_b16 v[134:135], v230 offset:1024
    ds_read_b64_tr_b16 v[136:137], v229 offset:8192
    ds_read_b64_tr_b16 v[138:139], v229 offset:9216
    ds_read_b64_tr_b16 v[140:141], v230 offset:8192
    ds_read_b64_tr_b16 v[142:143], v230 offset:9216
    ds_read_b128 v[144:147], v228 offset:0
    ds_read_b128 v[148:151], v228 offset:1024
    ds_read_b128 v[152:155], v228 offset:2048
    ds_read_b128 v[156:159], v228 offset:3072
    ds_read_b128 v[160:163], v228 offset:4096
    ds_read_b128 v[164:167], v228 offset:5120
    ds_read_b128 v[168:171], v228 offset:6144
    ds_read_b128 v[172:175], v228 offset:7168
    s_add_u32 s48, s48, 1
    s_cmp_eq_u32 s48, 5
    s_cselect_b32 s37, -131072, 0
    s_cselect_b32 s48, 0, s48
    s_cselect_b32 s38, 0, 32768
    s_add_u32 s37, s37, s38
    v_add_u32 v228, s37, v228
    v_add_u32 v229, s37, v229
    v_add_u32 v230, s37, v230
    s_waitcnt lgkmcnt(0)
    s_waitcnt vmcnt(20)
    s_barrier
    v_mfma_f32_16x16x32_bf16 v[0:3], v[128:131], v[144:147], 0
    v_mfma_f32_16x16x32_bf16 v[4:7], v[132:135], v[144:147], 0
    ds_read_b64_tr_b16 v[176:177], v229 offset:0
    s_add_u32 m0, s26, 0
    s_mov_b32 s35, s24
    buffer_load_dwordx4 v226, s[8:11], s35 offen lds
    v_mfma_f32_16x16x32_bf16 v[8:11], v[136:139], v[144:147], 0
    ds_read_b64_tr_b16 v[178:179], v229 offset:1024
    v_mfma_f32_16x16x32_bf16 v[12:15], v[140:143], v[144:147], 0
    ds_read_b64_tr_b16 v[180:181], v230 offset:0
    v_mfma_f32_16x16x32_bf16 v[16:19], v[128:131], v[148:151], 0
    ds_read_b64_tr_b16 v[182:183], v230 offset:1024
    v_mfma_f32_16x16x32_bf16 v[20:23], v[132:135], v[148:151], 0
    ds_read_b64_tr_b16 v[184:185], v229 offset:8192
    v_mfma_f32_16x16x32_bf16 v[24:27], v[136:139], v[148:151], 0
    ds_read_b64_tr_b16 v[186:187], v229 offset:9216
    v_mfma_f32_16x16x32_bf16 v[28:31], v[140:143], v[148:151], 0
    ds_read_b64_tr_b16 v[188:189], v230 offset:8192
    s_add_u32 m0, s26, 8192
    s_add_u32 s35, s35, s46
    buffer_load_dwordx4 v226, s[8:11], s35 offen lds
    v_mfma_f32_16x16x32_bf16 v[32:35], v[128:131], v[152:155], 0
    ds_read_b64_tr_b16 v[190:191], v230 offset:9216
    v_mfma_f32_16x16x32_bf16 v[36:39], v[132:135], v[152:155], 0
    ds_read_b128 v[192:195], v228 offset:0
    v_mfma_f32_16x16x32_bf16 v[40:43], v[136:139], v[152:155], 0
    ds_read_b128 v[196:199], v228 offset:1024
    v_mfma_f32_16x16x32_bf16 v[44:47], v[140:143], v[152:155], 0
    ds_read_b128 v[200:203], v228 offset:2048
    v_mfma_f32_16x16x32_bf16 v[48:51], v[128:131], v[156:159], 0
    ds_read_b128 v[204:207], v228 offset:3072
    v_mfma_f32_16x16x32_bf16 v[52:55], v[132:135], v[156:159], 0
    ds_read_b128 v[208:211], v228 offset:4096
    s_add_u32 m0, s26, 16384
    s_add_u32 s35, s25, 0
    buffer_load_dwordx4 v227, s[12:15], s35 offen lds
    v_mfma_f32_16x16x32_bf16 v[56:59], v[136:139], v[156:159], 0
    ds_read_b128 v[212:215], v228 offset:5120
    v_mfma_f32_16x16x32_bf16 v[60:63], v[140:143], v[156:159], 0
    ds_read_b128 v[216:219], v228 offset:6144
    v_mfma_f32_16x16x32_bf16 v[64:67], v[128:131], v[160:163], 0
    ds_read_b128 v[220:223], v228 offset:7168
    v_mfma_f32_16x16x32_bf16 v[68:71], v[132:135], v[160:163], 0
    s_add_u32 s48, s48, 1
    s_cmp_eq_u32 s48, 5
    s_cselect_b32 s37, -131072, 0
    s_cselect_b32 s48, 0, s48
    s_cselect_b32 s38, 0, 32768
    s_add_u32 s37, s37, s38
    v_add_u32 v228, s37, v228
    v_add_u32 v229, s37, v229
    v_add_u32 v230, s37, v230
    v_mfma_f32_16x16x32_bf16 v[72:75], v[136:139], v[160:163], 0
    v_mfma_f32_16x16x32_bf16 v[76:79], v[140:143], v[160:163], 0
    s_add_u32 m0, s26, 24576
    s_add_u32 s35, s34, 0
    buffer_load_dwordx4 v227, s[16:19], s35 offen lds
    v_mfma_f32_16x16x32_bf16 v[80:83], v[128:131], v[164:167], 0
    v_mfma_f32_16x16x32_bf16 v[84:87], v[132:135], v[164:167], 0
    v_mfma_f32_16x16x32_bf16 v[88:91], v[136:139], v[164:167], 0
    v_mfma_f32_16x16x32_bf16 v[92:95], v[140:143], v[164:167], 0
    v_mfma_f32_16x16x32_bf16 v[96:99], v[128:131], v[168:171], 0
    v_mfma_f32_16x16x32_bf16 v[100:103], v[132:135], v[168:171], 0
    s_add_u32 s24, s24, 64
    s_add_u32 s25, s25, 229376
    s_add_u32 s34, s34, 229376
    s_add_u32 s26, s26, 32768
    s_add_u32 s47, s47, 1
    s_cmp_eq_u32 s47, 5
    s_cselect_b32 s35, 163840, 0
    s_cselect_b32 s47, 0, s47
    s_sub_u32 s26, s26, s35
    v_mfma_f32_16x16x32_bf16 v[104:107], v[136:139], v[168:171], 0
    v_mfma_f32_16x16x32_bf16 v[108:111], v[140:143], v[168:171], 0
    v_mfma_f32_16x16x32_bf16 v[112:115], v[128:131], v[172:175], 0
    v_mfma_f32_16x16x32_bf16 v[116:119], v[132:135], v[172:175], 0
    v_mfma_f32_16x16x32_bf16 v[120:123], v[136:139], v[172:175], 0
    v_mfma_f32_16x16x32_bf16 v[124:127], v[140:143], v[172:175], 0
    s_waitcnt lgkmcnt(0)
    s_waitcnt vmcnt(20)
    s_barrier
    v_mfma_f32_16x16x32_bf16 v[0:3], v[176:179], v[192:195], v[0:3]
    v_mfma_f32_16x16x32_bf16 v[4:7], v[180:183], v[192:195], v[4:7]
    ds_read_b64_tr_b16 v[128:129], v229 offset:0
    s_add_u32 m0, s26, 0
    s_mov_b32 s35, s24
    buffer_load_dwordx4 v226, s[8:11], s35 offen lds
    v_mfma_f32_16x16x32_bf16 v[8:11], v[184:187], v[192:195], v[8:11]
    ds_read_b64_tr_b16 v[130:131], v229 offset:1024
    v_mfma_f32_16x16x32_bf16 v[12:15], v[188:191], v[192:195], v[12:15]
    ds_read_b64_tr_b16 v[132:133], v230 offset:0
    v_mfma_f32_16x16x32_bf16 v[16:19], v[176:179], v[196:199], v[16:19]
    ds_read_b64_tr_b16 v[134:135], v230 offset:1024
    v_mfma_f32_16x16x32_bf16 v[20:23], v[180:183], v[196:199], v[20:23]
    ds_read_b64_tr_b16 v[136:137], v229 offset:8192
    v_mfma_f32_16x16x32_bf16 v[24:27], v[184:187], v[196:199], v[24:27]
    ds_read_b64_tr_b16 v[138:139], v229 offset:9216
    v_mfma_f32_16x16x32_bf16 v[28:31], v[188:191], v[196:199], v[28:31]
    ds_read_b64_tr_b16 v[140:141], v230 offset:8192
    s_add_u32 m0, s26, 8192
    s_add_u32 s35, s35, s46
    buffer_load_dwordx4 v226, s[8:11], s35 offen lds
    v_mfma_f32_16x16x32_bf16 v[32:35], v[176:179], v[200:203], v[32:35]
    ds_read_b64_tr_b16 v[142:143], v230 offset:9216
    v_mfma_f32_16x16x32_bf16 v[36:39], v[180:183], v[200:203], v[36:39]
    ds_read_b128 v[144:147], v228 offset:0
    v_mfma_f32_16x16x32_bf16 v[40:43], v[184:187], v[200:203], v[40:43]
    ds_read_b128 v[148:151], v228 offset:1024
    v_mfma_f32_16x16x32_bf16 v[44:47], v[188:191], v[200:203], v[44:47]
    ds_read_b128 v[152:155], v228 offset:2048
    v_mfma_f32_16x16x32_bf16 v[48:51], v[176:179], v[204:207], v[48:51]
    ds_read_b128 v[156:159], v228 offset:3072
    v_mfma_f32_16x16x32_bf16 v[52:55], v[180:183], v[204:207], v[52:55]
    ds_read_b128 v[160:163], v228 offset:4096
    s_add_u32 m0, s26, 16384
    s_add_u32 s35, s25, 0
    buffer_load_dwordx4 v227, s[12:15], s35 offen lds
    v_mfma_f32_16x16x32_bf16 v[56:59], v[184:187], v[204:207], v[56:59]
    ds_read_b128 v[164:167], v228 offset:5120
    v_mfma_f32_16x16x32_bf16 v[60:63], v[188:191], v[204:207], v[60:63]
    ds_read_b128 v[168:171], v228 offset:6144
    v_mfma_f32_16x16x32_bf16 v[64:67], v[176:179], v[208:211], v[64:67]
    ds_read_b128 v[172:175], v228 offset:7168
    v_mfma_f32_16x16x32_bf16 v[68:71], v[180:183], v[208:211], v[68:71]
    s_add_u32 s48, s48, 1
    s_cmp_eq_u32 s48, 5
    s_cselect_b32 s37, -131072, 0
    s_cselect_b32 s48, 0, s48
    s_cselect_b32 s38, 0, 32768
    s_add_u32 s37, s37, s38
    v_add_u32 v228, s37, v228
    v_add_u32 v229, s37, v229
    v_add_u32 v230, s37, v230
    v_mfma_f32_16x16x32_bf16 v[72:75], v[184:187], v[208:211], v[72:75]
    v_mfma_f32_16x16x32_bf16 v[76:79], v[188:191], v[208:211], v[76:79]
    s_add_u32 m0, s26, 24576
    s_add_u32 s35, s34, 0
    buffer_load_dwordx4 v227, s[16:19], s35 offen lds
    v_mfma_f32_16x16x32_bf16 v[80:83], v[176:179], v[212:215], v[80:83]
    v_mfma_f32_16x16x32_bf16 v[84:87], v[180:183], v[212:215], v[84:87]
    v_mfma_f32_16x16x32_bf16 v[88:91], v[184:187], v[212:215], v[88:91]
    v_mfma_f32_16x16x32_bf16 v[92:95], v[188:191], v[212:215], v[92:95]
    v_mfma_f32_16x16x32_bf16 v[96:99], v[176:179], v[216:219], v[96:99]
    v_mfma_f32_16x16x32_bf16 v[100:103], v[180:183], v[216:219], v[100:103]
    s_add_u32 s24, s24, 64
    s_add_u32 s25, s25, 229376
    s_add_u32 s34, s34, 229376
    s_add_u32 s26, s26, 32768
    s_add_u32 s47, s47, 1
    s_cmp_eq_u32 s47, 5
    s_cselect_b32 s35, 163840, 0
    s_cselect_b32 s47, 0, s47
    s_sub_u32 s26, s26, s35
    v_mfma_f32_16x16x32_bf16 v[104:107], v[184:187], v[216:219], v[104:107]
    v_mfma_f32_16x16x32_bf16 v[108:111], v[188:191], v[216:219], v[108:111]
    v_mfma_f32_16x16x32_bf16 v[112:115], v[176:179], v[220:223], v[112:115]
    v_mfma_f32_16x16x32_bf16 v[116:119], v[180:183], v[220:223], v[116:119]
    v_mfma_f32_16x16x32_bf16 v[120:123], v[184:187], v[220:223], v[120:123]
    v_mfma_f32_16x16x32_bf16 v[124:127], v[188:191], v[220:223], v[124:127]
    s_waitcnt lgkmcnt(0)
    s_waitcnt vmcnt(20)
    s_barrier
    v_mfma_f32_16x16x32_bf16 v[0:3], v[128:131], v[144:147], v[0:3]
    v_mfma_f32_16x16x32_bf16 v[4:7], v[132:135], v[144:147], v[4:7]
    ds_read_b64_tr_b16 v[176:177], v229 offset:0
    s_add_u32 m0, s26, 0
    s_mov_b32 s35, s24
    buffer_load_dwordx4 v226, s[8:11], s35 offen lds
    v_mfma_f32_16x16x32_bf16 v[8:11], v[136:139], v[144:147], v[8:11]
    ds_read_b64_tr_b16 v[178:179], v229 offset:1024
    v_mfma_f32_16x16x32_bf16 v[12:15], v[140:143], v[144:147], v[12:15]
    ds_read_b64_tr_b16 v[180:181], v230 offset:0
    v_mfma_f32_16x16x32_bf16 v[16:19], v[128:131], v[148:151], v[16:19]
    ds_read_b64_tr_b16 v[182:183], v230 offset:1024
    v_mfma_f32_16x16x32_bf16 v[20:23], v[132:135], v[148:151], v[20:23]
    ds_read_b64_tr_b16 v[184:185], v229 offset:8192
    v_mfma_f32_16x16x32_bf16 v[24:27], v[136:139], v[148:151], v[24:27]
    ds_read_b64_tr_b16 v[186:187], v229 offset:9216
    v_mfma_f32_16x16x32_bf16 v[28:31], v[140:143], v[148:151], v[28:31]
    ds_read_b64_tr_b16 v[188:189], v230 offset:8192
    s_add_u32 m0, s26, 8192
    s_add_u32 s35, s35, s46
    buffer_load_dwordx4 v226, s[8:11], s35 offen lds
    v_mfma_f32_16x16x32_bf16 v[32:35], v[128:131], v[152:155], v[32:35]
    ds_read_b64_tr_b16 v[190:191], v230 offset:9216
    v_mfma_f32_16x16x32_bf16 v[36:39], v[132:135], v[152:155], v[36:39]
    ds_read_b128 v[192:195], v228 offset:0
    v_mfma_f32_16x16x32_bf16 v[40:43], v[136:139], v[152:155], v[40:43]
    ds_read_b128 v[196:199], v228 offset:1024
    v_mfma_f32_16x16x32_bf16 v[44:47], v[140:143], v[152:155], v[44:47]
    ds_read_b128 v[200:203], v228 offset:2048
    v_mfma_f32_16x16x32_bf16 v[48:51], v[128:131], v[156:159], v[48:51]
    ds_read_b128 v[204:207], v228 offset:3072
    v_mfma_f32_16x16x32_bf16 v[52:55], v[132:135], v[156:159], v[52:55]
    ds_read_b128 v[208:211], v228 offset:4096
    s_add_u32 m0, s26, 16384
    s_add_u32 s35, s25, 0
    buffer_load_dwordx4 v227, s[12:15], s35 offen lds
    v_mfma_f32_16x16x32_bf16 v[56:59], v[136:139], v[156:159], v[56:59]
    ds_read_b128 v[212:215], v228 offset:5120
    v_mfma_f32_16x16x32_bf16 v[60:63], v[140:143], v[156:159], v[60:63]
    ds_read_b128 v[216:219], v228 offset:6144
    v_mfma_f32_16x16x32_bf16 v[64:67], v[128:131], v[160:163], v[64:67]
    ds_read_b128 v[220:223], v228 offset:7168
    v_mfma_f32_16x16x32_bf16 v[68:71], v[132:135], v[160:163], v[68:71]
    s_add_u32 s48, s48, 1
    s_cmp_eq_u32 s48, 5
    s_cselect_b32 s37, -131072, 0
    s_cselect_b32 s48, 0, s48
    s_cselect_b32 s38, 0, 32768
    s_add_u32 s37, s37, s38
    v_add_u32 v228, s37, v228
    v_add_u32 v229, s37, v229
    v_add_u32 v230, s37, v230
    v_mfma_f32_16x16x32_bf16 v[72:75], v[136:139], v[160:163], v[72:75]
    v_mfma_f32_16x16x32_bf16 v[76:79], v[140:143], v[160:163], v[76:79]
    s_add_u32 m0, s26, 24576
    s_add_u32 s35, s34, 0
    buffer_load_dwordx4 v227, s[16:19], s35 offen lds
    v_mfma_f32_16x16x32_bf16 v[80:83], v[128:131], v[164:167], v[80:83]
    v_mfma_f32_16x16x32_bf16 v[84:87], v[132:135], v[164:167], v[84:87]
    v_mfma_f32_16x16x32_bf16 v[88:91], v[136:139], v[164:167], v[88:91]
    v_mfma_f32_16x16x32_bf16 v[92:95], v[140:143], v[164:167], v[92:95]
    v_mfma_f32_16x16x32_bf16 v[96:99], v[128:131], v[168:171], v[96:99]
    v_mfma_f32_16x16x32_bf16 v[100:103], v[132:135], v[168:171], v[100:103]
    s_add_u32 s24, s24, 64
    s_add_u32 s25, s25, 229376
    s_add_u32 s34, s34, 229376
    s_add_u32 s26, s26, 32768
    s_add_u32 s47, s47, 1
    s_cmp_eq_u32 s47, 5
    s_cselect_b32 s35, 163840, 0
    s_cselect_b32 s47, 0, s47
    s_sub_u32 s26, s26, s35
    v_mfma_f32_16x16x32_bf16 v[104:107], v[136:139], v[168:171], v[104:107]
    v_mfma_f32_16x16x32_bf16 v[108:111], v[140:143], v[168:171], v[108:111]
    v_mfma_f32_16x16x32_bf16 v[112:115], v[128:131], v[172:175], v[112:115]
    v_mfma_f32_16x16x32_bf16 v[116:119], v[132:135], v[172:175], v[116:119]
    v_mfma_f32_16x16x32_bf16 v[120:123], v[136:139], v[172:175], v[120:123]
    v_mfma_f32_16x16x32_bf16 v[124:127], v[140:143], v[172:175], v[124:127]
    s_waitcnt lgkmcnt(0)
    s_waitcnt vmcnt(20)
    s_barrier
    v_mfma_f32_16x16x32_bf16 v[0:3], v[176:179], v[192:195], v[0:3]
    v_mfma_f32_16x16x32_bf16 v[4:7], v[180:183], v[192:195], v[4:7]
    ds_read_b64_tr_b16 v[128:129], v229 offset:0
    s_add_u32 m0, s26, 0
    s_mov_b32 s35, s24
    buffer_load_dwordx4 v226, s[8:11], s35 offen lds
    v_mfma_f32_16x16x32_bf16 v[8:11], v[184:187], v[192:195], v[8:11]
    ds_read_b64_tr_b16 v[130:131], v229 offset:1024
    v_mfma_f32_16x16x32_bf16 v[12:15], v[188:191], v[192:195], v[12:15]
    ds_read_b64_tr_b16 v[132:133], v230 offset:0
    v_mfma_f32_16x16x32_bf16 v[16:19], v[176:179], v[196:199], v[16:19]
    ds_read_b64_tr_b16 v[134:135], v230 offset:1024
    v_mfma_f32_16x16x32_bf16 v[20:23], v[180:183], v[196:199], v[20:23]
    ds_read_b64_tr_b16 v[136:137], v229 offset:8192
    v_mfma_f32_16x16x32_bf16 v[24:27], v[184:187], v[196:199], v[24:27]
    ds_read_b64_tr_b16 v[138:139], v229 offset:9216
    v_mfma_f32_16x16x32_bf16 v[28:31], v[188:191], v[196:199], v[28:31]
    ds_read_b64_tr_b16 v[140:141], v230 offset:8192
    s_add_u32 m0, s26, 8192
    s_add_u32 s35, s35, s46
    buffer_load_dwordx4 v226, s[8:11], s35 offen lds
    v_mfma_f32_16x16x32_bf16 v[32:35], v[176:179], v[200:203], v[32:35]
    ds_read_b64_tr_b16 v[142:143], v230 offset:9216
    v_mfma_f32_16x16x32_bf16 v[36:39], v[180:183], v[200:203], v[36:39]
    ds_read_b128 v[144:147], v228 offset:0
    v_mfma_f32_16x16x32_bf16 v[40:43], v[184:187], v[200:203], v[40:43]
    ds_read_b128 v[148:151], v228 offset:1024
    v_mfma_f32_16x16x32_bf16 v[44:47], v[188:191], v[200:203], v[44:47]
    ds_read_b128 v[152:155], v228 offset:2048
    v_mfma_f32_16x16x32_bf16 v[48:51], v[176:179], v[204:207], v[48:51]
    ds_read_b128 v[156:159], v228 offset:3072
    v_mfma_f32_16x16x32_bf16 v[52:55], v[180:183], v[204:207], v[52:55]
    ds_read_b128 v[160:163], v228 offset:4096
    s_add_u32 m0, s26, 16384
    s_add_u32 s35, s25, 0
    buffer_load_dwordx4 v227, s[12:15], s35 offen lds
    v_mfma_f32_16x16x32_bf16 v[56:59], v[184:187], v[204:207], v[56:59]
    ds_read_b128 v[164:167], v228 offset:5120
    v_mfma_f32_16x16x32_bf16 v[60:63], v[188:191], v[204:207], v[60:63]
    ds_read_b128 v[168:171], v228 offset:6144
    v_mfma_f32_16x16x32_bf16 v[64:67], v[176:179], v[208:211], v[64:67]
    ds_read_b128 v[172:175], v228 offset:7168
    v_mfma_f32_16x16x32_bf16 v[68:71], v[180:183], v[208:211], v[68:71]
    s_add_u32 s48, s48, 1
    s_cmp_eq_u32 s48, 5
    s_cselect_b32 s37, -131072, 0
    s_cselect_b32 s48, 0, s48
    s_cselect_b32 s38, 0, 32768
    s_add_u32 s37, s37, s38
    v_add_u32 v228, s37, v228
    v_add_u32 v229, s37, v229
    v_add_u32 v230, s37, v230
    v_mfma_f32_16x16x32_bf16 v[72:75], v[184:187], v[208:211], v[72:75]
    v_mfma_f32_16x16x32_bf16 v[76:79], v[188:191], v[208:211], v[76:79]
    s_add_u32 m0, s26, 24576
    s_add_u32 s35, s34, 0
    buffer_load_dwordx4 v227, s[16:19], s35 offen lds
    v_mfma_f32_16x16x32_bf16 v[80:83], v[176:179], v[212:215], v[80:83]
    v_mfma_f32_16x16x32_bf16 v[84:87], v[180:183], v[212:215], v[84:87]
    v_mfma_f32_16x16x32_bf16 v[88:91], v[184:187], v[212:215], v[88:91]
    v_mfma_f32_16x16x32_bf16 v[92:95], v[188:191], v[212:215], v[92:95]
    v_mfma_f32_16x16x32_bf16 v[96:99], v[176:179], v[216:219], v[96:99]
    v_mfma_f32_16x16x32_bf16 v[100:103], v[180:183], v[216:219], v[100:103]
    s_add_u32 s24, s24, 64
    s_add_u32 s25, s25, 229376
    s_add_u32 s34, s34, 229376
    s_add_u32 s26, s26, 32768
    s_add_u32 s47, s47, 1
    s_cmp_eq_u32 s47, 5
    s_cselect_b32 s35, 163840, 0
    s_cselect_b32 s47, 0, s47
    s_sub_u32 s26, s26, s35
    v_mfma_f32_16x16x32_bf16 v[104:107], v[184:187], v[216:219], v[104:107]
    v_mfma_f32_16x16x32_bf16 v[108:111], v[188:191], v[216:219], v[108:111]
    v_mfma_f32_16x16x32_bf16 v[112:115], v[176:179], v[220:223], v[112:115]
    v_mfma_f32_16x16x32_bf16 v[116:119], v[180:183], v[220:223], v[116:119]
    v_mfma_f32_16x16x32_bf16 v[120:123], v[184:187], v[220:223], v[120:123]
    v_mfma_f32_16x16x32_bf16 v[124:127], v[188:191], v[220:223], v[124:127]
    s_waitcnt lgkmcnt(0)
    s_waitcnt vmcnt(12)
    s_barrier
    v_mfma_f32_16x16x32_bf16 v[0:3], v[128:131], v[144:147], v[0:3]
    v_mfma_f32_16x16x32_bf16 v[4:7], v[132:135], v[144:147], v[4:7]
    ds_read_b64_tr_b16 v[176:177], v229 offset:0
    s_add_u32 m0, s26, 0
    s_mov_b32 s35, s24
    buffer_load_dwordx4 v226, s[8:11], s35 offen lds
    v_mfma_f32_16x16x32_bf16 v[8:11], v[136:139], v[144:147], v[8:11]
    ds_read_b64_tr_b16 v[178:179], v229 offset:1024
    v_mfma_f32_16x16x32_bf16 v[12:15], v[140:143], v[144:147], v[12:15]
    ds_read_b64_tr_b16 v[180:181], v230 offset:0
    v_mfma_f32_16x16x32_bf16 v[16:19], v[128:131], v[148:151], v[16:19]
    ds_read_b64_tr_b16 v[182:183], v230 offset:1024
    v_mfma_f32_16x16x32_bf16 v[20:23], v[132:135], v[148:151], v[20:23]
    ds_read_b64_tr_b16 v[184:185], v229 offset:8192
    v_mfma_f32_16x16x32_bf16 v[24:27], v[136:139], v[148:151], v[24:27]
    ds_read_b64_tr_b16 v[186:187], v229 offset:9216
    v_mfma_f32_16x16x32_bf16 v[28:31], v[140:143], v[148:151], v[28:31]
    ds_read_b64_tr_b16 v[188:189], v230 offset:8192
    s_add_u32 m0, s26, 8192
    s_add_u32 s35, s35, s46
    buffer_load_dwordx4 v226, s[8:11], s35 offen lds
    v_mfma_f32_16x16x32_bf16 v[32:35], v[128:131], v[152:155], v[32:35]
    ds_read_b64_tr_b16 v[190:191], v230 offset:9216
    v_mfma_f32_16x16x32_bf16 v[36:39], v[132:135], v[152:155], v[36:39]
    ds_read_b128 v[192:195], v228 offset:0
    v_mfma_f32_16x16x32_bf16 v[40:43], v[136:139], v[152:155], v[40:43]
    ds_read_b128 v[196:199], v228 offset:1024
    v_mfma_f32_16x16x32_bf16 v[44:47], v[140:143], v[152:155], v[44:47]
    ds_read_b128 v[200:203], v228 offset:2048
    v_mfma_f32_16x16x32_bf16 v[48:51], v[128:131], v[156:159], v[48:51]
    ds_read_b128 v[204:207], v228 offset:3072
    v_mfma_f32_16x16x32_bf16 v[52:55], v[132:135], v[156:159], v[52:55]
    ds_read_b128 v[208:211], v228 offset:4096
    s_add_u32 m0, s26, 16384
    s_add_u32 s35, s25, 0
    buffer_load_dwordx4 v227, s[12:15], s35 offen lds
    v_mfma_f32_16x16x32_bf16 v[56:59], v[136:139], v[156:159], v[56:59]
    ds_read_b128 v[212:215], v228 offset:5120
    v_mfma_f32_16x16x32_bf16 v[60:63], v[140:143], v[156:159], v[60:63]
    ds_read_b128 v[216:219], v228 offset:6144
    v_mfma_f32_16x16x32_bf16 v[64:67], v[128:131], v[160:163], v[64:67]
    ds_read_b128 v[220:223], v228 offset:7168
    v_mfma_f32_16x16x32_bf16 v[68:71], v[132:135], v[160:163], v[68:71]
    s_add_u32 s48, s48, 1
    s_cmp_eq_u32 s48, 5
    s_cselect_b32 s37, -131072, 0
    s_cselect_b32 s48, 0, s48
    s_cselect_b32 s38, 0, 32768
    s_add_u32 s37, s37, s38
    v_add_u32 v228, s37, v228
    v_add_u32 v229, s37, v229
    v_add_u32 v230, s37, v230
    v_mfma_f32_16x16x32_bf16 v[72:75], v[136:139], v[160:163], v[72:75]
    v_mfma_f32_16x16x32_bf16 v[76:79], v[140:143], v[160:163], v[76:79]
    s_add_u32 m0, s26, 24576
    s_add_u32 s35, s34, 0
    buffer_load_dwordx4 v227, s[16:19], s35 offen lds
    v_mfma_f32_16x16x32_bf16 v[80:83], v[128:131], v[164:167], v[80:83]
    v_mfma_f32_16x16x32_bf16 v[84:87], v[132:135], v[164:167], v[84:87]
    v_mfma_f32_16x16x32_bf16 v[88:91], v[136:139], v[164:167], v[88:91]
    v_mfma_f32_16x16x32_bf16 v[92:95], v[140:143], v[164:167], v[92:95]
    v_mfma_f32_16x16x32_bf16 v[96:99], v[128:131], v[168:171], v[96:99]
    v_mfma_f32_16x16x32_bf16 v[100:103], v[132:135], v[168:171], v[100:103]
    s_add_u32 s24, s24, 64
    s_add_u32 s25, s25, 229376
    s_add_u32 s34, s34, 229376
    s_add_u32 s26, s26, 32768
    s_add_u32 s47, s47, 1
    s_cmp_eq_u32 s47, 5
    s_cselect_b32 s35, 163840, 0
    s_cselect_b32 s47, 0, s47
    s_sub_u32 s26, s26, s35
    v_mfma_f32_16x16x32_bf16 v[104:107], v[136:139], v[168:171], v[104:107]
    v_mfma_f32_16x16x32_bf16 v[108:111], v[140:143], v[168:171], v[108:111]
    v_mfma_f32_16x16x32_bf16 v[112:115], v[128:131], v[172:175], v[112:115]
    v_mfma_f32_16x16x32_bf16 v[116:119], v[132:135], v[172:175], v[116:119]
    v_mfma_f32_16x16x32_bf16 v[120:123], v[136:139], v[172:175], v[120:123]
    v_mfma_f32_16x16x32_bf16 v[124:127], v[140:143], v[172:175], v[124:127]
    s_sub_u32 s27, s42, 10
    s_lshr_b32 s27, s27, 1
L_gu_loop:
    s_waitcnt lgkmcnt(0)
    s_waitcnt vmcnt(12)
    s_barrier
    v_mfma_f32_16x16x32_bf16 v[0:3], v[176:179], v[192:195], v[0:3]
    v_mfma_f32_16x16x32_bf16 v[4:7], v[180:183], v[192:195], v[4:7]
    ds_read_b64_tr_b16 v[128:129], v229 offset:0
    s_add_u32 m0, s26, 0
    s_mov_b32 s35, s24
    buffer_load_dwordx4 v226, s[8:11], s35 offen lds
    v_mfma_f32_16x16x32_bf16 v[8:11], v[184:187], v[192:195], v[8:11]
    ds_read_b64_tr_b16 v[130:131], v229 offset:1024
    v_mfma_f32_16x16x32_bf16 v[12:15], v[188:191], v[192:195], v[12:15]
    ds_read_b64_tr_b16 v[132:133], v230 offset:0
    v_mfma_f32_16x16x32_bf16 v[16:19], v[176:179], v[196:199], v[16:19]
    ds_read_b64_tr_b16 v[134:135], v230 offset:1024
    v_mfma_f32_16x16x32_bf16 v[20:23], v[180:183], v[196:199], v[20:23]
    ds_read_b64_tr_b16 v[136:137], v229 offset:8192
    v_mfma_f32_16x16x32_bf16 v[24:27], v[184:187], v[196:199], v[24:27]
    ds_read_b64_tr_b16 v[138:139], v229 offset:9216
    v_mfma_f32_16x16x32_bf16 v[28:31], v[188:191], v[196:199], v[28:31]
    ds_read_b64_tr_b16 v[140:141], v230 offset:8192
    s_add_u32 m0, s26, 8192
    s_add_u32 s35, s35, s46
    buffer_load_dwordx4 v226, s[8:11], s35 offen lds
    v_mfma_f32_16x16x32_bf16 v[32:35], v[176:179], v[200:203], v[32:35]
    ds_read_b64_tr_b16 v[142:143], v230 offset:9216
    v_mfma_f32_16x16x32_bf16 v[36:39], v[180:183], v[200:203], v[36:39]
    ds_read_b128 v[144:147], v228 offset:0
    v_mfma_f32_16x16x32_bf16 v[40:43], v[184:187], v[200:203], v[40:43]
    ds_read_b128 v[148:151], v228 offset:1024
    v_mfma_f32_16x16x32_bf16 v[44:47], v[188:191], v[200:203], v[44:47]
    ds_read_b128 v[152:155], v228 offset:2048
    v_mfma_f32_16x16x32_bf16 v[48:51], v[176:179], v[204:207], v[48:51]
    ds_read_b128 v[156:159], v228 offset:3072
    v_mfma_f32_16x16x32_bf16 v[52:55], v[180:183], v[204:207], v[52:55]
    ds_read_b128 v[160:163], v228 offset:4096
    s_add_u32 m0, s26, 16384
    s_add_u32 s35, s25, 0
    buffer_load_dwordx4 v227, s[12:15], s35 offen lds
    v_mfma_f32_16x16x32_bf16 v[56:59], v[184:187], v[204:207], v[56:59]
    ds_read_b128 v[164:167], v228 offset:5120
    v_mfma_f32_16x16x32_bf16 v[60:63], v[188:191], v[204:207], v[60:63]
    ds_read_b128 v[168:171], v228 offset:6144
    v_mfma_f32_16x16x32_bf16 v[64:67], v[176:179], v[208:211], v[64:67]
    ds_read_b128 v[172:175], v228 offset:7168
    v_mfma_f32_16x16x32_bf16 v[68:71], v[180:183], v[208:211], v[68:71]
    s_add_u32 s48, s48, 1
    s_cmp_eq_u32 s48, 5
    s_cselect_b32 s37, -131072, 0
    s_cselect_b32 s48, 0, s48
    s_cselect_b32 s38, 0, 32768
    s_add_u32 s37, s37, s38
    v_add_u32 v228, s37, v228
    v_add_u32 v229, s37, v229
    v_add_u32 v230, s37, v230
    v_mfma_f32_16x16x32_bf16 v[72:75], v[184:187], v[208:211], v[72:75]
    v_mfma_f32_16x16x32_bf16 v[76:79], v[188:191], v[208:211], v[76:79]
    s_add_u32 m0, s26, 24576
    s_add_u32 s35, s34, 0
    buffer_load_dwordx4 v227, s[16:19], s35 offen lds
    v_mfma_f32_16x16x32_bf16 v[80:83], v[176:179], v[212:215], v[80:83]
    v_mfma_f32_16x16x32_bf16 v[84:87], v[180:183], v[212:215], v[84:87]
    v_mfma_f32_16x16x32_bf16 v[88:91], v[184:187], v[212:215], v[88:91]
    v_mfma_f32_16x16x32_bf16 v[92:95], v[188:191], v[212:215], v[92:95]
    v_mfma_f32_16x16x32_bf16 v[96:99], v[176:179], v[216:219], v[96:99]
    v_mfma_f32_16x16x32_bf16 v[100:103], v[180:183], v[216:219], v[100:103]
    s_add_u32 s24, s24, 64
    s_add_u32 s25, s25, 229376
    s_add_u32 s34, s34, 229376
    s_add_u32 s26, s26, 32768
    s_add_u32 s47, s47, 1
    s_cmp_eq_u32 s47, 5
    s_cselect_b32 s35, 163840, 0
    s_cselect_b32 s47, 0, s47
    s_sub_u32 s26, s26, s35
    v_mfma_f32_16x16x32_bf16 v[104:107], v[184:187], v[216:219], v[104:107]
    v_mfma_f32_16x16x32_bf16 v[108:111], v[188:191], v[216:219], v[108:111]
    v_mfma_f32_16x16x32_bf16 v[112:115], v[176:179], v[220:223], v[112:115]
    v_mfma_f32_16x16x32_bf16 v[116:119], v[180:183], v[220:223], v[116:119]
    v_mfma_f32_16x16x32_bf16 v[120:123], v[184:187], v[220:223], v[120:123]
    v_mfma_f32_16x16x32_bf16 v[124:127], v[188:191], v[220:223], v[124:127]
    s_waitcnt lgkmcnt(0)
    s_waitcnt vmcnt(12)
    s_barrier
    v_mfma_f32_16x16x32_bf16 v[0:3], v[128:131], v[144:147], v[0:3]
    v_mfma_f32_16x16x32_bf16 v[4:7], v[132:135], v[144:147], v[4:7]
    ds_read_b64_tr_b16 v[176:177], v229 offset:0
    s_add_u32 m0, s26, 0
    s_mov_b32 s35, s24
    buffer_load_dwordx4 v226, s[8:11], s35 offen lds
    v_mfma_f32_16x16x32_bf16 v[8:11], v[136:139], v[144:147], v[8:11]
    ds_read_b64_tr_b16 v[178:179], v229 offset:1024
    v_mfma_f32_16x16x32_bf16 v[12:15], v[140:143], v[144:147], v[12:15]
    ds_read_b64_tr_b16 v[180:181], v230 offset:0
    v_mfma_f32_16x16x32_bf16 v[16:19], v[128:131], v[148:151], v[16:19]
    ds_read_b64_tr_b16 v[182:183], v230 offset:1024
    v_mfma_f32_16x16x32_bf16 v[20:23], v[132:135], v[148:151], v[20:23]
    ds_read_b64_tr_b16 v[184:185], v229 offset:8192
    v_mfma_f32_16x16x32_bf16 v[24:27], v[136:139], v[148:151], v[24:27]
    ds_read_b64_tr_b16 v[186:187], v229 offset:9216
    v_mfma_f32_16x16x32_bf16 v[28:31], v[140:143], v[148:151], v[28:31]
    ds_read_b64_tr_b16 v[188:189], v230 offset:8192
    s_add_u32 m0, s26, 8192
    s_add_u32 s35, s35, s46
    buffer_load_dwordx4 v226, s[8:11], s35 offen lds
    v_mfma_f32_16x16x32_bf16 v[32:35], v[128:131], v[152:155], v[32:35]
    ds_read_b64_tr_b16 v[190:191], v230 offset:9216
    v_mfma_f32_16x16x32_bf16 v[36:39], v[132:135], v[152:155], v[36:39]
    ds_read_b128 v[192:195], v228 offset:0
    v_mfma_f32_16x16x32_bf16 v[40:43], v[136:139], v[152:155], v[40:43]
    ds_read_b128 v[196:199], v228 offset:1024
    v_mfma_f32_16x16x32_bf16 v[44:47], v[140:143], v[152:155], v[44:47]
    ds_read_b128 v[200:203], v228 offset:2048
    v_mfma_f32_16x16x32_bf16 v[48:51], v[128:131], v[156:159], v[48:51]
    ds_read_b128 v[204:207], v228 offset:3072
    v_mfma_f32_16x16x32_bf16 v[52:55], v[132:135], v[156:159], v[52:55]
    ds_read_b128 v[208:211], v228 offset:4096
    s_add_u32 m0, s26, 16384
    s_add_u32 s35, s25, 0
    buffer_load_dwordx4 v227, s[12:15], s35 offen lds
    v_mfma_f32_16x16x32_bf16 v[56:59], v[136:139], v[156:159], v[56:59]
    ds_read_b128 v[212:215], v228 offset:5120
    v_mfma_f32_16x16x32_bf16 v[60:63], v[140:143], v[156:159], v[60:63]
    ds_read_b128 v[216:219], v228 offset:6144
    v_mfma_f32_16x16x32_bf16 v[64:67], v[128:131], v[160:163], v[64:67]
    ds_read_b128 v[220:223], v228 offset:7168
    v_mfma_f32_16x16x32_bf16 v[68:71], v[132:135], v[160:163], v[68:71]
    s_add_u32 s48, s48, 1
    s_cmp_eq_u32 s48, 5
    s_cselect_b32 s37, -131072, 0
    s_cselect_b32 s48, 0, s48
    s_cselect_b32 s38, 0, 32768
    s_add_u32 s37, s37, s38
    v_add_u32 v228, s37, v228
    v_add_u32 v229, s37, v229
    v_add_u32 v230, s37, v230
    v_mfma_f32_16x16x32_bf16 v[72:75], v[136:139], v[160:163], v[72:75]
    v_mfma_f32_16x16x32_bf16 v[76:79], v[140:143], v[160:163], v[76:79]
    s_add_u32 m0, s26, 24576
    s_add_u32 s35, s34, 0
    buffer_load_dwordx4 v227, s[16:19], s35 offen lds
    v_mfma_f32_16x16x32_bf16 v[80:83], v[128:131], v[164:167], v[80:83]
    v_mfma_f32_16x16x32_bf16 v[84:87], v[132:135], v[164:167], v[84:87]
    v_mfma_f32_16x16x32_bf16 v[88:91], v[136:139], v[164:167], v[88:91]
    v_mfma_f32_16x16x32_bf16 v[92:95], v[140:143], v[164:167], v[92:95]
    v_mfma_f32_16x16x32_bf16 v[96:99], v[128:131], v[168:171], v[96:99]
    v_mfma_f32_16x16x32_bf16 v[100:103], v[132:135], v[168:171], v[100:103]
    s_add_u32 s24, s24, 64
    s_add_u32 s25, s25, 229376
    s_add_u32 s34, s34, 229376
    s_add_u32 s26, s26, 32768
    s_add_u32 s47, s47, 1
    s_cmp_eq_u32 s47, 5
    s_cselect_b32 s35, 163840, 0
    s_cselect_b32 s47, 0, s47
    s_sub_u32 s26, s26, s35
    v_mfma_f32_16x16x32_bf16 v[104:107], v[136:139], v[168:171], v[104:107]
    v_mfma_f32_16x16x32_bf16 v[108:111], v[140:143], v[168:171], v[108:111]
    v_mfma_f32_16x16x32_bf16 v[112:115], v[128:131], v[172:175], v[112:115]
    v_mfma_f32_16x16x32_bf16 v[116:119], v[132:135], v[172:175], v[116:119]
    v_mfma_f32_16x16x32_bf16 v[120:123], v[136:139], v[172:175], v[120:123]
    v_mfma_f32_16x16x32_bf16 v[124:127], v[140:143], v[172:175], v[124:127]
    s_sub_u32 s27, s27, 1
    s_cmp_lg_u32 s27, 0
    s_cbranch_scc1 L_gu_loop
    s_waitcnt lgkmcnt(0)
    s_waitcnt vmcnt(12)
    s_barrier
    v_mfma_f32_16x16x32_bf16 v[0:3], v[176:179], v[192:195], v[0:3]
    v_mfma_f32_16x16x32_bf16 v[4:7], v[180:183], v[192:195], v[4:7]
    ds_read_b64_tr_b16 v[128:129], v229 offset:0
    v_mfma_f32_16x16x32_bf16 v[8:11], v[184:187], v[192:195], v[8:11]
    ds_read_b64_tr_b16 v[130:131], v229 offset:1024
    v_mfma_f32_16x16x32_bf16 v[12:15], v[188:191], v[192:195], v[12:15]
    ds_read_b64_tr_b16 v[132:133], v230 offset:0
    v_mfma_f32_16x16x32_bf16 v[16:19], v[176:179], v[196:199], v[16:19]
    ds_read_b64_tr_b16 v[134:135], v230 offset:1024
    v_mfma_f32_16x16x32_bf16 v[20:23], v[180:183], v[196:199], v[20:23]
    ds_read_b64_tr_b16 v[136:137], v229 offset:8192
    v_mfma_f32_16x16x32_bf16 v[24:27], v[184:187], v[196:199], v[24:27]
    ds_read_b64_tr_b16 v[138:139], v229 offset:9216
    v_mfma_f32_16x16x32_bf16 v[28:31], v[188:191], v[196:199], v[28:31]
    ds_read_b64_tr_b16 v[140:141], v230 offset:8192
    v_mfma_f32_16x16x32_bf16 v[32:35], v[176:179], v[200:203], v[32:35]
    ds_read_b64_tr_b16 v[142:143], v230 offset:9216
    v_mfma_f32_16x16x32_bf16 v[36:39], v[180:183], v[200:203], v[36:39]
    ds_read_b128 v[144:147], v228 offset:0
    v_mfma_f32_16x16x32_bf16 v[40:43], v[184:187], v[200:203], v[40:43]
    ds_read_b128 v[148:151], v228 offset:1024
    v_mfma_f32_16x16x32_bf16 v[44:47], v[188:191], v[200:203], v[44:47]
    ds_read_b128 v[152:155], v228 offset:2048
    v_mfma_f32_16x16x32_bf16 v[48:51], v[176:179], v[204:207], v[48:51]
    ds_read_b128 v[156:159], v228 offset:3072
    v_mfma_f32_16x16x32_bf16 v[52:55], v[180:183], v[204:207], v[52:55]
    ds_read_b128 v[160:163], v228 offset:4096
    v_mfma_f32_16x16x32_bf16 v[56:59], v[184:187], v[204:207], v[56:59]
    ds_read_b128 v[164:167], v228 offset:5120
    v_mfma_f32_16x16x32_bf16 v[60:63], v[188:191], v[204:207], v[60:63]
    ds_read_b128 v[168:171], v228 offset:6144
    v_mfma_f32_16x16x32_bf16 v[64:67], v[176:179], v[208:211], v[64:67]
    ds_read_b128 v[172:175], v228 offset:7168
    v_mfma_f32_16x16x32_bf16 v[68:71], v[180:183], v[208:211], v[68:71]
    s_add_u32 s48, s48, 1
    s_cmp_eq_u32 s48, 5
    s_cselect_b32 s37, -131072, 0
    s_cselect_b32 s48, 0, s48
    s_cselect_b32 s38, 0, 32768
    s_add_u32 s37, s37, s38
    v_add_u32 v228, s37, v228
    v_add_u32 v229, s37, v229
    v_add_u32 v230, s37, v230
    v_mfma_f32_16x16x32_bf16 v[72:75], v[184:187], v[208:211], v[72:75]
    v_mfma_f32_16x16x32_bf16 v[76:79], v[188:191], v[208:211], v[76:79]
    v_mfma_f32_16x16x32_bf16 v[80:83], v[176:179], v[212:215], v[80:83]
    v_mfma_f32_16x16x32_bf16 v[84:87], v[180:183], v[212:215], v[84:87]
    v_mfma_f32_16x16x32_bf16 v[88:91], v[184:187], v[212:215], v[88:91]
    v_mfma_f32_16x16x32_bf16 v[92:95], v[188:191], v[212:215], v[92:95]
    v_mfma_f32_16x16x32_bf16 v[96:99], v[176:179], v[216:219], v[96:99]
    v_mfma_f32_16x16x32_bf16 v[100:103], v[180:183], v[216:219], v[100:103]
    v_mfma_f32_16x16x32_bf16 v[104:107], v[184:187], v[216:219], v[104:107]
    v_mfma_f32_16x16x32_bf16 v[108:111], v[188:191], v[216:219], v[108:111]
    v_mfma_f32_16x16x32_bf16 v[112:115], v[176:179], v[220:223], v[112:115]
    v_mfma_f32_16x16x32_bf16 v[116:119], v[180:183], v[220:223], v[116:119]
    v_mfma_f32_16x16x32_bf16 v[120:123], v[184:187], v[220:223], v[120:123]
    v_mfma_f32_16x16x32_bf16 v[124:127], v[188:191], v[220:223], v[124:127]
    s_waitcnt lgkmcnt(0)
    s_waitcnt vmcnt(8)
    s_barrier
    v_mfma_f32_16x16x32_bf16 v[0:3], v[128:131], v[144:147], v[0:3]
    v_mfma_f32_16x16x32_bf16 v[4:7], v[132:135], v[144:147], v[4:7]
    ds_read_b64_tr_b16 v[176:177], v229 offset:0
    v_mfma_f32_16x16x32_bf16 v[8:11], v[136:139], v[144:147], v[8:11]
    ds_read_b64_tr_b16 v[178:179], v229 offset:1024
    v_mfma_f32_16x16x32_bf16 v[12:15], v[140:143], v[144:147], v[12:15]
    ds_read_b64_tr_b16 v[180:181], v230 offset:0
    v_mfma_f32_16x16x32_bf16 v[16:19], v[128:131], v[148:151], v[16:19]
    ds_read_b64_tr_b16 v[182:183], v230 offset:1024
    v_mfma_f32_16x16x32_bf16 v[20:23], v[132:135], v[148:151], v[20:23]
    ds_read_b64_tr_b16 v[184:185], v229 offset:8192
    v_mfma_f32_16x16x32_bf16 v[24:27], v[136:139], v[148:151], v[24:27]
    ds_read_b64_tr_b16 v[186:187], v229 offset:9216
    v_mfma_f32_16x16x32_bf16 v[28:31], v[140:143], v[148:151], v[28:31]
    ds_read_b64_tr_b16 v[188:189], v230 offset:8192
    v_mfma_f32_16x16x32_bf16 v[32:35], v[128:131], v[152:155], v[32:35]
    ds_read_b64_tr_b16 v[190:191], v230 offset:9216
    v_mfma_f32_16x16x32_bf16 v[36:39], v[132:135], v[152:155], v[36:39]
    ds_read_b128 v[192:195], v228 offset:0
    v_mfma_f32_16x16x32_bf16 v[40:43], v[136:139], v[152:155], v[40:43]
    ds_read_b128 v[196:199], v228 offset:1024
    v_mfma_f32_16x16x32_bf16 v[44:47], v[140:143], v[152:155], v[44:47]
    ds_read_b128 v[200:203], v228 offset:2048
    v_mfma_f32_16x16x32_bf16 v[48:51], v[128:131], v[156:159], v[48:51]
    ds_read_b128 v[204:207], v228 offset:3072
    v_mfma_f32_16x16x32_bf16 v[52:55], v[132:135], v[156:159], v[52:55]
    ds_read_b128 v[208:211], v228 offset:4096
    v_mfma_f32_16x16x32_bf16 v[56:59], v[136:139], v[156:159], v[56:59]
    ds_read_b128 v[212:215], v228 offset:5120
    v_mfma_f32_16x16x32_bf16 v[60:63], v[140:143], v[156:159], v[60:63]
    ds_read_b128 v[216:219], v228 offset:6144
    v_mfma_f32_16x16x32_bf16 v[64:67], v[128:131], v[160:163], v[64:67]
    ds_read_b128 v[220:223], v228 offset:7168
    v_mfma_f32_16x16x32_bf16 v[68:71], v[132:135], v[160:163], v[68:71]
    s_add_u32 s48, s48, 1
    s_cmp_eq_u32 s48, 5
    s_cselect_b32 s37, -131072, 0
    s_cselect_b32 s48, 0, s48
    s_cselect_b32 s38, 0, 32768
    s_add_u32 s37, s37, s38
    v_add_u32 v228, s37, v228
    v_add_u32 v229, s37, v229
    v_add_u32 v230, s37, v230
    v_mfma_f32_16x16x32_bf16 v[72:75], v[136:139], v[160:163], v[72:75]
    v_mfma_f32_16x16x32_bf16 v[76:79], v[140:143], v[160:163], v[76:79]
    v_mfma_f32_16x16x32_bf16 v[80:83], v[128:131], v[164:167], v[80:83]
    v_mfma_f32_16x16x32_bf16 v[84:87], v[132:135], v[164:167], v[84:87]
    v_mfma_f32_16x16x32_bf16 v[88:91], v[136:139], v[164:167], v[88:91]
    v_mfma_f32_16x16x32_bf16 v[92:95], v[140:143], v[164:167], v[92:95]
    v_mfma_f32_16x16x32_bf16 v[96:99], v[128:131], v[168:171], v[96:99]
    v_mfma_f32_16x16x32_bf16 v[100:103], v[132:135], v[168:171], v[100:103]
    v_mfma_f32_16x16x32_bf16 v[104:107], v[136:139], v[168:171], v[104:107]
    v_mfma_f32_16x16x32_bf16 v[108:111], v[140:143], v[168:171], v[108:111]
    v_mfma_f32_16x16x32_bf16 v[112:115], v[128:131], v[172:175], v[112:115]
    v_mfma_f32_16x16x32_bf16 v[116:119], v[132:135], v[172:175], v[116:119]
    v_mfma_f32_16x16x32_bf16 v[120:123], v[136:139], v[172:175], v[120:123]
    v_mfma_f32_16x16x32_bf16 v[124:127], v[140:143], v[172:175], v[124:127]
    s_waitcnt lgkmcnt(0)
    s_waitcnt vmcnt(4)
    s_barrier
    v_mfma_f32_16x16x32_bf16 v[0:3], v[176:179], v[192:195], v[0:3]
    v_mfma_f32_16x16x32_bf16 v[4:7], v[180:183], v[192:195], v[4:7]
    ds_read_b64_tr_b16 v[128:129], v229 offset:0
    v_mfma_f32_16x16x32_bf16 v[8:11], v[184:187], v[192:195], v[8:11]
    ds_read_b64_tr_b16 v[130:131], v229 offset:1024
    v_mfma_f32_16x16x32_bf16 v[12:15], v[188:191], v[192:195], v[12:15]
    ds_read_b64_tr_b16 v[132:133], v230 offset:0
    v_mfma_f32_16x16x32_bf16 v[16:19], v[176:179], v[196:199], v[16:19]
    ds_read_b64_tr_b16 v[134:135], v230 offset:1024
    v_mfma_f32_16x16x32_bf16 v[20:23], v[180:183], v[196:199], v[20:23]
    ds_read_b64_tr_b16 v[136:137], v229 offset:8192
    v_mfma_f32_16x16x32_bf16 v[24:27], v[184:187], v[196:199], v[24:27]
    ds_read_b64_tr_b16 v[138:139], v229 offset:9216
    v_mfma_f32_16x16x32_bf16 v[28:31], v[188:191], v[196:199], v[28:31]
    ds_read_b64_tr_b16 v[140:141], v230 offset:8192
    v_mfma_f32_16x16x32_bf16 v[32:35], v[176:179], v[200:203], v[32:35]
    ds_read_b64_tr_b16 v[142:143], v230 offset:9216
    v_mfma_f32_16x16x32_bf16 v[36:39], v[180:183], v[200:203], v[36:39]
    ds_read_b128 v[144:147], v228 offset:0
    v_mfma_f32_16x16x32_bf16 v[40:43], v[184:187], v[200:203], v[40:43]
    ds_read_b128 v[148:151], v228 offset:1024
    v_mfma_f32_16x16x32_bf16 v[44:47], v[188:191], v[200:203], v[44:47]
    ds_read_b128 v[152:155], v228 offset:2048
    v_mfma_f32_16x16x32_bf16 v[48:51], v[176:179], v[204:207], v[48:51]
    ds_read_b128 v[156:159], v228 offset:3072
    v_mfma_f32_16x16x32_bf16 v[52:55], v[180:183], v[204:207], v[52:55]
    ds_read_b128 v[160:163], v228 offset:4096
    v_mfma_f32_16x16x32_bf16 v[56:59], v[184:187], v[204:207], v[56:59]
    ds_read_b128 v[164:167], v228 offset:5120
    v_mfma_f32_16x16x32_bf16 v[60:63], v[188:191], v[204:207], v[60:63]
    ds_read_b128 v[168:171], v228 offset:6144
    v_mfma_f32_16x16x32_bf16 v[64:67], v[176:179], v[208:211], v[64:67]
    ds_read_b128 v[172:175], v228 offset:7168
    v_mfma_f32_16x16x32_bf16 v[68:71], v[180:183], v[208:211], v[68:71]
    s_add_u32 s48, s48, 1
    s_cmp_eq_u32 s48, 5
    s_cselect_b32 s37, -131072, 0
    s_cselect_b32 s48, 0, s48
    s_cselect_b32 s38, 0, 32768
    s_add_u32 s37, s37, s38
    v_add_u32 v228, s37, v228
    v_add_u32 v229, s37, v229
    v_add_u32 v230, s37, v230
    v_mfma_f32_16x16x32_bf16 v[72:75], v[184:187], v[208:211], v[72:75]
    v_mfma_f32_16x16x32_bf16 v[76:79], v[188:191], v[208:211], v[76:79]
    v_mfma_f32_16x16x32_bf16 v[80:83], v[176:179], v[212:215], v[80:83]
    v_mfma_f32_16x16x32_bf16 v[84:87], v[180:183], v[212:215], v[84:87]
    v_mfma_f32_16x16x32_bf16 v[88:91], v[184:187], v[212:215], v[88:91]
    v_mfma_f32_16x16x32_bf16 v[92:95], v[188:191], v[212:215], v[92:95]
    v_mfma_f32_16x16x32_bf16 v[96:99], v[176:179], v[216:219], v[96:99]
    v_mfma_f32_16x16x32_bf16 v[100:103], v[180:183], v[216:219], v[100:103]
    v_mfma_f32_16x16x32_bf16 v[104:107], v[184:187], v[216:219], v[104:107]
    v_mfma_f32_16x16x32_bf16 v[108:111], v[188:191], v[216:219], v[108:111]
    v_mfma_f32_16x16x32_bf16 v[112:115], v[176:179], v[220:223], v[112:115]
    v_mfma_f32_16x16x32_bf16 v[116:119], v[180:183], v[220:223], v[116:119]
    v_mfma_f32_16x16x32_bf16 v[120:123], v[184:187], v[220:223], v[120:123]
    v_mfma_f32_16x16x32_bf16 v[124:127], v[188:191], v[220:223], v[124:127]
    s_waitcnt lgkmcnt(0)
    s_waitcnt vmcnt(0)
    s_barrier
    v_mfma_f32_16x16x32_bf16 v[0:3], v[128:131], v[144:147], v[0:3]
    v_mfma_f32_16x16x32_bf16 v[4:7], v[132:135], v[144:147], v[4:7]
    ds_read_b64_tr_b16 v[176:177], v229 offset:0
    v_mfma_f32_16x16x32_bf16 v[8:11], v[136:139], v[144:147], v[8:11]
    ds_read_b64_tr_b16 v[178:179], v229 offset:1024
    v_mfma_f32_16x16x32_bf16 v[12:15], v[140:143], v[144:147], v[12:15]
    ds_read_b64_tr_b16 v[180:181], v230 offset:0
    v_mfma_f32_16x16x32_bf16 v[16:19], v[128:131], v[148:151], v[16:19]
    ds_read_b64_tr_b16 v[182:183], v230 offset:1024
    v_mfma_f32_16x16x32_bf16 v[20:23], v[132:135], v[148:151], v[20:23]
    ds_read_b64_tr_b16 v[184:185], v229 offset:8192
    v_mfma_f32_16x16x32_bf16 v[24:27], v[136:139], v[148:151], v[24:27]
    ds_read_b64_tr_b16 v[186:187], v229 offset:9216
    v_mfma_f32_16x16x32_bf16 v[28:31], v[140:143], v[148:151], v[28:31]
    ds_read_b64_tr_b16 v[188:189], v230 offset:8192
    v_mfma_f32_16x16x32_bf16 v[32:35], v[128:131], v[152:155], v[32:35]
    ds_read_b64_tr_b16 v[190:191], v230 offset:9216
    v_mfma_f32_16x16x32_bf16 v[36:39], v[132:135], v[152:155], v[36:39]
    ds_read_b128 v[192:195], v228 offset:0
    v_mfma_f32_16x16x32_bf16 v[40:43], v[136:139], v[152:155], v[40:43]
    ds_read_b128 v[196:199], v228 offset:1024
    v_mfma_f32_16x16x32_bf16 v[44:47], v[140:143], v[152:155], v[44:47]
    ds_read_b128 v[200:203], v228 offset:2048
    v_mfma_f32_16x16x32_bf16 v[48:51], v[128:131], v[156:159], v[48:51]
    ds_read_b128 v[204:207], v228 offset:3072
    v_mfma_f32_16x16x32_bf16 v[52:55], v[132:135], v[156:159], v[52:55]
    ds_read_b128 v[208:211], v228 offset:4096
    v_mfma_f32_16x16x32_bf16 v[56:59], v[136:139], v[156:159], v[56:59]
    ds_read_b128 v[212:215], v228 offset:5120
    v_mfma_f32_16x16x32_bf16 v[60:63], v[140:143], v[156:159], v[60:63]
    ds_read_b128 v[216:219], v228 offset:6144
    v_mfma_f32_16x16x32_bf16 v[64:67], v[128:131], v[160:163], v[64:67]
    ds_read_b128 v[220:223], v228 offset:7168
    v_mfma_f32_16x16x32_bf16 v[68:71], v[132:135], v[160:163], v[68:71]
    s_add_u32 s48, s48, 1
    s_cmp_eq_u32 s48, 5
    s_cselect_b32 s37, -131072, 0
    s_cselect_b32 s48, 0, s48
    s_cselect_b32 s38, 0, 32768
    s_add_u32 s37, s37, s38
    v_add_u32 v228, s37, v228
    v_add_u32 v229, s37, v229
    v_add_u32 v230, s37, v230
    v_mfma_f32_16x16x32_bf16 v[72:75], v[136:139], v[160:163], v[72:75]
    v_mfma_f32_16x16x32_bf16 v[76:79], v[140:143], v[160:163], v[76:79]
    v_mfma_f32_16x16x32_bf16 v[80:83], v[128:131], v[164:167], v[80:83]
    v_mfma_f32_16x16x32_bf16 v[84:87], v[132:135], v[164:167], v[84:87]
    v_mfma_f32_16x16x32_bf16 v[88:91], v[136:139], v[164:167], v[88:91]
    v_mfma_f32_16x16x32_bf16 v[92:95], v[140:143], v[164:167], v[92:95]
    v_mfma_f32_16x16x32_bf16 v[96:99], v[128:131], v[168:171], v[96:99]
    v_mfma_f32_16x16x32_bf16 v[100:103], v[132:135], v[168:171], v[100:103]
    v_mfma_f32_16x16x32_bf16 v[104:107], v[136:139], v[168:171], v[104:107]
    v_mfma_f32_16x16x32_bf16 v[108:111], v[140:143], v[168:171], v[108:111]
    v_mfma_f32_16x16x32_bf16 v[112:115], v[128:131], v[172:175], v[112:115]
    v_mfma_f32_16x16x32_bf16 v[116:119], v[132:135], v[172:175], v[116:119]
    v_mfma_f32_16x16x32_bf16 v[120:123], v[136:139], v[172:175], v[120:123]
    v_mfma_f32_16x16x32_bf16 v[124:127], v[140:143], v[172:175], v[124:127]
    s_waitcnt lgkmcnt(0)
    v_mfma_f32_16x16x32_bf16 v[0:3], v[176:179], v[192:195], v[0:3]
    v_mfma_f32_16x16x32_bf16 v[4:7], v[180:183], v[192:195], v[4:7]
    v_mfma_f32_16x16x32_bf16 v[8:11], v[184:187], v[192:195], v[8:11]
    v_mfma_f32_16x16x32_bf16 v[12:15], v[188:191], v[192:195], v[12:15]
    v_mfma_f32_16x16x32_bf16 v[16:19], v[176:179], v[196:199], v[16:19]
    v_mfma_f32_16x16x32_bf16 v[20:23], v[180:183], v[196:199], v[20:23]
    v_mfma_f32_16x16x32_bf16 v[24:27], v[184:187], v[196:199], v[24:27]
    v_mfma_f32_16x16x32_bf16 v[28:31], v[188:191], v[196:199], v[28:31]
    v_mfma_f32_16x16x32_bf16 v[32:35], v[176:179], v[200:203], v[32:35]
    v_mfma_f32_16x16x32_bf16 v[36:39], v[180:183], v[200:203], v[36:39]
    v_mfma_f32_16x16x32_bf16 v[40:43], v[184:187], v[200:203], v[40:43]
    v_mfma_f32_16x16x32_bf16 v[44:47], v[188:191], v[200:203], v[44:47]
    v_mfma_f32_16x16x32_bf16 v[48:51], v[176:179], v[204:207], v[48:51]
    v_mfma_f32_16x16x32_bf16 v[52:55], v[180:183], v[204:207], v[52:55]
    v_mfma_f32_16x16x32_bf16 v[56:59], v[184:187], v[204:207], v[56:59]
    v_mfma_f32_16x16x32_bf16 v[60:63], v[188:191], v[204:207], v[60:63]
    v_mfma_f32_16x16x32_bf16 v[64:67], v[176:179], v[208:211], v[64:67]
    v_mfma_f32_16x16x32_bf16 v[68:71], v[180:183], v[208:211], v[68:71]
    v_mfma_f32_16x16x32_bf16 v[72:75], v[184:187], v[208:211], v[72:75]
    v_mfma_f32_16x16x32_bf16 v[76:79], v[188:191], v[208:211], v[76:79]
    v_mfma_f32_16x16x32_bf16 v[80:83], v[176:179], v[212:215], v[80:83]
    v_mfma_f32_16x16x32_bf16 v[84:87], v[180:183], v[212:215], v[84:87]
    v_mfma_f32_16x16x32_bf16 v[88:91], v[184:187], v[212:215], v[88:91]
    v_mfma_f32_16x16x32_bf16 v[92:95], v[188:191], v[212:215], v[92:95]
    v_mfma_f32_16x16x32_bf16 v[96:99], v[176:179], v[216:219], v[96:99]
    v_mfma_f32_16x16x32_bf16 v[100:103], v[180:183], v[216:219], v[100:103]
    v_mfma_f32_16x16x32_bf16 v[104:107], v[184:187], v[216:219], v[104:107]
    v_mfma_f32_16x16x32_bf16 v[108:111], v[188:191], v[216:219], v[108:111]
    v_mfma_f32_16x16x32_bf16 v[112:115], v[176:179], v[220:223], v[112:115]
    v_mfma_f32_16x16x32_bf16 v[116:119], v[180:183], v[220:223], v[116:119]
    v_mfma_f32_16x16x32_bf16 v[120:123], v[184:187], v[220:223], v[120:123]
    v_mfma_f32_16x16x32_bf16 v[124:127], v[188:191], v[220:223], v[124:127]
    s_nop 7
    v_bfe_u32 v232, v225, 2, 1
    v_mul_u32_u24 v231, 8, v232
    s_mul_i32 s33, s30, 16
    v_add_u32 v231, s33, v231
    v_mul_u32_u24 v231, 112, v231
    v_and_b32 v232, 3, v225
    v_add_u32 v231, v231, v232
    s_lshl_b32 s33, s31, 2
    v_add_u32 v231, s33, v231
    v_lshlrev_b32 v231, 10, v231
    v_lshl_add_u32 v228, v224, 4, v231
    s_mov_b32 s37, 0
    v_max_f32 v0, 0, v0
    v_mul_f32 v0, v0, v8
    v_max_f32 v1, 0, v1
    v_mul_f32 v1, v1, v9
    v_max_f32 v2, 0, v2
    v_mul_f32 v2, v2, v10
    v_max_f32 v3, 0, v3
    v_mul_f32 v3, v3, v11
    v_max_f32 v4, 0, v4
    v_mul_f32 v4, v4, v12
    v_max_f32 v5, 0, v5
    v_mul_f32 v5, v5, v13
    v_max_f32 v6, 0, v6
    v_mul_f32 v6, v6, v14
    v_max_f32 v7, 0, v7
    v_mul_f32 v7, v7, v15
    v_cvt_pk_bf16_f32 v128, v0, v1
    v_cvt_pk_bf16_f32 v129, v2, v3
    v_cvt_pk_bf16_f32 v130, v4, v5
    v_cvt_pk_bf16_f32 v131, v6, v7
    s_nop 1
    v_permlane16_swap_b32 v128, v130
    v_permlane16_swap_b32 v129, v131
    buffer_store_dwordx4 v[128:131], v228, s[20:23], s37 offen
    s_mov_b32 s37, 114688
    v_max_f32 v16, 0, v16
    v_mul_f32 v16, v16, v24
    v_max_f32 v17, 0, v17
    v_mul_f32 v17, v17, v25
    v_max_f32 v18, 0, v18
    v_mul_f32 v18, v18, v26
    v_max_f32 v19, 0, v19
    v_mul_f32 v19, v19, v27
    v_max_f32 v20, 0, v20
    v_mul_f32 v20, v20, v28
    v_max_f32 v21, 0, v21
    v_mul_f32 v21, v21, v29
    v_max_f32 v22, 0, v22
    v_mul_f32 v22, v22, v30
    v_max_f32 v23, 0, v23
    v_mul_f32 v23, v23, v31
    v_cvt_pk_bf16_f32 v132, v16, v17
    v_cvt_pk_bf16_f32 v133, v18, v19
    v_cvt_pk_bf16_f32 v134, v20, v21
    v_cvt_pk_bf16_f32 v135, v22, v23
    s_nop 1
    v_permlane16_swap_b32 v132, v134
    v_permlane16_swap_b32 v133, v135
    buffer_store_dwordx4 v[132:135], v228, s[20:23], s37 offen
    s_mov_b32 s37, 229376
    v_max_f32 v32, 0, v32
    v_mul_f32 v32, v32, v40
    v_max_f32 v33, 0, v33
    v_mul_f32 v33, v33, v41
    v_max_f32 v34, 0, v34
    v_mul_f32 v34, v34, v42
    v_max_f32 v35, 0, v35
    v_mul_f32 v35, v35, v43
    v_max_f32 v36, 0, v36
    v_mul_f32 v36, v36, v44
    v_max_f32 v37, 0, v37
    v_mul_f32 v37, v37, v45
    v_max_f32 v38, 0, v38
    v_mul_f32 v38, v38, v46
    v_max_f32 v39, 0, v39
    v_mul_f32 v39, v39, v47
    v_cvt_pk_bf16_f32 v136, v32, v33
    v_cvt_pk_bf16_f32 v137, v34, v35
    v_cvt_pk_bf16_f32 v138, v36, v37
    v_cvt_pk_bf16_f32 v139, v38, v39
    s_nop 1
    v_permlane16_swap_b32 v136, v138
    v_permlane16_swap_b32 v137, v139
    buffer_store_dwordx4 v[136:139], v228, s[20:23], s37 offen
    s_mov_b32 s37, 344064
    v_max_f32 v48, 0, v48
    v_mul_f32 v48, v48, v56
    v_max_f32 v49, 0, v49
    v_mul_f32 v49, v49, v57
    v_max_f32 v50, 0, v50
    v_mul_f32 v50, v50, v58
    v_max_f32 v51, 0, v51
    v_mul_f32 v51, v51, v59
    v_max_f32 v52, 0, v52
    v_mul_f32 v52, v52, v60
    v_max_f32 v53, 0, v53
    v_mul_f32 v53, v53, v61
    v_max_f32 v54, 0, v54
    v_mul_f32 v54, v54, v62
    v_max_f32 v55, 0, v55
    v_mul_f32 v55, v55, v63
    v_cvt_pk_bf16_f32 v140, v48, v49
    v_cvt_pk_bf16_f32 v141, v50, v51
    v_cvt_pk_bf16_f32 v142, v52, v53
    v_cvt_pk_bf16_f32 v143, v54, v55
    s_nop 1
    v_permlane16_swap_b32 v140, v142
    v_permlane16_swap_b32 v141, v143
    buffer_store_dwordx4 v[140:143], v228, s[20:23], s37 offen
    s_mov_b32 s37, 458752
    v_max_f32 v64, 0, v64
    v_mul_f32 v64, v64, v72
    v_max_f32 v65, 0, v65
    v_mul_f32 v65, v65, v73
    v_max_f32 v66, 0, v66
    v_mul_f32 v66, v66, v74
    v_max_f32 v67, 0, v67
    v_mul_f32 v67, v67, v75
    v_max_f32 v68, 0, v68
    v_mul_f32 v68, v68, v76
    v_max_f32 v69, 0, v69
    v_mul_f32 v69, v69, v77
    v_max_f32 v70, 0, v70
    v_mul_f32 v70, v70, v78
    v_max_f32 v71, 0, v71
    v_mul_f32 v71, v71, v79
    v_cvt_pk_bf16_f32 v128, v64, v65
    v_cvt_pk_bf16_f32 v129, v66, v67
    v_cvt_pk_bf16_f32 v130, v68, v69
    v_cvt_pk_bf16_f32 v131, v70, v71
    s_nop 1
    v_permlane16_swap_b32 v128, v130
    v_permlane16_swap_b32 v129, v131
    buffer_store_dwordx4 v[128:131], v228, s[20:23], s37 offen
    s_mov_b32 s37, 573440
    v_max_f32 v80, 0, v80
    v_mul_f32 v80, v80, v88
    v_max_f32 v81, 0, v81
    v_mul_f32 v81, v81, v89
    v_max_f32 v82, 0, v82
    v_mul_f32 v82, v82, v90
    v_max_f32 v83, 0, v83
    v_mul_f32 v83, v83, v91
    v_max_f32 v84, 0, v84
    v_mul_f32 v84, v84, v92
    v_max_f32 v85, 0, v85
    v_mul_f32 v85, v85, v93
    v_max_f32 v86, 0, v86
    v_mul_f32 v86, v86, v94
    v_max_f32 v87, 0, v87
    v_mul_f32 v87, v87, v95
    v_cvt_pk_bf16_f32 v132, v80, v81
    v_cvt_pk_bf16_f32 v133, v82, v83
    v_cvt_pk_bf16_f32 v134, v84, v85
    v_cvt_pk_bf16_f32 v135, v86, v87
    s_nop 1
    v_permlane16_swap_b32 v132, v134
    v_permlane16_swap_b32 v133, v135
    buffer_store_dwordx4 v[132:135], v228, s[20:23], s37 offen
    s_mov_b32 s37, 688128
    v_max_f32 v96, 0, v96
    v_mul_f32 v96, v96, v104
    v_max_f32 v97, 0, v97
    v_mul_f32 v97, v97, v105
    v_max_f32 v98, 0, v98
    v_mul_f32 v98, v98, v106
    v_max_f32 v99, 0, v99
    v_mul_f32 v99, v99, v107
    v_max_f32 v100, 0, v100
    v_mul_f32 v100, v100, v108
    v_max_f32 v101, 0, v101
    v_mul_f32 v101, v101, v109
    v_max_f32 v102, 0, v102
    v_mul_f32 v102, v102, v110
    v_max_f32 v103, 0, v103
    v_mul_f32 v103, v103, v111
    v_cvt_pk_bf16_f32 v136, v96, v97
    v_cvt_pk_bf16_f32 v137, v98, v99
    v_cvt_pk_bf16_f32 v138, v100, v101
    v_cvt_pk_bf16_f32 v139, v102, v103
    s_nop 1
    v_permlane16_swap_b32 v136, v138
    v_permlane16_swap_b32 v137, v139
    buffer_store_dwordx4 v[136:139], v228, s[20:23], s37 offen
    s_mov_b32 s37, 802816
    v_max_f32 v112, 0, v112
    v_mul_f32 v112, v112, v120
    v_max_f32 v113, 0, v113
    v_mul_f32 v113, v113, v121
    v_max_f32 v114, 0, v114
    v_mul_f32 v114, v114, v122
    v_max_f32 v115, 0, v115
    v_mul_f32 v115, v115, v123
    v_max_f32 v116, 0, v116
    v_mul_f32 v116, v116, v124
    v_max_f32 v117, 0, v117
    v_mul_f32 v117, v117, v125
    v_max_f32 v118, 0, v118
    v_mul_f32 v118, v118, v126
    v_max_f32 v119, 0, v119
    v_mul_f32 v119, v119, v127
    v_cvt_pk_bf16_f32 v140, v112, v113
    v_cvt_pk_bf16_f32 v141, v114, v115
    v_cvt_pk_bf16_f32 v142, v116, v117
    v_cvt_pk_bf16_f32 v143, v118, v119
    s_nop 1
    v_permlane16_swap_b32 v140, v142
    v_permlane16_swap_b32 v141, v143
    buffer_store_dwordx4 v[140:143], v228, s[20:23], s37 offen
    s_endpgm
.section .rodata,"a"
.p2align 6
.amdhsa_kernel attn_kernel
  .amdhsa_next_free_vgpr 241
  .amdhsa_next_free_sgpr 100
  .amdhsa_accum_offset 244
  .amdhsa_group_segment_fixed_size 0
  .amdhsa_kernarg_size 96
  .amdhsa_user_sgpr_count 2
  .amdhsa_user_sgpr_kernarg_segment_ptr 1
  .amdhsa_system_sgpr_workgroup_id_x 1
  .amdhsa_float_denorm_mode_32 3
.end_amdhsa_kernel
.text
.globl g2_kernel
.p2align 8
.type g2_kernel,@function
g2_kernel:
    s_cmp_ge_u32 s2, 256
    s_cbranch_scc1 L_g2_done
    s_load_dwordx2 s[4:5], s[0:1], 88
    s_load_dwordx2 s[6:7], s[0:1], 32
    s_load_dwordx2 s[28:29], s[0:1], 64
    s_and_b32 s3, s2, 7
    s_lshr_b32 s40, s3, 2
    s_bfe_u32 s49, s3, 0x10001
    s_and_b32 s30, s3, 1
    s_lshl_b32 s30, s30, 2
    s_bfe_u32 s31, s2, 0x20003
    s_add_u32 s30, s30, s31
    s_lshr_b32 s31, s2, 5
    v_and_b32 v224, 63, v0
    v_lshrrev_b32 v225, 6, v0
    s_nop 0
    v_readfirstlane_b32 s32, v225
    s_waitcnt lgkmcnt(0)
    s_mov_b32 s41, 8192
    s_mov_b32 s42, 32
    s_mov_b32 s43, 0x2400000
    s_mov_b32 s44, 0x1000000
    s_mov_b32 s45, 0x3400000
    s_mov_b32 s12, s6
    s_mov_b32 s13, s7
    s_mov_b32 s14, 0x800000
    s_cmp_eq_u32 s40, 0
    s_cbranch_scc1 L_g2_sel
    s_mov_b32 s41, 7168
    s_mov_b32 s42, 28
    s_mov_b32 s43, 0x1400000
    s_mov_b32 s44, 0xe00000
    s_mov_b32 s45, 0x3c00000
    s_mov_b32 s12, s28
    s_mov_b32 s13, s29
    s_mov_b32 s14, 0x700000
L_g2_sel:
    s_and_b32 s13, s13, 0xffff
    s_mov_b32 s15, 0x00020000
    s_add_u32 s8, s4, s43
    s_addc_u32 s9, s5, 0
    s_and_b32 s9, s9, 0xffff
    s_mov_b32 s10, s44
    s_mov_b32 s11, 0x00020000
    s_lshl_b32 s33, s49, 22
    s_add_u32 s45, s45, s33
    s_add_u32 s20, s4, s45
    s_addc_u32 s21, s5, 0
    s_and_b32 s21, s21, 0xffff
    s_mov_b32 s22, 0x400000
    s_mov_b32 s23, 0x00020000
    v_lshrrev_b32 v233, 3, v224
    v_lshrrev_b32 v234, 4, v224
    v_and_b32 v235, 1, v225
    v_lshl_add_u32 v234, v235, 2, v234
    v_xor_b32 v234, v234, v224
    v_and_b32 v234, 7, v234
    v_mul_u32_u24 v235, 8, v225
    v_add_u32 v233, v233, v235
    s_mul_i32 s33, s30, 256
    v_add_u32 v233, s33, v233
    v_and_b32 v233, 3, v225
    v_lshl_add_u32 v233, v233, 6, v224
    s_mul_i32 s33, s30, 256
    v_add_u32 v233, s33, v233
    v_lshrrev_b32 v234, 2, v225
    s_cmp_eq_u32 s40, 0
    s_cbranch_scc0 L_g2_xh
    v_lshrrev_b32 v235, 4, v233
    v_lshlrev_b32 v235, 17, v235
    v_lshl_add_u32 v235, v234, 9, v235
    v_and_b32 v236, 15, v233
    v_lshl_add_u32 v226, v236, 4, v235
    s_mov_b32 s51, 256
    s_mov_b32 s52, 1024
    s_mov_b32 s53, 1280
    s_mov_b32 s50, 2048
    s_branch L_g2_xj
    v_lshrrev_b32 v235, 5, v233
    v_lshlrev_b32 v235, 18, v235
    v_lshl_add_u32 v235, v234, 9, v235
    v_and_b32 v236, 31, v233
    v_lshl_add_u32 v226, v236, 4, v235
    s_mov_b32 s51, 1024
    s_mov_b32 s52, 2048
    s_mov_b32 s53, 3072
    s_mov_b32 s50, 4096
    s_branch L_g2_xj
L_g2_xh:
    v_lshrrev_b32 v235, 4, v233
    s_mov_b32 s33, 114688
    v_mul_lo_u32 v235, v235, s33
    v_lshl_add_u32 v235, v234, 9, v235
    v_and_b32 v236, 15, v233
    v_lshl_add_u32 v226, v236, 4, v235
    s_mov_b32 s51, 256
    s_mov_b32 s52, 1024
    s_mov_b32 s53, 1280
    s_mov_b32 s50, 2048
L_g2_xj:
    v_lshrrev_b32 v233, 4, v224
    v_and_b32 v234, 15, v224
    v_lshlrev_b32 v235, 1, v233
    v_xor_b32 v234, v234, v235
    v_bfe_u32 v235, v225, 1, 1
    v_lshlrev_b32 v235, 3, v235
    v_xor_b32 v234, v234, v235
    v_lshl_add_u32 v233, v225, 2, v233
    s_mov_b32 s33, 2048
    v_mul_lo_u32 v233, v233, s33
    v_lshl_add_u32 v227, v234, 4, v233
    s_mov_b32 s24, 0
    s_mul_i32 s33, s42, s49
    s_mul_i32 s24, s33, s50
    s_mul_i32 s25, s33, 131072
    s_lshl_b32 s33, s31, 8
    s_add_u32 s25, s25, s33
    s_lshl_b32 s26, s32, 10
    s_mov_b32 s47, 0
    s_mov_b32 s48, 0
    s_add_u32 m0, s26, 0
    s_mov_b32 s35, s24
    buffer_load_dwordx4 v226, s[8:11], s35 offen lds
    s_add_u32 m0, s26, 8192
    s_add_u32 s35, s24, s51
    buffer_load_dwordx4 v226, s[8:11], s35 offen lds
    s_add_u32 m0, s26, 16384
    s_add_u32 s35, s24, s52
    buffer_load_dwordx4 v226, s[8:11], s35 offen lds
    s_add_u32 m0, s26, 24576
    s_add_u32 s35, s24, s53
    buffer_load_dwordx4 v226, s[8:11], s35 offen lds
    s_add_u32 m0, s26, 32768
    s_add_u32 s35, s25, 0
    buffer_load_dwordx4 v227, s[12:15], s35 offen lds
    s_add_u32 m0, s26, 40960
    s_add_u32 s35, s25, 65536
    buffer_load_dwordx4 v227, s[12:15], s35 offen lds
    s_add_u32 s24, s24, s50
    s_add_u32 s25, s25, 131072
    s_add_u32 s26, s26, 49152
    s_add_u32 s47, s47, 1
    s_cmp_eq_u32 s47, 3
    s_cselect_b32 s35, 147456, 0
    s_cselect_b32 s47, 0, s47
    s_sub_u32 s26, s26, s35
    s_add_u32 m0, s26, 0
    s_mov_b32 s35, s24
    buffer_load_dwordx4 v226, s[8:11], s35 offen lds
    s_add_u32 m0, s26, 8192
    s_add_u32 s35, s24, s51
    buffer_load_dwordx4 v226, s[8:11], s35 offen lds
    s_add_u32 m0, s26, 16384
    s_add_u32 s35, s24, s52
    buffer_load_dwordx4 v226, s[8:11], s35 offen lds
    s_add_u32 m0, s26, 24576
    s_add_u32 s35, s24, s53
    buffer_load_dwordx4 v226, s[8:11], s35 offen lds
    s_add_u32 m0, s26, 32768
    s_add_u32 s35, s25, 0
    buffer_load_dwordx4 v227, s[12:15], s35 offen lds
    s_add_u32 m0, s26, 40960
    s_add_u32 s35, s25, 65536
    buffer_load_dwordx4 v227, s[12:15], s35 offen lds
    s_add_u32 s24, s24, s50
    s_add_u32 s25, s25, 131072
    s_add_u32 s26, s26, 49152
    s_add_u32 s47, s47, 1
    s_cmp_eq_u32 s47, 3
    s_cselect_b32 s35, 147456, 0
    s_cselect_b32 s47, 0, s47
    s_sub_u32 s26, s26, s35
    v_and_b32 v233, 15, v224
    v_bfe_u32 v234, v225, 1, 1
    v_mul_u32_u24 v234, 128, v234
    v_add_u32 v233, v233, v234
    v_lshrrev_b32 v234, 4, v224
    v_lshrrev_b32 v235, 2, v225
    v_lshl_add_u32 v234, v235, 2, v234
    v_lshlrev_b32 v233, 4, v233
    v_lshl_add_u32 v228, v234, 12, v233
    v_bfe_u32 v233, v224, 2, 2
    v_lshrrev_b32 v234, 4, v224
    v_lshl_add_u32 v234, v234, 3, v233
    v_lshrrev_b32 v235, 2, v225
    v_lshl_add_u32 v234, v235, 5, v234
    v_lshlrev_b32 v234, 8, v234
    v_bfe_u32 v235, v224, 1, 1
    v_lshl_add_u32 v234, v235, 4, v234
    v_and_b32 v235, 1, v224
    v_lshl_add_u32 v234, v235, 3, v234
    v_add_u32 v234, 0x8000, v234
    v_lshlrev_b32 v233, 1, v233
    v_bfe_u32 v235, v224, 4, 1
    v_lshl_add_u32 v233, v235, 3, v233
    v_and_b32 v235, 1, v225
    v_mul_u32_u24 v235, 8, v235
    v_xor_b32 v233, v233, v235
    v_xor_b32 v235, 0, v233
    v_lshl_add_u32 v229, v235, 4, v234
    v_xor_b32 v235, 2, v233
    v_lshl_add_u32 v230, v235, 4, v234
    v_xor_b32 v235, 4, v233
    v_lshl_add_u32 v231, v235, 4, v234
    v_xor_b32 v235, 6, v233
    v_lshl_add_u32 v232, v235, 4, v234
    s_waitcnt vmcnt(6)
    s_barrier
    ds_read_b64_tr_b16 v[128:129], v229 offset:0
    ds_read_b64_tr_b16 v[130:131], v229 offset:1024
    ds_read_b64_tr_b16 v[132:133], v230 offset:0
    ds_read_b64_tr_b16 v[134:135], v230 offset:1024
    ds_read_b64_tr_b16 v[136:137], v231 offset:0
    ds_read_b64_tr_b16 v[138:139], v231 offset:1024
    ds_read_b64_tr_b16 v[140:141], v232 offset:0
    ds_read_b64_tr_b16 v[142:143], v232 offset:1024
    ds_read_b128 v[144:147], v228 offset:0
    ds_read_b128 v[148:151], v228 offset:256
    ds_read_b128 v[152:155], v228 offset:512
    ds_read_b128 v[156:159], v228 offset:768
    ds_read_b128 v[160:163], v228 offset:1024
    ds_read_b128 v[164:167], v228 offset:1280
    ds_read_b128 v[168:171], v228 offset:1536
    ds_read_b128 v[172:175], v228 offset:1792
    s_add_u32 s48, s48, 1
    s_cmp_eq_u32 s48, 3
    s_cselect_b32 s37, -98304, 0
    s_cselect_b32 s48, 0, s48
    s_cselect_b32 s38, 0, 49152
    s_add_u32 s37, s37, s38
    v_add_u32 v228, s37, v228
    v_add_u32 v229, s37, v229
    v_add_u32 v230, s37, v230
    v_add_u32 v231, s37, v231
    v_add_u32 v232, s37, v232
    s_add_u32 m0, s26, 0
    s_mov_b32 s35, s24
    buffer_load_dwordx4 v226, s[8:11], s35 offen lds
    s_add_u32 m0, s26, 8192
    s_add_u32 s35, s24, s51
    buffer_load_dwordx4 v226, s[8:11], s35 offen lds
    s_add_u32 m0, s26, 16384
    s_add_u32 s35, s24, s52
    buffer_load_dwordx4 v226, s[8:11], s35 offen lds
    s_add_u32 m0, s26, 24576
    s_add_u32 s35, s24, s53
    buffer_load_dwordx4 v226, s[8:11], s35 offen lds
    s_add_u32 m0, s26, 32768
    s_add_u32 s35, s25, 0
    buffer_load_dwordx4 v227, s[12:15], s35 offen lds
    s_add_u32 m0, s26, 40960
    s_add_u32 s35, s25, 65536
    buffer_load_dwordx4 v227, s[12:15], s35 offen lds
    s_add_u32 s24, s24, s50
    s_add_u32 s25, s25, 131072
    s_add_u32 s26, s26, 49152
    s_add_u32 s47, s47, 1
    s_cmp_eq_u32 s47, 3
    s_cselect_b32 s35, 147456, 0
    s_cselect_b32 s47, 0, s47
    s_sub_u32 s26, s26, s35
    s_waitcnt lgkmcnt(0)
    s_waitcnt vmcnt(6)
    s_barrier
    v_mfma_f32_16x16x32_bf16 v[0:3], v[128:131], v[144:147], 0
    v_mfma_f32_16x16x32_bf16 v[4:7], v[132:135], v[144:147], 0
    ds_read_b64_tr_b16 v[176:177], v229 offset:0
    s_add_u32 m0, s26, 0
    s_mov_b32 s35, s24
    buffer_load_dwordx4 v226, s[8:11], s35 offen lds
    v_mfma_f32_16x16x32_bf16 v[8:11], v[136:139], v[144:147], 0
    ds_read_b64_tr_b16 v[178:179], v229 offset:1024
    v_mfma_f32_16x16x32_bf16 v[12:15], v[140:143], v[144:147], 0
    ds_read_b64_tr_b16 v[180:181], v230 offset:0
    v_mfma_f32_16x16x32_bf16 v[16:19], v[128:131], v[148:151], 0
    ds_read_b64_tr_b16 v[182:183], v230 offset:1024
    v_mfma_f32_16x16x32_bf16 v[20:23], v[132:135], v[148:151], 0
    ds_read_b64_tr_b16 v[184:185], v231 offset:0
    s_add_u32 m0, s26, 8192
    s_add_u32 s35, s24, s51
    buffer_load_dwordx4 v226, s[8:11], s35 offen lds
    v_mfma_f32_16x16x32_bf16 v[24:27], v[136:139], v[148:151], 0
    ds_read_b64_tr_b16 v[186:187], v231 offset:1024
    v_mfma_f32_16x16x32_bf16 v[28:31], v[140:143], v[148:151], 0
    ds_read_b64_tr_b16 v[188:189], v232 offset:0
    v_mfma_f32_16x16x32_bf16 v[32:35], v[128:131], v[152:155], 0
    ds_read_b64_tr_b16 v[190:191], v232 offset:1024
    v_mfma_f32_16x16x32_bf16 v[36:39], v[132:135], v[152:155], 0
    ds_read_b128 v[192:195], v228 offset:0
    s_add_u32 m0, s26, 16384
    s_add_u32 s35, s24, s52
    buffer_load_dwordx4 v226, s[8:11], s35 offen lds
    v_mfma_f32_16x16x32_bf16 v[40:43], v[136:139], v[152:155], 0
    ds_read_b128 v[196:199], v228 offset:256
    v_mfma_f32_16x16x32_bf16 v[44:47], v[140:143], v[152:155], 0
    ds_read_b128 v[200:203], v228 offset:512
    v_mfma_f32_16x16x32_bf16 v[48:51], v[128:131], v[156:159], 0
    ds_read_b128 v[204:207], v228 offset:768
    v_mfma_f32_16x16x32_bf16 v[52:55], v[132:135], v[156:159], 0
    ds_read_b128 v[208:211], v228 offset:1024
    s_add_u32 m0, s26, 24576
    s_add_u32 s35, s24, s53
    buffer_load_dwordx4 v226, s[8:11], s35 offen lds
    v_mfma_f32_16x16x32_bf16 v[56:59], v[136:139], v[156:159], 0
    ds_read_b128 v[212:215], v228 offset:1280
    v_mfma_f32_16x16x32_bf16 v[60:63], v[140:143], v[156:159], 0
    ds_read_b128 v[216:219], v228 offset:1536
    v_mfma_f32_16x16x32_bf16 v[64:67], v[128:131], v[160:163], 0
    ds_read_b128 v[220:223], v228 offset:1792
    v_mfma_f32_16x16x32_bf16 v[68:71], v[132:135], v[160:163], 0
    s_add_u32 s48, s48, 1
    s_cmp_eq_u32 s48, 3
    s_cselect_b32 s37, -98304, 0
    s_cselect_b32 s48, 0, s48
    s_cselect_b32 s38, 0, 49152
    s_add_u32 s37, s37, s38
    v_add_u32 v228, s37, v228
    v_add_u32 v229, s37, v229
    v_add_u32 v230, s37, v230
    v_add_u32 v231, s37, v231
    v_add_u32 v232, s37, v232
    v_mfma_f32_16x16x32_bf16 v[72:75], v[136:139], v[160:163], 0
    s_add_u32 m0, s26, 32768
    s_add_u32 s35, s25, 0
    buffer_load_dwordx4 v227, s[12:15], s35 offen lds
    v_mfma_f32_16x16x32_bf16 v[76:79], v[140:143], v[160:163], 0
    v_mfma_f32_16x16x32_bf16 v[80:83], v[128:131], v[164:167], 0
    v_mfma_f32_16x16x32_bf16 v[84:87], v[132:135], v[164:167], 0
    v_mfma_f32_16x16x32_bf16 v[88:91], v[136:139], v[164:167], 0
    s_add_u32 m0, s26, 40960
    s_add_u32 s35, s25, 65536
    buffer_load_dwordx4 v227, s[12:15], s35 offen lds
    v_mfma_f32_16x16x32_bf16 v[92:95], v[140:143], v[164:167], 0
    v_mfma_f32_16x16x32_bf16 v[96:99], v[128:131], v[168:171], 0
    v_mfma_f32_16x16x32_bf16 v[100:103], v[132:135], v[168:171], 0
    v_mfma_f32_16x16x32_bf16 v[104:107], v[136:139], v[168:171], 0
    s_add_u32 s24, s24, s50
    s_add_u32 s25, s25, 131072
    s_add_u32 s26, s26, 49152
    s_add_u32 s47, s47, 1
    s_cmp_eq_u32 s47, 3
    s_cselect_b32 s35, 147456, 0
    s_cselect_b32 s47, 0, s47
    s_sub_u32 s26, s26, s35
    v_mfma_f32_16x16x32_bf16 v[108:111], v[140:143], v[168:171], 0
    v_mfma_f32_16x16x32_bf16 v[112:115], v[128:131], v[172:175], 0
    v_mfma_f32_16x16x32_bf16 v[116:119], v[132:135], v[172:175], 0
    v_mfma_f32_16x16x32_bf16 v[120:123], v[136:139], v[172:175], 0
    v_mfma_f32_16x16x32_bf16 v[124:127], v[140:143], v[172:175], 0
    s_waitcnt lgkmcnt(0)
    s_waitcnt vmcnt(6)
    s_barrier
    v_mfma_f32_16x16x32_bf16 v[0:3], v[176:179], v[192:195], v[0:3]
    v_mfma_f32_16x16x32_bf16 v[4:7], v[180:183], v[192:195], v[4:7]
    ds_read_b64_tr_b16 v[128:129], v229 offset:0
    s_add_u32 m0, s26, 0
    s_mov_b32 s35, s24
    buffer_load_dwordx4 v226, s[8:11], s35 offen lds
    v_mfma_f32_16x16x32_bf16 v[8:11], v[184:187], v[192:195], v[8:11]
    ds_read_b64_tr_b16 v[130:131], v229 offset:1024
    v_mfma_f32_16x16x32_bf16 v[12:15], v[188:191], v[192:195], v[12:15]
    ds_read_b64_tr_b16 v[132:133], v230 offset:0
    v_mfma_f32_16x16x32_bf16 v[16:19], v[176:179], v[196:199], v[16:19]
    ds_read_b64_tr_b16 v[134:135], v230 offset:1024
    v_mfma_f32_16x16x32_bf16 v[20:23], v[180:183], v[196:199], v[20:23]
    ds_read_b64_tr_b16 v[136:137], v231 offset:0
    s_add_u32 m0, s26, 8192
    s_add_u32 s35, s24, s51
    buffer_load_dwordx4 v226, s[8:11], s35 offen lds
    v_mfma_f32_16x16x32_bf16 v[24:27], v[184:187], v[196:199], v[24:27]
    ds_read_b64_tr_b16 v[138:139], v231 offset:1024
    v_mfma_f32_16x16x32_bf16 v[28:31], v[188:191], v[196:199], v[28:31]
    ds_read_b64_tr_b16 v[140:141], v232 offset:0
    v_mfma_f32_16x16x32_bf16 v[32:35], v[176:179], v[200:203], v[32:35]
    ds_read_b64_tr_b16 v[142:143], v232 offset:1024
    v_mfma_f32_16x16x32_bf16 v[36:39], v[180:183], v[200:203], v[36:39]
    ds_read_b128 v[144:147], v228 offset:0
    s_add_u32 m0, s26, 16384
    s_add_u32 s35, s24, s52
    buffer_load_dwordx4 v226, s[8:11], s35 offen lds
    v_mfma_f32_16x16x32_bf16 v[40:43], v[184:187], v[200:203], v[40:43]
    ds_read_b128 v[148:151], v228 offset:256
    v_mfma_f32_16x16x32_bf16 v[44:47], v[188:191], v[200:203], v[44:47]
    ds_read_b128 v[152:155], v228 offset:512
    v_mfma_f32_16x16x32_bf16 v[48:51], v[176:179], v[204:207], v[48:51]
    ds_read_b128 v[156:159], v228 offset:768
    v_mfma_f32_16x16x32_bf16 v[52:55], v[180:183], v[204:207], v[52:55]
    ds_read_b128 v[160:163], v228 offset:1024
    s_add_u32 m0, s26, 24576
    s_add_u32 s35, s24, s53
    buffer_load_dwordx4 v226, s[8:11], s35 offen lds
    v_mfma_f32_16x16x32_bf16 v[56:59], v[184:187], v[204:207], v[56:59]
    ds_read_b128 v[164:167], v228 offset:1280
    v_mfma_f32_16x16x32_bf16 v[60:63], v[188:191], v[204:207], v[60:63]
    ds_read_b128 v[168:171], v228 offset:1536
    v_mfma_f32_16x16x32_bf16 v[64:67], v[176:179], v[208:211], v[64:67]
    ds_read_b128 v[172:175], v228 offset:1792
    v_mfma_f32_16x16x32_bf16 v[68:71], v[180:183], v[208:211], v[68:71]
    s_add_u32 s48, s48, 1
    s_cmp_eq_u32 s48, 3
    s_cselect_b32 s37, -98304, 0
    s_cselect_b32 s48, 0, s48
    s_cselect_b32 s38, 0, 49152
    s_add_u32 s37, s37, s38
    v_add_u32 v228, s37, v228
    v_add_u32 v229, s37, v229
    v_add_u32 v230, s37, v230
    v_add_u32 v231, s37, v231
    v_add_u32 v232, s37, v232
    v_mfma_f32_16x16x32_bf16 v[72:75], v[184:187], v[208:211], v[72:75]
    s_add_u32 m0, s26, 32768
    s_add_u32 s35, s25, 0
    buffer_load_dwordx4 v227, s[12:15], s35 offen lds
    v_mfma_f32_16x16x32_bf16 v[76:79], v[188:191], v[208:211], v[76:79]
    v_mfma_f32_16x16x32_bf16 v[80:83], v[176:179], v[212:215], v[80:83]
    v_mfma_f32_16x16x32_bf16 v[84:87], v[180:183], v[212:215], v[84:87]
    v_mfma_f32_16x16x32_bf16 v[88:91], v[184:187], v[212:215], v[88:91]
    s_add_u32 m0, s26, 40960
    s_add_u32 s35, s25, 65536
    buffer_load_dwordx4 v227, s[12:15], s35 offen lds
    v_mfma_f32_16x16x32_bf16 v[92:95], v[188:191], v[212:215], v[92:95]
    v_mfma_f32_16x16x32_bf16 v[96:99], v[176:179], v[216:219], v[96:99]
    v_mfma_f32_16x16x32_bf16 v[100:103], v[180:183], v[216:219], v[100:103]
    v_mfma_f32_16x16x32_bf16 v[104:107], v[184:187], v[216:219], v[104:107]
    s_add_u32 s24, s24, s50
    s_add_u32 s25, s25, 131072
    s_add_u32 s26, s26, 49152
    s_add_u32 s47, s47, 1
    s_cmp_eq_u32 s47, 3
    s_cselect_b32 s35, 147456, 0
    s_cselect_b32 s47, 0, s47
    s_sub_u32 s26, s26, s35
    v_mfma_f32_16x16x32_bf16 v[108:111], v[188:191], v[216:219], v[108:111]
    v_mfma_f32_16x16x32_bf16 v[112:115], v[176:179], v[220:223], v[112:115]
    v_mfma_f32_16x16x32_bf16 v[116:119], v[180:183], v[220:223], v[116:119]
    v_mfma_f32_16x16x32_bf16 v[120:123], v[184:187], v[220:223], v[120:123]
    v_mfma_f32_16x16x32_bf16 v[124:127], v[188:191], v[220:223], v[124:127]
    s_waitcnt lgkmcnt(0)
    s_waitcnt vmcnt(6)
    s_barrier
    v_mfma_f32_16x16x32_bf16 v[0:3], v[128:131], v[144:147], v[0:3]
    v_mfma_f32_16x16x32_bf16 v[4:7], v[132:135], v[144:147], v[4:7]
    ds_read_b64_tr_b16 v[176:177], v229 offset:0
    s_add_u32 m0, s26, 0
    s_mov_b32 s35, s24
    buffer_load_dwordx4 v226, s[8:11], s35 offen lds
    v_mfma_f32_16x16x32_bf16 v[8:11], v[136:139], v[144:147], v[8:11]
    ds_read_b64_tr_b16 v[178:179], v229 offset:1024
    v_mfma_f32_16x16x32_bf16 v[12:15], v[140:143], v[144:147], v[12:15]
    ds_read_b64_tr_b16 v[180:181], v230 offset:0
    v_mfma_f32_16x16x32_bf16 v[16:19], v[128:131], v[148:151], v[16:19]
    ds_read_b64_tr_b16 v[182:183], v230 offset:1024
    v_mfma_f32_16x16x32_bf16 v[20:23], v[132:135], v[148:151], v[20:23]
    ds_read_b64_tr_b16 v[184:185], v231 offset:0
    s_add_u32 m0, s26, 8192
    s_add_u32 s35, s24, s51
    buffer_load_dwordx4 v226, s[8:11], s35 offen lds
    v_mfma_f32_16x16x32_bf16 v[24:27], v[136:139], v[148:151], v[24:27]
    ds_read_b64_tr_b16 v[186:187], v231 offset:1024
    v_mfma_f32_16x16x32_bf16 v[28:31], v[140:143], v[148:151], v[28:31]
    ds_read_b64_tr_b16 v[188:189], v232 offset:0
    v_mfma_f32_16x16x32_bf16 v[32:35], v[128:131], v[152:155], v[32:35]
    ds_read_b64_tr_b16 v[190:191], v232 offset:1024
    v_mfma_f32_16x16x32_bf16 v[36:39], v[132:135], v[152:155], v[36:39]
    ds_read_b128 v[192:195], v228 offset:0
    s_add_u32 m0, s26, 16384
    s_add_u32 s35, s24, s52
    buffer_load_dwordx4 v226, s[8:11], s35 offen lds
    v_mfma_f32_16x16x32_bf16 v[40:43], v[136:139], v[152:155], v[40:43]
    ds_read_b128 v[196:199], v228 offset:256
    v_mfma_f32_16x16x32_bf16 v[44:47], v[140:143], v[152:155], v[44:47]
    ds_read_b128 v[200:203], v228 offset:512
    v_mfma_f32_16x16x32_bf16 v[48:51], v[128:131], v[156:159], v[48:51]
    ds_read_b128 v[204:207], v228 offset:768
    v_mfma_f32_16x16x32_bf16 v[52:55], v[132:135], v[156:159], v[52:55]
    ds_read_b128 v[208:211], v228 offset:1024
    s_add_u32 m0, s26, 24576
    s_add_u32 s35, s24, s53
    buffer_load_dwordx4 v226, s[8:11], s35 offen lds
    v_mfma_f32_16x16x32_bf16 v[56:59], v[136:139], v[156:159], v[56:59]
    ds_read_b128 v[212:215], v228 offset:1280
    v_mfma_f32_16x16x32_bf16 v[60:63], v[140:143], v[156:159], v[60:63]
    ds_read_b128 v[216:219], v228 offset:1536
    v_mfma_f32_16x16x32_bf16 v[64:67], v[128:131], v[160:163], v[64:67]
    ds_read_b128 v[220:223], v228 offset:1792
    v_mfma_f32_16x16x32_bf16 v[68:71], v[132:135], v[160:163], v[68:71]
    s_add_u32 s48, s48, 1
    s_cmp_eq_u32 s48, 3
    s_cselect_b32 s37, -98304, 0
    s_cselect_b32 s48, 0, s48
    s_cselect_b32 s38, 0, 49152
    s_add_u32 s37, s37, s38
    v_add_u32 v228, s37, v228
    v_add_u32 v229, s37, v229
    v_add_u32 v230, s37, v230
    v_add_u32 v231, s37, v231
    v_add_u32 v232, s37, v232
    v_mfma_f32_16x16x32_bf16 v[72:75], v[136:139], v[160:163], v[72:75]
    s_add_u32 m0, s26, 32768
    s_add_u32 s35, s25, 0
    buffer_load_dwordx4 v227, s[12:15], s35 offen lds
    v_mfma_f32_16x16x32_bf16 v[76:79], v[140:143], v[160:163], v[76:79]
    v_mfma_f32_16x16x32_bf16 v[80:83], v[128:131], v[164:167], v[80:83]
    v_mfma_f32_16x16x32_bf16 v[84:87], v[132:135], v[164:167], v[84:87]
    v_mfma_f32_16x16x32_bf16 v[88:91], v[136:139], v[164:167], v[88:91]
    s_add_u32 m0, s26, 40960
    s_add_u32 s35, s25, 65536
    buffer_load_dwordx4 v227, s[12:15], s35 offen lds
    v_mfma_f32_16x16x32_bf16 v[92:95], v[140:143], v[164:167], v[92:95]
    v_mfma_f32_16x16x32_bf16 v[96:99], v[128:131], v[168:171], v[96:99]
    v_mfma_f32_16x16x32_bf16 v[100:103], v[132:135], v[168:171], v[100:103]
    v_mfma_f32_16x16x32_bf16 v[104:107], v[136:139], v[168:171], v[104:107]
    s_add_u32 s24, s24, s50
    s_add_u32 s25, s25, 131072
    s_add_u32 s26, s26, 49152
    s_add_u32 s47, s47, 1
    s_cmp_eq_u32 s47, 3
    s_cselect_b32 s35, 147456, 0
    s_cselect_b32 s47, 0, s47
    s_sub_u32 s26, s26, s35
    v_mfma_f32_16x16x32_bf16 v[108:111], v[140:143], v[168:171], v[108:111]
    v_mfma_f32_16x16x32_bf16 v[112:115], v[128:131], v[172:175], v[112:115]
    v_mfma_f32_16x16x32_bf16 v[116:119], v[132:135], v[172:175], v[116:119]
    v_mfma_f32_16x16x32_bf16 v[120:123], v[136:139], v[172:175], v[120:123]
    v_mfma_f32_16x16x32_bf16 v[124:127], v[140:143], v[172:175], v[124:127]
    s_sub_u32 s27, s42, 6
    s_lshr_b32 s27, s27, 1
L_g2_loop:
    s_waitcnt lgkmcnt(0)
    s_waitcnt vmcnt(6)
    s_barrier
    v_mfma_f32_16x16x32_bf16 v[0:3], v[176:179], v[192:195], v[0:3]
    v_mfma_f32_16x16x32_bf16 v[4:7], v[180:183], v[192:195], v[4:7]
    ds_read_b64_tr_b16 v[128:129], v229 offset:0
    s_add_u32 m0, s26, 0
    s_mov_b32 s35, s24
    buffer_load_dwordx4 v226, s[8:11], s35 offen lds
    v_mfma_f32_16x16x32_bf16 v[8:11], v[184:187], v[192:195], v[8:11]
    ds_read_b64_tr_b16 v[130:131], v229 offset:1024
    v_mfma_f32_16x16x32_bf16 v[12:15], v[188:191], v[192:195], v[12:15]
    ds_read_b64_tr_b16 v[132:133], v230 offset:0
    v_mfma_f32_16x16x32_bf16 v[16:19], v[176:179], v[196:199], v[16:19]
    ds_read_b64_tr_b16 v[134:135], v230 offset:1024
    v_mfma_f32_16x16x32_bf16 v[20:23], v[180:183], v[196:199], v[20:23]
    ds_read_b64_tr_b16 v[136:137], v231 offset:0
    s_add_u32 m0, s26, 8192
    s_add_u32 s35, s24, s51
    buffer_load_dwordx4 v226, s[8:11], s35 offen lds
    v_mfma_f32_16x16x32_bf16 v[24:27], v[184:187], v[196:199], v[24:27]
    ds_read_b64_tr_b16 v[138:139], v231 offset:1024
    v_mfma_f32_16x16x32_bf16 v[28:31], v[188:191], v[196:199], v[28:31]
    ds_read_b64_tr_b16 v[140:141], v232 offset:0
    v_mfma_f32_16x16x32_bf16 v[32:35], v[176:179], v[200:203], v[32:35]
    ds_read_b64_tr_b16 v[142:143], v232 offset:1024
    v_mfma_f32_16x16x32_bf16 v[36:39], v[180:183], v[200:203], v[36:39]
    ds_read_b128 v[144:147], v228 offset:0
    s_add_u32 m0, s26, 16384
    s_add_u32 s35, s24, s52
    buffer_load_dwordx4 v226, s[8:11], s35 offen lds
    v_mfma_f32_16x16x32_bf16 v[40:43], v[184:187], v[200:203], v[40:43]
    ds_read_b128 v[148:151], v228 offset:256
    v_mfma_f32_16x16x32_bf16 v[44:47], v[188:191], v[200:203], v[44:47]
    ds_read_b128 v[152:155], v228 offset:512
    v_mfma_f32_16x16x32_bf16 v[48:51], v[176:179], v[204:207], v[48:51]
    ds_read_b128 v[156:159], v228 offset:768
    v_mfma_f32_16x16x32_bf16 v[52:55], v[180:183], v[204:207], v[52:55]
    ds_read_b128 v[160:163], v228 offset:1024
    s_add_u32 m0, s26, 24576
    s_add_u32 s35, s24, s53
    buffer_load_dwordx4 v226, s[8:11], s35 offen lds
    v_mfma_f32_16x16x32_bf16 v[56:59], v[184:187], v[204:207], v[56:59]
    ds_read_b128 v[164:167], v228 offset:1280
    v_mfma_f32_16x16x32_bf16 v[60:63], v[188:191], v[204:207], v[60:63]
    ds_read_b128 v[168:171], v228 offset:1536
    v_mfma_f32_16x16x32_bf16 v[64:67], v[176:179], v[208:211], v[64:67]
    ds_read_b128 v[172:175], v228 offset:1792
    v_mfma_f32_16x16x32_bf16 v[68:71], v[180:183], v[208:211], v[68:71]
    s_add_u32 s48, s48, 1
    s_cmp_eq_u32 s48, 3
    s_cselect_b32 s37, -98304, 0
    s_cselect_b32 s48, 0, s48
    s_cselect_b32 s38, 0, 49152
    s_add_u32 s37, s37, s38
    v_add_u32 v228, s37, v228
    v_add_u32 v229, s37, v229
    v_add_u32 v230, s37, v230
    v_add_u32 v231, s37, v231
    v_add_u32 v232, s37, v232
    v_mfma_f32_16x16x32_bf16 v[72:75], v[184:187], v[208:211], v[72:75]
    s_add_u32 m0, s26, 32768
    s_add_u32 s35, s25, 0
    buffer_load_dwordx4 v227, s[12:15], s35 offen lds
    v_mfma_f32_16x16x32_bf16 v[76:79], v[188:191], v[208:211], v[76:79]
    v_mfma_f32_16x16x32_bf16 v[80:83], v[176:179], v[212:215], v[80:83]
    v_mfma_f32_16x16x32_bf16 v[84:87], v[180:183], v[212:215], v[84:87]
    v_mfma_f32_16x16x32_bf16 v[88:91], v[184:187], v[212:215], v[88:91]
    s_add_u32 m0, s26, 40960
    s_add_u32 s35, s25, 65536
    buffer_load_dwordx4 v227, s[12:15], s35 offen lds
    v_mfma_f32_16x16x32_bf16 v[92:95], v[188:191], v[212:215], v[92:95]
    v_mfma_f32_16x16x32_bf16 v[96:99], v[176:179], v[216:219], v[96:99]
    v_mfma_f32_16x16x32_bf16 v[100:103], v[180:183], v[216:219], v[100:103]
    v_mfma_f32_16x16x32_bf16 v[104:107], v[184:187], v[216:219], v[104:107]
    s_add_u32 s24, s24, s50
    s_add_u32 s25, s25, 131072
    s_add_u32 s26, s26, 49152
    s_add_u32 s47, s47, 1
    s_cmp_eq_u32 s47, 3
    s_cselect_b32 s35, 147456, 0
    s_cselect_b32 s47, 0, s47
    s_sub_u32 s26, s26, s35
    v_mfma_f32_16x16x32_bf16 v[108:111], v[188:191], v[216:219], v[108:111]
    v_mfma_f32_16x16x32_bf16 v[112:115], v[176:179], v[220:223], v[112:115]
    v_mfma_f32_16x16x32_bf16 v[116:119], v[180:183], v[220:223], v[116:119]
    v_mfma_f32_16x16x32_bf16 v[120:123], v[184:187], v[220:223], v[120:123]
    v_mfma_f32_16x16x32_bf16 v[124:127], v[188:191], v[220:223], v[124:127]
    s_waitcnt lgkmcnt(0)
    s_waitcnt vmcnt(6)
    s_barrier
    v_mfma_f32_16x16x32_bf16 v[0:3], v[128:131], v[144:147], v[0:3]
    v_mfma_f32_16x16x32_bf16 v[4:7], v[132:135], v[144:147], v[4:7]
    ds_read_b64_tr_b16 v[176:177], v229 offset:0
    s_add_u32 m0, s26, 0
    s_mov_b32 s35, s24
    buffer_load_dwordx4 v226, s[8:11], s35 offen lds
    v_mfma_f32_16x16x32_bf16 v[8:11], v[136:139], v[144:147], v[8:11]
    ds_read_b64_tr_b16 v[178:179], v229 offset:1024
    v_mfma_f32_16x16x32_bf16 v[12:15], v[140:143], v[144:147], v[12:15]
    ds_read_b64_tr_b16 v[180:181], v230 offset:0
    v_mfma_f32_16x16x32_bf16 v[16:19], v[128:131], v[148:151], v[16:19]
    ds_read_b64_tr_b16 v[182:183], v230 offset:1024
    v_mfma_f32_16x16x32_bf16 v[20:23], v[132:135], v[148:151], v[20:23]
    ds_read_b64_tr_b16 v[184:185], v231 offset:0
    s_add_u32 m0, s26, 8192
    s_add_u32 s35, s24, s51
    buffer_load_dwordx4 v226, s[8:11], s35 offen lds
    v_mfma_f32_16x16x32_bf16 v[24:27], v[136:139], v[148:151], v[24:27]
    ds_read_b64_tr_b16 v[186:187], v231 offset:1024
    v_mfma_f32_16x16x32_bf16 v[28:31], v[140:143], v[148:151], v[28:31]
    ds_read_b64_tr_b16 v[188:189], v232 offset:0
    v_mfma_f32_16x16x32_bf16 v[32:35], v[128:131], v[152:155], v[32:35]
    ds_read_b64_tr_b16 v[190:191], v232 offset:1024
    v_mfma_f32_16x16x32_bf16 v[36:39], v[132:135], v[152:155], v[36:39]
    ds_read_b128 v[192:195], v228 offset:0
    s_add_u32 m0, s26, 16384
    s_add_u32 s35, s24, s52
    buffer_load_dwordx4 v226, s[8:11], s35 offen lds
    v_mfma_f32_16x16x32_bf16 v[40:43], v[136:139], v[152:155], v[40:43]
    ds_read_b128 v[196:199], v228 offset:256
    v_mfma_f32_16x16x32_bf16 v[44:47], v[140:143], v[152:155], v[44:47]
    ds_read_b128 v[200:203], v228 offset:512
    v_mfma_f32_16x16x32_bf16 v[48:51], v[128:131], v[156:159], v[48:51]
    ds_read_b128 v[204:207], v228 offset:768
    v_mfma_f32_16x16x32_bf16 v[52:55], v[132:135], v[156:159], v[52:55]
    ds_read_b128 v[208:211], v228 offset:1024
    s_add_u32 m0, s26, 24576
    s_add_u32 s35, s24, s53
    buffer_load_dwordx4 v226, s[8:11], s35 offen lds
    v_mfma_f32_16x16x32_bf16 v[56:59], v[136:139], v[156:159], v[56:59]
    ds_read_b128 v[212:215], v228 offset:1280
    v_mfma_f32_16x16x32_bf16 v[60:63], v[140:143], v[156:159], v[60:63]
    ds_read_b128 v[216:219], v228 offset:1536
    v_mfma_f32_16x16x32_bf16 v[64:67], v[128:131], v[160:163], v[64:67]
    ds_read_b128 v[220:223], v228 offset:1792
    v_mfma_f32_16x16x32_bf16 v[68:71], v[132:135], v[160:163], v[68:71]
    s_add_u32 s48, s48, 1
    s_cmp_eq_u32 s48, 3
    s_cselect_b32 s37, -98304, 0
    s_cselect_b32 s48, 0, s48
    s_cselect_b32 s38, 0, 49152
    s_add_u32 s37, s37, s38
    v_add_u32 v228, s37, v228
    v_add_u32 v229, s37, v229
    v_add_u32 v230, s37, v230
    v_add_u32 v231, s37, v231
    v_add_u32 v232, s37, v232
    v_mfma_f32_16x16x32_bf16 v[72:75], v[136:139], v[160:163], v[72:75]
    s_add_u32 m0, s26, 32768
    s_add_u32 s35, s25, 0
    buffer_load_dwordx4 v227, s[12:15], s35 offen lds
    v_mfma_f32_16x16x32_bf16 v[76:79], v[140:143], v[160:163], v[76:79]
    v_mfma_f32_16x16x32_bf16 v[80:83], v[128:131], v[164:167], v[80:83]
    v_mfma_f32_16x16x32_bf16 v[84:87], v[132:135], v[164:167], v[84:87]
    v_mfma_f32_16x16x32_bf16 v[88:91], v[136:139], v[164:167], v[88:91]
    s_add_u32 m0, s26, 40960
    s_add_u32 s35, s25, 65536
    buffer_load_dwordx4 v227, s[12:15], s35 offen lds
    v_mfma_f32_16x16x32_bf16 v[92:95], v[140:143], v[164:167], v[92:95]
    v_mfma_f32_16x16x32_bf16 v[96:99], v[128:131], v[168:171], v[96:99]
    v_mfma_f32_16x16x32_bf16 v[100:103], v[132:135], v[168:171], v[100:103]
    v_mfma_f32_16x16x32_bf16 v[104:107], v[136:139], v[168:171], v[104:107]
    s_add_u32 s24, s24, s50
    s_add_u32 s25, s25, 131072
    s_add_u32 s26, s26, 49152
    s_add_u32 s47, s47, 1
    s_cmp_eq_u32 s47, 3
    s_cselect_b32 s35, 147456, 0
    s_cselect_b32 s47, 0, s47
    s_sub_u32 s26, s26, s35
    v_mfma_f32_16x16x32_bf16 v[108:111], v[140:143], v[168:171], v[108:111]
    v_mfma_f32_16x16x32_bf16 v[112:115], v[128:131], v[172:175], v[112:115]
    v_mfma_f32_16x16x32_bf16 v[116:119], v[132:135], v[172:175], v[116:119]
    v_mfma_f32_16x16x32_bf16 v[120:123], v[136:139], v[172:175], v[120:123]
    v_mfma_f32_16x16x32_bf16 v[124:127], v[140:143], v[172:175], v[124:127]
    s_sub_u32 s27, s27, 1
    s_cmp_lg_u32 s27, 0
    s_cbranch_scc1 L_g2_loop
    s_waitcnt lgkmcnt(0)
    s_waitcnt vmcnt(6)
    s_barrier
    v_mfma_f32_16x16x32_bf16 v[0:3], v[176:179], v[192:195], v[0:3]
    v_mfma_f32_16x16x32_bf16 v[4:7], v[180:183], v[192:195], v[4:7]
    ds_read_b64_tr_b16 v[128:129], v229 offset:0
    v_mfma_f32_16x16x32_bf16 v[8:11], v[184:187], v[192:195], v[8:11]
    ds_read_b64_tr_b16 v[130:131], v229 offset:1024
    v_mfma_f32_16x16x32_bf16 v[12:15], v[188:191], v[192:195], v[12:15]
    ds_read_b64_tr_b16 v[132:133], v230 offset:0
    v_mfma_f32_16x16x32_bf16 v[16:19], v[176:179], v[196:199], v[16:19]
    ds_read_b64_tr_b16 v[134:135], v230 offset:1024
    v_mfma_f32_16x16x32_bf16 v[20:23], v[180:183], v[196:199], v[20:23]
    ds_read_b64_tr_b16 v[136:137], v231 offset:0
    v_mfma_f32_16x16x32_bf16 v[24:27], v[184:187], v[196:199], v[24:27]
    ds_read_b64_tr_b16 v[138:139], v231 offset:1024
    v_mfma_f32_16x16x32_bf16 v[28:31], v[188:191], v[196:199], v[28:31]
    ds_read_b64_tr_b16 v[140:141], v232 offset:0
    v_mfma_f32_16x16x32_bf16 v[32:35], v[176:179], v[200:203], v[32:35]
    ds_read_b64_tr_b16 v[142:143], v232 offset:1024
    v_mfma_f32_16x16x32_bf16 v[36:39], v[180:183], v[200:203], v[36:39]
    ds_read_b128 v[144:147], v228 offset:0
    v_mfma_f32_16x16x32_bf16 v[40:43], v[184:187], v[200:203], v[40:43]
    ds_read_b128 v[148:151], v228 offset:256
    v_mfma_f32_16x16x32_bf16 v[44:47], v[188:191], v[200:203], v[44:47]
    ds_read_b128 v[152:155], v228 offset:512
    v_mfma_f32_16x16x32_bf16 v[48:51], v[176:179], v[204:207], v[48:51]
    ds_read_b128 v[156:159], v228 offset:768
    v_mfma_f32_16x16x32_bf16 v[52:55], v[180:183], v[204:207], v[52:55]
    ds_read_b128 v[160:163], v228 offset:1024
    v_mfma_f32_16x16x32_bf16 v[56:59], v[184:187], v[204:207], v[56:59]
    ds_read_b128 v[164:167], v228 offset:1280
    v_mfma_f32_16x16x32_bf16 v[60:63], v[188:191], v[204:207], v[60:63]
    ds_read_b128 v[168:171], v228 offset:1536
    v_mfma_f32_16x16x32_bf16 v[64:67], v[176:179], v[208:211], v[64:67]
    ds_read_b128 v[172:175], v228 offset:1792
    v_mfma_f32_16x16x32_bf16 v[68:71], v[180:183], v[208:211], v[68:71]
    s_add_u32 s48, s48, 1
    s_cmp_eq_u32 s48, 3
    s_cselect_b32 s37, -98304, 0
    s_cselect_b32 s48, 0, s48
    s_cselect_b32 s38, 0, 49152
    s_add_u32 s37, s37, s38
    v_add_u32 v228, s37, v228
    v_add_u32 v229, s37, v229
    v_add_u32 v230, s37, v230
    v_add_u32 v231, s37, v231
    v_add_u32 v232, s37, v232
    v_mfma_f32_16x16x32_bf16 v[72:75], v[184:187], v[208:211], v[72:75]
    v_mfma_f32_16x16x32_bf16 v[76:79], v[188:191], v[208:211], v[76:79]
    v_mfma_f32_16x16x32_bf16 v[80:83], v[176:179], v[212:215], v[80:83]
    v_mfma_f32_16x16x32_bf16 v[84:87], v[180:183], v[212:215], v[84:87]
    v_mfma_f32_16x16x32_bf16 v[88:91], v[184:187], v[212:215], v[88:91]
    v_mfma_f32_16x16x32_bf16 v[92:95], v[188:191], v[212:215], v[92:95]
    v_mfma_f32_16x16x32_bf16 v[96:99], v[176:179], v[216:219], v[96:99]
    v_mfma_f32_16x16x32_bf16 v[100:103], v[180:183], v[216:219], v[100:103]
    v_mfma_f32_16x16x32_bf16 v[104:107], v[184:187], v[216:219], v[104:107]
    v_mfma_f32_16x16x32_bf16 v[108:111], v[188:191], v[216:219], v[108:111]
    v_mfma_f32_16x16x32_bf16 v[112:115], v[176:179], v[220:223], v[112:115]
    v_mfma_f32_16x16x32_bf16 v[116:119], v[180:183], v[220:223], v[116:119]
    v_mfma_f32_16x16x32_bf16 v[120:123], v[184:187], v[220:223], v[120:123]
    v_mfma_f32_16x16x32_bf16 v[124:127], v[188:191], v[220:223], v[124:127]
    s_waitcnt lgkmcnt(0)
    s_waitcnt vmcnt(0)
    s_barrier
    v_mfma_f32_16x16x32_bf16 v[0:3], v[128:131], v[144:147], v[0:3]
    v_mfma_f32_16x16x32_bf16 v[4:7], v[132:135], v[144:147], v[4:7]
    ds_read_b64_tr_b16 v[176:177], v229 offset:0
    v_mfma_f32_16x16x32_bf16 v[8:11], v[136:139], v[144:147], v[8:11]
    ds_read_b64_tr_b16 v[178:179], v229 offset:1024
    v_mfma_f32_16x16x32_bf16 v[12:15], v[140:143], v[144:147], v[12:15]
    ds_read_b64_tr_b16 v[180:181], v230 offset:0
    v_mfma_f32_16x16x32_bf16 v[16:19], v[128:131], v[148:151], v[16:19]
    ds_read_b64_tr_b16 v[182:183], v230 offset:1024
    v_mfma_f32_16x16x32_bf16 v[20:23], v[132:135], v[148:151], v[20:23]
    ds_read_b64_tr_b16 v[184:185], v231 offset:0
    v_mfma_f32_16x16x32_bf16 v[24:27], v[136:139], v[148:151], v[24:27]
    ds_read_b64_tr_b16 v[186:187], v231 offset:1024
    v_mfma_f32_16x16x32_bf16 v[28:31], v[140:143], v[148:151], v[28:31]
    ds_read_b64_tr_b16 v[188:189], v232 offset:0
    v_mfma_f32_16x16x32_bf16 v[32:35], v[128:131], v[152:155], v[32:35]
    ds_read_b64_tr_b16 v[190:191], v232 offset:1024
    v_mfma_f32_16x16x32_bf16 v[36:39], v[132:135], v[152:155], v[36:39]
    ds_read_b128 v[192:195], v228 offset:0
    v_mfma_f32_16x16x32_bf16 v[40:43], v[136:139], v[152:155], v[40:43]
    ds_read_b128 v[196:199], v228 offset:256
    v_mfma_f32_16x16x32_bf16 v[44:47], v[140:143], v[152:155], v[44:47]
    ds_read_b128 v[200:203], v228 offset:512
    v_mfma_f32_16x16x32_bf16 v[48:51], v[128:131], v[156:159], v[48:51]
    ds_read_b128 v[204:207], v228 offset:768
    v_mfma_f32_16x16x32_bf16 v[52:55], v[132:135], v[156:159], v[52:55]
    ds_read_b128 v[208:211], v228 offset:1024
    v_mfma_f32_16x16x32_bf16 v[56:59], v[136:139], v[156:159], v[56:59]
    ds_read_b128 v[212:215], v228 offset:1280
    v_mfma_f32_16x16x32_bf16 v[60:63], v[140:143], v[156:159], v[60:63]
    ds_read_b128 v[216:219], v228 offset:1536
    v_mfma_f32_16x16x32_bf16 v[64:67], v[128:131], v[160:163], v[64:67]
    ds_read_b128 v[220:223], v228 offset:1792
    v_mfma_f32_16x16x32_bf16 v[68:71], v[132:135], v[160:163], v[68:71]
    s_add_u32 s48, s48, 1
    s_cmp_eq_u32 s48, 3
    s_cselect_b32 s37, -98304, 0
    s_cselect_b32 s48, 0, s48
    s_cselect_b32 s38, 0, 49152
    s_add_u32 s37, s37, s38
    v_add_u32 v228, s37, v228
    v_add_u32 v229, s37, v229
    v_add_u32 v230, s37, v230
    v_add_u32 v231, s37, v231
    v_add_u32 v232, s37, v232
    v_mfma_f32_16x16x32_bf16 v[72:75], v[136:139], v[160:163], v[72:75]
    v_mfma_f32_16x16x32_bf16 v[76:79], v[140:143], v[160:163], v[76:79]
    v_mfma_f32_16x16x32_bf16 v[80:83], v[128:131], v[164:167], v[80:83]
    v_mfma_f32_16x16x32_bf16 v[84:87], v[132:135], v[164:167], v[84:87]
    v_mfma_f32_16x16x32_bf16 v[88:91], v[136:139], v[164:167], v[88:91]
    v_mfma_f32_16x16x32_bf16 v[92:95], v[140:143], v[164:167], v[92:95]
    v_mfma_f32_16x16x32_bf16 v[96:99], v[128:131], v[168:171], v[96:99]
    v_mfma_f32_16x16x32_bf16 v[100:103], v[132:135], v[168:171], v[100:103]
    v_mfma_f32_16x16x32_bf16 v[104:107], v[136:139], v[168:171], v[104:107]
    v_mfma_f32_16x16x32_bf16 v[108:111], v[140:143], v[168:171], v[108:111]
    v_mfma_f32_16x16x32_bf16 v[112:115], v[128:131], v[172:175], v[112:115]
    v_mfma_f32_16x16x32_bf16 v[116:119], v[132:135], v[172:175], v[116:119]
    v_mfma_f32_16x16x32_bf16 v[120:123], v[136:139], v[172:175], v[120:123]
    v_mfma_f32_16x16x32_bf16 v[124:127], v[140:143], v[172:175], v[124:127]
    s_waitcnt lgkmcnt(0)
    v_mfma_f32_16x16x32_bf16 v[0:3], v[176:179], v[192:195], v[0:3]
    v_mfma_f32_16x16x32_bf16 v[4:7], v[180:183], v[192:195], v[4:7]
    v_mfma_f32_16x16x32_bf16 v[8:11], v[184:187], v[192:195], v[8:11]
    v_mfma_f32_16x16x32_bf16 v[12:15], v[188:191], v[192:195], v[12:15]
    v_mfma_f32_16x16x32_bf16 v[16:19], v[176:179], v[196:199], v[16:19]
    v_mfma_f32_16x16x32_bf16 v[20:23], v[180:183], v[196:199], v[20:23]
    v_mfma_f32_16x16x32_bf16 v[24:27], v[184:187], v[196:199], v[24:27]
    v_mfma_f32_16x16x32_bf16 v[28:31], v[188:191], v[196:199], v[28:31]
    v_mfma_f32_16x16x32_bf16 v[32:35], v[176:179], v[200:203], v[32:35]
    v_mfma_f32_16x16x32_bf16 v[36:39], v[180:183], v[200:203], v[36:39]
    v_mfma_f32_16x16x32_bf16 v[40:43], v[184:187], v[200:203], v[40:43]
    v_mfma_f32_16x16x32_bf16 v[44:47], v[188:191], v[200:203], v[44:47]
    v_mfma_f32_16x16x32_bf16 v[48:51], v[176:179], v[204:207], v[48:51]
    v_mfma_f32_16x16x32_bf16 v[52:55], v[180:183], v[204:207], v[52:55]
    v_mfma_f32_16x16x32_bf16 v[56:59], v[184:187], v[204:207], v[56:59]
    v_mfma_f32_16x16x32_bf16 v[60:63], v[188:191], v[204:207], v[60:63]
    v_mfma_f32_16x16x32_bf16 v[64:67], v[176:179], v[208:211], v[64:67]
    v_mfma_f32_16x16x32_bf16 v[68:71], v[180:183], v[208:211], v[68:71]
    v_mfma_f32_16x16x32_bf16 v[72:75], v[184:187], v[208:211], v[72:75]
    v_mfma_f32_16x16x32_bf16 v[76:79], v[188:191], v[208:211], v[76:79]
    v_mfma_f32_16x16x32_bf16 v[80:83], v[176:179], v[212:215], v[80:83]
    v_mfma_f32_16x16x32_bf16 v[84:87], v[180:183], v[212:215], v[84:87]
    v_mfma_f32_16x16x32_bf16 v[88:91], v[184:187], v[212:215], v[88:91]
    v_mfma_f32_16x16x32_bf16 v[92:95], v[188:191], v[212:215], v[92:95]
    v_mfma_f32_16x16x32_bf16 v[96:99], v[176:179], v[216:219], v[96:99]
    v_mfma_f32_16x16x32_bf16 v[100:103], v[180:183], v[216:219], v[100:103]
    v_mfma_f32_16x16x32_bf16 v[104:107], v[184:187], v[216:219], v[104:107]
    v_mfma_f32_16x16x32_bf16 v[108:111], v[188:191], v[216:219], v[108:111]
    v_mfma_f32_16x16x32_bf16 v[112:115], v[176:179], v[220:223], v[112:115]
    v_mfma_f32_16x16x32_bf16 v[116:119], v[180:183], v[220:223], v[116:119]
    v_mfma_f32_16x16x32_bf16 v[120:123], v[184:187], v[220:223], v[120:123]
    v_mfma_f32_16x16x32_bf16 v[124:127], v[188:191], v[220:223], v[124:127]
    s_nop 7
    s_barrier
    v_lshlrev_b32 v233, 4, v224
    v_mul_u32_u24 v234, 16384, v225
    v_add_u32 v234, v234, v233
    v_xor_b32 v235, 4, v225
    v_mul_u32_u24 v235, 16384, v235
    v_add_u32 v235, v235, v233
    s_cmp_ge_u32 s32, 4
    s_cbranch_scc1 L_g2_hi
    ds_write_b128 v234, v[8:11] offset:0
    ds_write_b128 v234, v[12:15] offset:1024
    ds_write_b128 v234, v[24:27] offset:2048
    ds_write_b128 v234, v[28:31] offset:3072
    ds_write_b128 v234, v[40:43] offset:4096
    ds_write_b128 v234, v[44:47] offset:5120
    ds_write_b128 v234, v[56:59] offset:6144
    ds_write_b128 v234, v[60:63] offset:7168
    ds_write_b128 v234, v[72:75] offset:8192
    ds_write_b128 v234, v[76:79] offset:9216
    ds_write_b128 v234, v[88:91] offset:10240
    ds_write_b128 v234, v[92:95] offset:11264
    ds_write_b128 v234, v[104:107] offset:12288
    ds_write_b128 v234, v[108:111] offset:13312
    ds_write_b128 v234, v[120:123] offset:14336
    ds_write_b128 v234, v[124:127] offset:15360
    s_waitcnt lgkmcnt(0)
    s_barrier
    ds_read_b128 v[128:131], v235 offset:0
    ds_read_b128 v[132:135], v235 offset:1024
    ds_read_b128 v[136:139], v235 offset:2048
    ds_read_b128 v[140:143], v235 offset:3072
    ds_read_b128 v[144:147], v235 offset:4096
    ds_read_b128 v[148:151], v235 offset:5120
    ds_read_b128 v[152:155], v235 offset:6144
    ds_read_b128 v[156:159], v235 offset:7168
    ds_read_b128 v[160:163], v235 offset:8192
    ds_read_b128 v[164:167], v235 offset:9216
    ds_read_b128 v[168:171], v235 offset:10240
    ds_read_b128 v[172:175], v235 offset:11264
    ds_read_b128 v[176:179], v235 offset:12288
    ds_read_b128 v[180:183], v235 offset:13312
    ds_read_b128 v[184:187], v235 offset:14336
    ds_read_b128 v[188:191], v235 offset:15360
    s_waitcnt lgkmcnt(15)
    v_add_f32 v0, v0, v128
    v_add_f32 v1, v1, v129
    v_add_f32 v2, v2, v130
    v_add_f32 v3, v3, v131
    s_waitcnt lgkmcnt(14)
    v_add_f32 v4, v4, v132
    v_add_f32 v5, v5, v133
    v_add_f32 v6, v6, v134
    v_add_f32 v7, v7, v135
    s_waitcnt lgkmcnt(13)
    v_add_f32 v16, v16, v136
    v_add_f32 v17, v17, v137
    v_add_f32 v18, v18, v138
    v_add_f32 v19, v19, v139
    s_waitcnt lgkmcnt(12)
    v_add_f32 v20, v20, v140
    v_add_f32 v21, v21, v141
    v_add_f32 v22, v22, v142
    v_add_f32 v23, v23, v143
    s_waitcnt lgkmcnt(11)
    v_add_f32 v32, v32, v144
    v_add_f32 v33, v33, v145
    v_add_f32 v34, v34, v146
    v_add_f32 v35, v35, v147
    s_waitcnt lgkmcnt(10)
    v_add_f32 v36, v36, v148
    v_add_f32 v37, v37, v149
    v_add_f32 v38, v38, v150
    v_add_f32 v39, v39, v151
    s_waitcnt lgkmcnt(9)
    v_add_f32 v48, v48, v152
    v_add_f32 v49, v49, v153
    v_add_f32 v50, v50, v154
    v_add_f32 v51, v51, v155
    s_waitcnt lgkmcnt(8)
    v_add_f32 v52, v52, v156
    v_add_f32 v53, v53, v157
    v_add_f32 v54, v54, v158
    v_add_f32 v55, v55, v159
    s_waitcnt lgkmcnt(7)
    v_add_f32 v64, v64, v160
    v_add_f32 v65, v65, v161
    v_add_f32 v66, v66, v162
    v_add_f32 v67, v67, v163
    s_waitcnt lgkmcnt(6)
    v_add_f32 v68, v68, v164
    v_add_f32 v69, v69, v165
    v_add_f32 v70, v70, v166
    v_add_f32 v71, v71, v167
    s_waitcnt lgkmcnt(5)
    v_add_f32 v80, v80, v168
    v_add_f32 v81, v81, v169
    v_add_f32 v82, v82, v170
    v_add_f32 v83, v83, v171
    s_waitcnt lgkmcnt(4)
    v_add_f32 v84, v84, v172
    v_add_f32 v85, v85, v173
    v_add_f32 v86, v86, v174
    v_add_f32 v87, v87, v175
    s_waitcnt lgkmcnt(3)
    v_add_f32 v96, v96, v176
    v_add_f32 v97, v97, v177
    v_add_f32 v98, v98, v178
    v_add_f32 v99, v99, v179
    s_waitcnt lgkmcnt(2)
    v_add_f32 v100, v100, v180
    v_add_f32 v101, v101, v181
    v_add_f32 v102, v102, v182
    v_add_f32 v103, v103, v183
    s_waitcnt lgkmcnt(1)
    v_add_f32 v112, v112, v184
    v_add_f32 v113, v113, v185
    v_add_f32 v114, v114, v186
    v_add_f32 v115, v115, v187
    s_waitcnt lgkmcnt(0)
    v_add_f32 v116, v116, v188
    v_add_f32 v117, v117, v189
    v_add_f32 v118, v118, v190
    v_add_f32 v119, v119, v191
    s_branch L_g2_join
L_g2_hi:
    ds_write_b128 v234, v[0:3] offset:0
    ds_write_b128 v234, v[4:7] offset:1024
    ds_write_b128 v234, v[16:19] offset:2048
    ds_write_b128 v234, v[20:23] offset:3072
    ds_write_b128 v234, v[32:35] offset:4096
    ds_write_b128 v234, v[36:39] offset:5120
    ds_write_b128 v234, v[48:51] offset:6144
    ds_write_b128 v234, v[52:55] offset:7168
    ds_write_b128 v234, v[64:67] offset:8192
    ds_write_b128 v234, v[68:71] offset:9216
    ds_write_b128 v234, v[80:83] offset:10240
    ds_write_b128 v234, v[84:87] offset:11264
    ds_write_b128 v234, v[96:99] offset:12288
    ds_write_b128 v234, v[100:103] offset:13312
    ds_write_b128 v234, v[112:115] offset:14336
    ds_write_b128 v234, v[116:119] offset:15360
    s_waitcnt lgkmcnt(0)
    s_barrier
    ds_read_b128 v[128:131], v235 offset:0
    ds_read_b128 v[132:135], v235 offset:1024
    ds_read_b128 v[136:139], v235 offset:2048
    ds_read_b128 v[140:143], v235 offset:3072
    ds_read_b128 v[144:147], v235 offset:4096
    ds_read_b128 v[148:151], v235 offset:5120
    ds_read_b128 v[152:155], v235 offset:6144
    ds_read_b128 v[156:159], v235 offset:7168
    ds_read_b128 v[160:163], v235 offset:8192
    ds_read_b128 v[164:167], v235 offset:9216
    ds_read_b128 v[168:171], v235 offset:10240
    ds_read_b128 v[172:175], v235 offset:11264
    ds_read_b128 v[176:179], v235 offset:12288
    ds_read_b128 v[180:183], v235 offset:13312
    ds_read_b128 v[184:187], v235 offset:14336
    ds_read_b128 v[188:191], v235 offset:15360
    s_waitcnt lgkmcnt(15)
    v_add_f32 v0, v8, v128
    v_add_f32 v1, v9, v129
    v_add_f32 v2, v10, v130
    v_add_f32 v3, v11, v131
    s_waitcnt lgkmcnt(14)
    v_add_f32 v4, v12, v132
    v_add_f32 v5, v13, v133
    v_add_f32 v6, v14, v134
    v_add_f32 v7, v15, v135
    s_waitcnt lgkmcnt(13)
    v_add_f32 v16, v24, v136
    v_add_f32 v17, v25, v137
    v_add_f32 v18, v26, v138
    v_add_f32 v19, v27, v139
    s_waitcnt lgkmcnt(12)
    v_add_f32 v20, v28, v140
    v_add_f32 v21, v29, v141
    v_add_f32 v22, v30, v142
    v_add_f32 v23, v31, v143
    s_waitcnt lgkmcnt(11)
    v_add_f32 v32, v40, v144
    v_add_f32 v33, v41, v145
    v_add_f32 v34, v42, v146
    v_add_f32 v35, v43, v147
    s_waitcnt lgkmcnt(10)
    v_add_f32 v36, v44, v148
    v_add_f32 v37, v45, v149
    v_add_f32 v38, v46, v150
    v_add_f32 v39, v47, v151
    s_waitcnt lgkmcnt(9)
    v_add_f32 v48, v56, v152
    v_add_f32 v49, v57, v153
    v_add_f32 v50, v58, v154
    v_add_f32 v51, v59, v155
    s_waitcnt lgkmcnt(8)
    v_add_f32 v52, v60, v156
    v_add_f32 v53, v61, v157
    v_add_f32 v54, v62, v158
    v_add_f32 v55, v63, v159
    s_waitcnt lgkmcnt(7)
    v_add_f32 v64, v72, v160
    v_add_f32 v65, v73, v161
    v_add_f32 v66, v74, v162
    v_add_f32 v67, v75, v163
    s_waitcnt lgkmcnt(6)
    v_add_f32 v68, v76, v164
    v_add_f32 v69, v77, v165
    v_add_f32 v70, v78, v166
    v_add_f32 v71, v79, v167
    s_waitcnt lgkmcnt(5)
    v_add_f32 v80, v88, v168
    v_add_f32 v81, v89, v169
    v_add_f32 v82, v90, v170
    v_add_f32 v83, v91, v171
    s_waitcnt lgkmcnt(4)
    v_add_f32 v84, v92, v172
    v_add_f32 v85, v93, v173
    v_add_f32 v86, v94, v174
    v_add_f32 v87, v95, v175
    s_waitcnt lgkmcnt(3)
    v_add_f32 v96, v104, v176
    v_add_f32 v97, v105, v177
    v_add_f32 v98, v106, v178
    v_add_f32 v99, v107, v179
    s_waitcnt lgkmcnt(2)
    v_add_f32 v100, v108, v180
    v_add_f32 v101, v109, v181
    v_add_f32 v102, v110, v182
    v_add_f32 v103, v111, v183
    s_waitcnt lgkmcnt(1)
    v_add_f32 v112, v120, v184
    v_add_f32 v113, v121, v185
    v_add_f32 v114, v122, v186
    v_add_f32 v115, v123, v187
    s_waitcnt lgkmcnt(0)
    v_add_f32 v116, v124, v188
    v_add_f32 v117, v125, v189
    v_add_f32 v118, v126, v190
    v_add_f32 v119, v127, v191
L_g2_join:
    v_bfe_u32 v234, v225, 1, 1
    v_mul_u32_u24 v233, 8, v234
    s_mul_i32 s33, s30, 16
    v_add_u32 v233, s33, v233
    v_mul_u32_u24 v233, 32, v233
    v_and_b32 v234, 1, v225
    v_lshlrev_b32 v234, 1, v234
    v_lshrrev_b32 v235, 2, v225
    v_add_u32 v234, v234, v235
    v_add_u32 v233, v233, v234
    s_lshl_b32 s33, s31, 2
    v_add_u32 v233, s33, v233
    v_lshlrev_b32 v233, 10, v233
    v_lshl_add_u32 v228, v224, 4, v233
    s_mov_b32 s37, 0
    v_cvt_pk_bf16_f32 v128, v0, v1
    v_cvt_pk_bf16_f32 v129, v2, v3
    v_cvt_pk_bf16_f32 v130, v4, v5
    v_cvt_pk_bf16_f32 v131, v6, v7
    s_nop 1
    v_permlane16_swap_b32 v128, v130
    v_permlane16_swap_b32 v129, v131
    buffer_store_dwordx4 v[128:131], v228, s[20:23], s37 offen
    s_mov_b32 s37, 32768
    v_cvt_pk_bf16_f32 v132, v16, v17
    v_cvt_pk_bf16_f32 v133, v18, v19
    v_cvt_pk_bf16_f32 v134, v20, v21
    v_cvt_pk_bf16_f32 v135, v22, v23
    s_nop 1
    v_permlane16_swap_b32 v132, v134
    v_permlane16_swap_b32 v133, v135
    buffer_store_dwordx4 v[132:135], v228, s[20:23], s37 offen
    s_mov_b32 s37, 65536
    v_cvt_pk_bf16_f32 v136, v32, v33
    v_cvt_pk_bf16_f32 v137, v34, v35
    v_cvt_pk_bf16_f32 v138, v36, v37
    v_cvt_pk_bf16_f32 v139, v38, v39
    s_nop 1
    v_permlane16_swap_b32 v136, v138
    v_permlane16_swap_b32 v137, v139
    buffer_store_dwordx4 v[136:139], v228, s[20:23], s37 offen
    s_mov_b32 s37, 98304
    v_cvt_pk_bf16_f32 v140, v48, v49
    v_cvt_pk_bf16_f32 v141, v50, v51
    v_cvt_pk_bf16_f32 v142, v52, v53
    v_cvt_pk_bf16_f32 v143, v54, v55
    s_nop 1
    v_permlane16_swap_b32 v140, v142
    v_permlane16_swap_b32 v141, v143
    buffer_store_dwordx4 v[140:143], v228, s[20:23], s37 offen
    s_mov_b32 s37, 131072
    v_cvt_pk_bf16_f32 v144, v64, v65
    v_cvt_pk_bf16_f32 v145, v66, v67
    v_cvt_pk_bf16_f32 v146, v68, v69
    v_cvt_pk_bf16_f32 v147, v70, v71
    s_nop 1
    v_permlane16_swap_b32 v144, v146
    v_permlane16_swap_b32 v145, v147
    buffer_store_dwordx4 v[144:147], v228, s[20:23], s37 offen
    s_mov_b32 s37, 163840
    v_cvt_pk_bf16_f32 v148, v80, v81
    v_cvt_pk_bf16_f32 v149, v82, v83
    v_cvt_pk_bf16_f32 v150, v84, v85
    v_cvt_pk_bf16_f32 v151, v86, v87
    s_nop 1
    v_permlane16_swap_b32 v148, v150
    v_permlane16_swap_b32 v149, v151
    buffer_store_dwordx4 v[148:151], v228, s[20:23], s37 offen
    s_mov_b32 s37, 196608
    v_cvt_pk_bf16_f32 v152, v96, v97
    v_cvt_pk_bf16_f32 v153, v98, v99
    v_cvt_pk_bf16_f32 v154, v100, v101
    v_cvt_pk_bf16_f32 v155, v102, v103
    s_nop 1
    v_permlane16_swap_b32 v152, v154
    v_permlane16_swap_b32 v153, v155
    buffer_store_dwordx4 v[152:155], v228, s[20:23], s37 offen
    s_mov_b32 s37, 229376
    v_cvt_pk_bf16_f32 v156, v112, v113
    v_cvt_pk_bf16_f32 v157, v114, v115
    v_cvt_pk_bf16_f32 v158, v116, v117
    v_cvt_pk_bf16_f32 v159, v118, v119
    s_nop 1
    v_permlane16_swap_b32 v156, v158
    v_permlane16_swap_b32 v157, v159
    buffer_store_dwordx4 v[156:159], v228, s[20:23], s37 offen
    s_endpgm
L_g2_done:
    s_endpgm
.section .rodata,"a"
.p2align 6
.amdhsa_kernel g2_kernel
  .amdhsa_next_free_vgpr 243
  .amdhsa_next_free_sgpr 100
  .amdhsa_accum_offset 244
  .amdhsa_group_segment_fixed_size 0
  .amdhsa_kernarg_size 96
  .amdhsa_user_sgpr_count 2
  .amdhsa_user_sgpr_kernarg_segment_ptr 1
  .amdhsa_system_sgpr_workgroup_id_x 1
  .amdhsa_float_denorm_mode_32 3
.end_amdhsa_kernel
.text
.globl comb_kernel
.p2align 8
.type comb_kernel,@function
comb_kernel:
    s_cmp_ge_u32 s2, 1024
    s_cbranch_scc1 L_cb_done
    s_load_dwordx2 s[4:5], s[0:1], 0
    s_load_dwordx2 s[6:7], s[0:1], 88
    s_load_dwordx2 s[24:25], s[0:1], 72
    s_lshl_b32 s3, s2, 12
    v_lshl_add_u32 v1, v0, 4, s3
    v_lshrrev_b32 v2, 15, v1
    v_bfe_u32 v3, v1, 4, 4
    v_lshl_add_u32 v2, v2, 4, v3
    v_lshlrev_b32 v2, 11, v2
    v_bfe_u32 v3, v1, 10, 5
    v_lshl_add_u32 v2, v3, 6, v2
    v_bfe_u32 v3, v1, 8, 1
    v_lshl_add_u32 v2, v3, 5, v2
    v_bfe_u32 v3, v1, 9, 1
    v_lshl_add_u32 v2, v3, 4, v2
    s_mov_b32 s26, 0x400000
    s_mov_b32 s27, 0xbfb8aa3b
    s_waitcnt lgkmcnt(0)
    s_mov_b32 s8, s4
    s_mov_b32 s9, s5
    s_and_b32 s9, s9, 0xffff
    s_mov_b32 s10, 0x400000
    s_mov_b32 s11, 0x00020000
    s_add_u32 s12, s6, 0x3400000
    s_addc_u32 s13, s7, 0
    s_and_b32 s13, s13, 0xffff
    s_mov_b32 s14, 0x800000
    s_mov_b32 s15, 0x00020000
    s_add_u32 s16, s6, 0x3c00000
    s_addc_u32 s17, s7, 0
    s_and_b32 s17, s17, 0xffff
    s_mov_b32 s18, 0x800000
    s_mov_b32 s19, 0x00020000
    s_mov_b32 s20, s24
    s_mov_b32 s21, s25
    s_and_b32 s21, s21, 0xffff
    s_mov_b32 s22, 0x400000
    s_mov_b32 s23, 0x00020000
    buffer_load_dwordx4 v[8:11], v1, s[12:15], 0 offen
    buffer_load_dwordx4 v[12:15], v1, s[12:15], s26 offen
    buffer_load_dwordx4 v[16:19], v1, s[16:19], 0 offen
    buffer_load_dwordx4 v[20:23], v1, s[16:19], s26 offen
    buffer_load_dwordx4 v[4:7], v2, s[8:11], 0 offen
    s_waitcnt vmcnt(0)
    v_lshlrev_b32 v24, 16, v8
    v_and_b32 v25, 0xffff0000, v8
    v_lshlrev_b32 v28, 16, v12
    v_and_b32 v29, 0xffff0000, v12
    v_add_f32 v24, v24, v28
    v_add_f32 v25, v25, v29
    v_cvt_pk_bf16_f32 v24, v24, v25
    v_and_b32 v25, 0xffff0000, v24
    v_lshlrev_b32 v24, 16, v24
    v_lshlrev_b32 v26, 16, v16
    v_and_b32 v27, 0xffff0000, v16
    v_lshlrev_b32 v28, 16, v20
    v_and_b32 v29, 0xffff0000, v20
    v_add_f32 v26, v26, v28
    v_add_f32 v27, v27, v29
    v_cvt_pk_bf16_f32 v26, v26, v27
    v_and_b32 v27, 0xffff0000, v26
    v_lshlrev_b32 v26, 16, v26
    v_mul_f32 v28, s27, v26
    v_mul_f32 v29, s27, v27
    v_exp_f32 v28, v28
    v_exp_f32 v29, v29
    s_nop 0
    v_add_f32 v28, 1.0, v28
    v_add_f32 v29, 1.0, v29
    v_rcp_f32 v28, v28
    v_rcp_f32 v29, v29
    s_nop 0
    v_mul_f32 v26, v26, v28
    v_mul_f32 v27, v27, v29
    v_cvt_pk_bf16_f32 v26, v26, v27
    v_and_b32 v27, 0xffff0000, v26
    v_lshlrev_b32 v26, 16, v26
    v_mul_f32 v24, v24, v26
    v_mul_f32 v25, v25, v27
    v_cvt_pk_bf16_f32 v24, v24, v25
    v_and_b32 v25, 0xffff0000, v24
    v_lshlrev_b32 v24, 16, v24
    v_lshlrev_b32 v26, 16, v4
    v_and_b32 v27, 0xffff0000, v4
    v_add_f32 v24, v24, v26
    v_add_f32 v25, v25, v27
    v_cvt_pk_bf16_f32 v4, v24, v25
    v_lshlrev_b32 v24, 16, v9
    v_and_b32 v25, 0xffff0000, v9
    v_lshlrev_b32 v28, 16, v13
    v_and_b32 v29, 0xffff0000, v13
    v_add_f32 v24, v24, v28
    v_add_f32 v25, v25, v29
    v_cvt_pk_bf16_f32 v24, v24, v25
    v_and_b32 v25, 0xffff0000, v24
    v_lshlrev_b32 v24, 16, v24
    v_lshlrev_b32 v26, 16, v17
    v_and_b32 v27, 0xffff0000, v17
    v_lshlrev_b32 v28, 16, v21
    v_and_b32 v29, 0xffff0000, v21
    v_add_f32 v26, v26, v28
    v_add_f32 v27, v27, v29
    v_cvt_pk_bf16_f32 v26, v26, v27
    v_and_b32 v27, 0xffff0000, v26
    v_lshlrev_b32 v26, 16, v26
    v_mul_f32 v28, s27, v26
    v_mul_f32 v29, s27, v27
    v_exp_f32 v28, v28
    v_exp_f32 v29, v29
    s_nop 0
    v_add_f32 v28, 1.0, v28
    v_add_f32 v29, 1.0, v29
    v_rcp_f32 v28, v28
    v_rcp_f32 v29, v29
    s_nop 0
    v_mul_f32 v26, v26, v28
    v_mul_f32 v27, v27, v29
    v_cvt_pk_bf16_f32 v26, v26, v27
    v_and_b32 v27, 0xffff0000, v26
    v_lshlrev_b32 v26, 16, v26
    v_mul_f32 v24, v24, v26
    v_mul_f32 v25, v25, v27
    v_cvt_pk_bf16_f32 v24, v24, v25
    v_and_b32 v25, 0xffff0000, v24
    v_lshlrev_b32 v24, 16, v24
    v_lshlrev_b32 v26, 16, v5
    v_and_b32 v27, 0xffff0000, v5
    v_add_f32 v24, v24, v26
    v_add_f32 v25, v25, v27
    v_cvt_pk_bf16_f32 v5, v24, v25
    v_lshlrev_b32 v24, 16, v10
    v_and_b32 v25, 0xffff0000, v10
    v_lshlrev_b32 v28, 16, v14
    v_and_b32 v29, 0xffff0000, v14
    v_add_f32 v24, v24, v28
    v_add_f32 v25, v25, v29
    v_cvt_pk_bf16_f32 v24, v24, v25
    v_and_b32 v25, 0xffff0000, v24
    v_lshlrev_b32 v24, 16, v24
    v_lshlrev_b32 v26, 16, v18
    v_and_b32 v27, 0xffff0000, v18
    v_lshlrev_b32 v28, 16, v22
    v_and_b32 v29, 0xffff0000, v22
    v_add_f32 v26, v26, v28
    v_add_f32 v27, v27, v29
    v_cvt_pk_bf16_f32 v26, v26, v27
    v_and_b32 v27, 0xffff0000, v26
    v_lshlrev_b32 v26, 16, v26
    v_mul_f32 v28, s27, v26
    v_mul_f32 v29, s27, v27
    v_exp_f32 v28, v28
    v_exp_f32 v29, v29
    s_nop 0
    v_add_f32 v28, 1.0, v28
    v_add_f32 v29, 1.0, v29
    v_rcp_f32 v28, v28
    v_rcp_f32 v29, v29
    s_nop 0
    v_mul_f32 v26, v26, v28
    v_mul_f32 v27, v27, v29
    v_cvt_pk_bf16_f32 v26, v26, v27
    v_and_b32 v27, 0xffff0000, v26
    v_lshlrev_b32 v26, 16, v26
    v_mul_f32 v24, v24, v26
    v_mul_f32 v25, v25, v27
    v_cvt_pk_bf16_f32 v24, v24, v25
    v_and_b32 v25, 0xffff0000, v24
    v_lshlrev_b32 v24, 16, v24
    v_lshlrev_b32 v26, 16, v6
    v_and_b32 v27, 0xffff0000, v6
    v_add_f32 v24, v24, v26
    v_add_f32 v25, v25, v27
    v_cvt_pk_bf16_f32 v6, v24, v25
    v_lshlrev_b32 v24, 16, v11
    v_and_b32 v25, 0xffff0000, v11
    v_lshlrev_b32 v28, 16, v15
    v_and_b32 v29, 0xffff0000, v15
    v_add_f32 v24, v24, v28
    v_add_f32 v25, v25, v29
    v_cvt_pk_bf16_f32 v24, v24, v25
    v_and_b32 v25, 0xffff0000, v24
    v_lshlrev_b32 v24, 16, v24
    v_lshlrev_b32 v26, 16, v19
    v_and_b32 v27, 0xffff0000, v19
    v_lshlrev_b32 v28, 16, v23
    v_and_b32 v29, 0xffff0000, v23
    v_add_f32 v26, v26, v28
    v_add_f32 v27, v27, v29
    v_cvt_pk_bf16_f32 v26, v26, v27
    v_and_b32 v27, 0xffff0000, v26
    v_lshlrev_b32 v26, 16, v26
    v_mul_f32 v28, s27, v26
    v_mul_f32 v29, s27, v27
    v_exp_f32 v28, v28
    v_exp_f32 v29, v29
    s_nop 0
    v_add_f32 v28, 1.0, v28
    v_add_f32 v29, 1.0, v29
    v_rcp_f32 v28, v28
    v_rcp_f32 v29, v29
    s_nop 0
    v_mul_f32 v26, v26, v28
    v_mul_f32 v27, v27, v29
    v_cvt_pk_bf16_f32 v26, v26, v27
    v_and_b32 v27, 0xffff0000, v26
    v_lshlrev_b32 v26, 16, v26
    v_mul_f32 v24, v24, v26
    v_mul_f32 v25, v25, v27
    v_cvt_pk_bf16_f32 v24, v24, v25
    v_and_b32 v25, 0xffff0000, v24
    v_lshlrev_b32 v24, 16, v24
    v_lshlrev_b32 v26, 16, v7
    v_and_b32 v27, 0xffff0000, v7
    v_add_f32 v24, v24, v26
    v_add_f32 v25, v25, v27
    v_cvt_pk_bf16_f32 v7, v24, v25
    buffer_store_dwordx4 v[4:7], v2, s[20:23], 0 offen
L_cb_done:
    s_endpgm
.section .rodata,"a"
.p2align 6
.amdhsa_kernel comb_kernel
  .amdhsa_next_free_vgpr 32
  .amdhsa_next_free_sgpr 32
  .amdhsa_accum_offset 32
  .amdhsa_group_segment_fixed_size 0
  .amdhsa_kernarg_size 96
  .amdhsa_user_sgpr_count 2
  .amdhsa_user_sgpr_kernarg_segment_ptr 1
  .amdhsa_system_sgpr_workgroup_id_x 1
  .amdhsa_float_denorm_mode_32 3
.end_amdhsa_kernel
```
